```python
import torch

def _softmax(x, axis=-1):
    return torch.softmax(x, dim=axis)
def _gelu(x):
    return torch.nn.functional.gelu(x, approximate="tanh")
def _silu(x):
    return torch.nn.functional.silu(x)
def _sigmoid(x):
    return torch.sigmoid(x)
def _layernorm(x, axis=-1, eps=1e-5):
    m = x.mean(dim=axis, keepdim=True)
    v = x.var(dim=axis, keepdim=True, unbiased=False)
    return (x - m) / torch.sqrt(v + eps)
def _scatter_add(tgt, idx, src, axis=0):
    return tgt.clone().index_add_(axis, idx, src)
def _segment_sum(src, seg, n):
    out = torch.zeros((n,) + src.shape[1:], dtype=src.dtype)
    return out.index_add_(0, seg, src)
def _pad(x, pw):
    flat = tuple(v for pair in reversed(pw) for v in pair)
    return torch.nn.functional.pad(x, flat)

kernel_name = 'gated_mix__linear_kernel_hedgehog__geglu_ffn__prompt'

def setup_inputs():

    _w = (lambda a: (lambda t: t.to(torch.bfloat16) if t.is_floating_point() else t)(torch.as_tensor(a)))
    def _A_setup():
        B, S, D, H = 1, 2048, 576, 32
        Dh = D // H
        return {
            "x": _w((lambda *s: torch.randn(*s, dtype=torch.bfloat16) * 0.05)(B, S, D)),
            "wqkv": _w((lambda *s: torch.randn(*s, dtype=torch.bfloat16) * 0.8)(D, 3 * D)),
            "w_phi": _w((lambda *s: torch.randn(*s, dtype=torch.bfloat16) * 0.8)(H, Dh, Dh) * (Dh ** -0.5)),
            "wo": _w((lambda *s: torch.randn(*s, dtype=torch.bfloat16) * 0.05)(D, D)),
        }
    _A_in = _A_setup()

    def _B_setup():
        B, S, D, F = 1, 2048, 576, 4608
        return {
            "x": _w((lambda *s: torch.randn(*s, dtype=torch.bfloat16) * 0.05)(B, S, D)),
            "w_gate": _w((lambda *s: torch.randn(*s, dtype=torch.bfloat16) * 0.05)(D, F)),
            "w_up": _w((lambda *s: torch.randn(*s, dtype=torch.bfloat16) * 0.05)(D, F)),
            "w_down": _w((lambda *s: torch.randn(*s, dtype=torch.bfloat16) * 0.05)(F, D)),
        }
    _B_in = _B_setup()

    return {
        "A_x": _A_in["x"],
        "A_wqkv": _A_in["wqkv"],
        "A_w_phi": _A_in["w_phi"],
        "A_wo": _A_in["wo"],
        "B_x": _B_in["x"],
        "B_w_gate": _B_in["w_gate"],
        "B_w_up": _B_in["w_up"],
        "B_w_down": _B_in["w_down"],
        "gate_w": _w((lambda *s: torch.randn(*s, dtype=torch.bfloat16) * 0.05)(576) * 16.0),
    }

def reference(A_x, A_wqkv, A_w_phi, A_wo, B_x, B_w_gate, B_w_up, B_w_down, gate_w):
    def _A_ref(x, wqkv, w_phi, wo):
        B, S, D = x.shape
        H = 32; Dh = D // H
        qkv = (lambda x, *d: x.permute(*d))((x @ wqkv).reshape(B, S, 3, H, Dh), 2, 0, 3, 1, 4)
        q, k, v = qkv[0], qkv[1], qkv[2]
        pq = torch.einsum("bhsd,hdf->bhsf", q, w_phi)
        pk = torch.einsum("bhsd,hdf->bhsf", k, w_phi)
        phi_q = torch.concatenate([_softmax(pq, axis=-1), _softmax(-pq, axis=-1)], axis=-1)
        phi_k = torch.concatenate([_softmax(pk, axis=-1), _softmax(-pk, axis=-1)], axis=-1)
        kv = torch.einsum("bhsf,bhsd->bhfd", phi_k, v)
        z  = torch.einsum("bhsf->bhf", phi_k)
        num = torch.einsum("bhqf,bhfd->bhqd", phi_q, kv)
        den = torch.einsum("bhqf,bhf->bhq", phi_q, z)[..., None] + 1e-6
        o = num / den
        return (lambda x, *d: x.permute(*d))(o, 0, 2, 1, 3).reshape(B, S, D) @ wo

    def _B_ref(x, w_gate, w_up, w_down):
        return (_gelu(x @ w_gate) * (x @ w_up)) @ w_down

    x = A_x
    g = _sigmoid((x * gate_w).sum(-1, keepdims=True))
    a = _A_ref(x, A_wqkv, A_w_phi, A_wo)
    b = _B_ref(x, B_w_gate, B_w_up, B_w_down)
    return g * a + (1 - g) * b
```

```asm
; @launch grid=(256,1,1) block=(256,1,1) lds=163840
.amdgcn_target "amdgcn-amd-amdhsa--gfx950"
.text
.globl gated_mix__linear_kernel_hedgehog__geglu_ffn__prompt_kernel
.p2align 8
.type gated_mix__linear_kernel_hedgehog__geglu_ffn__prompt_kernel,@function
gated_mix__linear_kernel_hedgehog__geglu_ffn__prompt_kernel:
    s_cmp_ge_u32 s2, 256
    s_cbranch_scc1 L_k1_end
    s_load_dwordx4 s[56:59], s[0:1], 0
    s_load_dwordx4 s[60:63], s[0:1], 16
    s_load_dwordx2 s[42:43], s[0:1], 40
    s_load_dwordx2 s[44:45], s[0:1], 48
    s_load_dwordx2 s[64:65], s[0:1], 64
    s_load_dwordx2 s[66:67], s[0:1], 56
    s_load_dwordx4 s[68:71], s[0:1], 80
    v_lshrrev_b32 v1, 6, v0
    s_and_b32 s4, s2, 7
    s_lshr_b32 s5, s2, 3
    v_readfirstlane_b32 s24, v1
    s_nop 0
    s_cmp_eq_u32 s24, 3
    s_cbranch_scc0 L_k1_ncpf
    s_getpc_b64 s[72:73]
L_cpf_k1:
    s_sub_u32 s72, s72, L_cpf_k1-gated_mix__linear_kernel_hedgehog__geglu_ffn__prompt_kernel
    s_subb_u32 s73, s73, 0
    s_lshr_b32 s74, s2, 3
    s_lshl_b32 s74, s74, 11
    s_min_u32 s74, s74, L_code_end-gated_mix__linear_kernel_hedgehog__geglu_ffn__prompt_kernel-2048
    s_add_u32 s72, s72, s74
    s_addc_u32 s73, s73, 0
    v_and_b32 v2, 63, v0
    v_lshlrev_b32 v2, 4, v2
    global_load_dwordx4 v[56:59], v2, s[72:73]
    global_load_dwordx4 v[56:59], v2, s[72:73] offset:1024
L_k1_ncpf:
    s_waitcnt lgkmcnt(0)
    s_mov_b32 s46, s70
    s_mov_b32 s47, s71
    s_mov_b32 s40, s56
    s_mov_b32 s41, s57
    s_lshl_b32 s72, s2, 2
    s_add_u32 s72, s72, s24
    v_and_b32 v2, 63, v0
    v_lshlrev_b32 v3, 4, v2
    s_mov_b32 s8, s56
    s_mov_b32 s9, s57
    s_mov_b32 s10, 2359296
    s_mov_b32 s11, 0x20000
    s_mul_i32 s73, s72, 2304
    buffer_load_dwordx4 v[56:59], v3, s[8:11], s73 offen offset:0
    buffer_load_dwordx4 v[56:59], v3, s[8:11], s73 offen offset:1024
    buffer_load_dwordx4 v[56:59], v3, s[8:11], s73 offen offset:2048
    s_cmp_eq_u32 s24, 0
    s_cbranch_scc0 L_k1_nz
    s_add_u32 s72, s70, 22806528
    s_addc_u32 s73, s71, 0
    s_lshl_b32 s74, s2, 7
    v_and_b32 v2, 31, v0
    v_lshlrev_b32 v2, 2, v2
    v_add_u32 v2, s74, v2
    v_mov_b32 v3, 0
    global_store_dword v2, v3, s[72:73] sc1
    s_cmp_lt_u32 s2, 17
    s_cbranch_scc0 L_k1_nz
    v_add_u32 v2, 32768, v2
    global_store_dword v2, v3, s[72:73] sc1
L_k1_nz:
    s_cmp_lt_u32 s5, 8
    s_cbranch_scc1 L_att
    s_sub_u32 s6, s5, 8
    s_lshr_b32 s36, s6, 3
    s_mul_i32 s7, s4, 3
    s_add_u32 s36, s36, s7
    s_and_b32 s37, s6, 7
    s_mul_i32 s39, s36, 384
    s_add_u32 s12, s42, s39
    s_addc_u32 s13, s43, 0
    s_sub_u32 s14, 5308416, s39
    s_mov_b32 s15, 0x20000
    s_add_u32 s16, s44, s39
    s_addc_u32 s17, s45, 0
    s_sub_u32 s18, 5308416, s39
    s_mov_b32 s19, 0x20000
    s_mul_i32 s38, s37, 294912
    s_add_u32 s8, s40, s38
    s_addc_u32 s9, s41, 0
    s_sub_u32 s8, s8, 4096
    s_subb_u32 s9, s9, 0
    s_mov_b32 s10, 299008
    s_mov_b32 s11, 0x20000
    v_and_b32 v24, 63, v0
    v_lshrrev_b32 v25, 4, v24
    v_and_b32 v26, 15, v24
    v_lshrrev_b32 v27, 3, v24
    v_and_b32 v28, 7, v24
    v_add_u32 v30, 0, v25
    v_and_b32 v30, 7, v30
    v_xor_b32 v30, v30, v28
    v_lshlrev_b32 v30, 4, v30
    v_add_u32 v31, 0, v27
    v_mul_u32_u24 v31, 0x480, v31
    v_add3_u32 v3, v30, v31, 0
    v_add_u32 v3, 4096, v3
    v_add_u32 v30, 4, v25
    v_and_b32 v30, 7, v30
    v_xor_b32 v30, v30, v28
    v_lshlrev_b32 v30, 4, v30
    v_add_u32 v31, 8, v27
    v_mul_u32_u24 v31, 0x480, v31
    v_add3_u32 v4, v30, v31, 0
    v_add_u32 v4, 3072, v4
    v_add_u32 v30, 0, v25
    v_and_b32 v30, 7, v30
    v_xor_b32 v30, v30, v28
    v_lshlrev_b32 v30, 4, v30
    v_add_u32 v31, 16, v27
    v_mul_u32_u24 v31, 0x480, v31
    v_add3_u32 v5, v30, v31, 0
    v_add_u32 v5, 2048, v5
    v_add_u32 v30, 4, v25
    v_and_b32 v30, 7, v30
    v_xor_b32 v30, v30, v28
    v_lshlrev_b32 v30, 4, v30
    v_add_u32 v31, 24, v27
    v_mul_u32_u24 v31, 0x480, v31
    v_add3_u32 v6, v30, v31, 0
    v_add_u32 v6, 1024, v6
    s_mov_b32 s50, s37
    s_mov_b32 s34, s50
    s_mov_b32 s35, s50
    s_mov_b32 s48, 0
    s_mul_i32 s25, s24, 73728
    s_lshl_b32 s38, s50, 7
    s_add_u32 s25, s25, s38
    s_add_u32 s26, s25, 36864
    s_lshl_b32 s31, s24, 13
    s_add_u32 m0, s31, 65536
    s_nop 0
    buffer_load_dwordx4 v3, s[8:11], s25 offen offset:0 lds
    buffer_load_dwordx4 v4, s[8:11], s25 offen offset:1024 lds
    buffer_load_dwordx4 v5, s[8:11], s25 offen offset:2048 lds
    buffer_load_dwordx4 v6, s[8:11], s25 offen offset:3072 lds
    s_add_u32 m0, s31, 69632
    s_nop 0
    buffer_load_dwordx4 v3, s[8:11], s26 offen offset:0 lds
    buffer_load_dwordx4 v4, s[8:11], s26 offen offset:1024 lds
    buffer_load_dwordx4 v5, s[8:11], s26 offen offset:2048 lds
    buffer_load_dwordx4 v6, s[8:11], s26 offen offset:3072 lds
    s_add_u32 s35, s35, 1
    s_cmp_eq_u32 s35, 9
    s_cselect_b32 s49, 1152, 0
    s_cselect_b32 s35, 0, s35
    s_add_u32 s25, s25, 128
    s_sub_u32 s25, s25, s49
    s_add_u32 s26, s25, 36864
    s_lshl_b32 s38, s24, 4
    v_bfe_u32 v30, v27, 1, 1
    v_lshrrev_b32 v31, 2, v28
    v_xor_b32 v30, v30, v31
    v_lshlrev_b32 v30, 6, v30
    v_and_b32 v31, 3, v28
    v_lshlrev_b32 v31, 4, v31
    v_add_u32 v30, v30, v31
    v_add_u32 v31, s38, v27
    v_mul_u32_u24 v31, 0x2400, v31
    v_add_u32 v1, v30, v31
    v_add_u32 v2, 72704, v1
    s_mul_i32 s27, s34, 589824
    s_lshl_b32 s30, s24, 11
    s_add_u32 m0, s30, 98304
    s_nop 0
    buffer_load_dwordx4 v1, s[12:15], s27 offen lds
    buffer_load_dwordx4 v2, s[12:15], s27 offen offset:1024 lds
    s_add_u32 m0, s30, 106496
    s_nop 0
    buffer_load_dwordx4 v1, s[16:19], s27 offen lds
    buffer_load_dwordx4 v2, s[16:19], s27 offen offset:1024 lds
    s_add_u32 s34, s34, 1
    s_cmp_eq_u32 s34, 9
    s_cselect_b32 s34, 0, s34
    s_mul_i32 s27, s34, 589824
    s_add_u32 s27, s27, s48
    s_mov_b32 s20, s46
    s_mov_b32 s21, s47
    s_mov_b32 s22, 21233664
    s_mov_b32 s23, 0x20000
    v_lshlrev_b32 v22, 4, v24
    v_lshrrev_b32 v30, 2, v26
    v_and_b32 v31, 3, v26
    v_lshrrev_b32 v29, 1, v25
    v_lshlrev_b32 v29, 3, v29
    v_add_u32 v29, v29, v30
    v_lshlrev_b32 v29, 7, v29
    v_lshlrev_b32 v31, 3, v31
    v_add_u32 v29, v29, v31
    v_and_b32 v31, 1, v25
    v_lshlrev_b32 v31, 5, v31
    v_add_u32 v29, v29, v31
    v_lshrrev_b32 v30, 1, v30
    v_xor_b32 v31, 0, v30
    v_lshlrev_b32 v31, 6, v31
    v_add_u32 v7, v31, v29
    v_xor_b32 v31, 1, v30
    v_lshlrev_b32 v31, 6, v31
    v_add_u32 v8, v31, v29
    v_and_b32 v29, 31, v24
    v_lshrrev_b32 v30, 5, v24
    v_bfe_u32 v31, v29, 1, 3
    v_xor_b32 v30, v30, v31
    v_lshlrev_b32 v30, 4, v30
    v_lshlrev_b32 v31, 7, v29
    v_add_u32 v30, v30, v31
    v_add_u32 v30, s31, v30
    v_add_u32 v14, 65536, v30
    v_xor_b32 v15, 32, v14
    v_xor_b32 v16, 64, v14
    v_xor_b32 v17, 96, v14
    v_add_u32 v18, 32768, v30
    v_xor_b32 v19, 32, v18
    v_xor_b32 v20, 64, v18
    v_xor_b32 v21, 96, v18
    v_mov_b32 v23, 0xbdd2d3e8
    s_lshl_b32 s38, s37, 3
    s_lshl_b32 s39, s24, 1
    s_add_u32 s38, s38, s39
    s_mul_i32 s38, s38, 162
    s_mul_i32 s39, s36, 6
    s_add_u32 s38, s38, s39
    s_lshl_b32 s28, s38, 11
    s_lshl_b32 s38, s36, 3
    s_add_u32 s38, s38, s37
    s_lshl_b32 s38, s38, 2
    s_add_u32 s38, s38, s24
    s_mul_i32 s32, s38, 8192
    s_mov_b32 s56, s66
    s_mov_b32 s57, s67
    s_mov_b32 s58, 5308416
    s_mov_b32 s59, 0x20000
    v_add_u32 v11, 98304, v7
    v_add_u32 v12, 98304, v8
    s_add_u32 m0, s30, 114688
    s_nop 0
    buffer_load_dwordx4 v1, s[12:15], s27 offen lds
    buffer_load_dwordx4 v2, s[12:15], s27 offen offset:1024 lds
    s_add_u32 m0, s30, 122880
    s_nop 0
    buffer_load_dwordx4 v1, s[16:19], s27 offen lds
    buffer_load_dwordx4 v2, s[16:19], s27 offen offset:1024 lds
    s_add_u32 s34, s34, 1
    s_cmp_eq_u32 s34, 9
    s_cselect_b32 s34, 0, s34
    s_mul_i32 s27, s34, 589824
    s_add_u32 s27, s27, s48
    s_add_u32 m0, s31, 32768
    s_nop 0
    buffer_load_dwordx4 v3, s[8:11], s25 offen offset:0 lds
    buffer_load_dwordx4 v4, s[8:11], s25 offen offset:1024 lds
    buffer_load_dwordx4 v5, s[8:11], s25 offen offset:2048 lds
    buffer_load_dwordx4 v6, s[8:11], s25 offen offset:3072 lds
    s_add_u32 m0, s31, 36864
    s_nop 0
    buffer_load_dwordx4 v3, s[8:11], s26 offen offset:0 lds
    buffer_load_dwordx4 v4, s[8:11], s26 offen offset:1024 lds
    buffer_load_dwordx4 v5, s[8:11], s26 offen offset:2048 lds
    buffer_load_dwordx4 v6, s[8:11], s26 offen offset:3072 lds
    s_add_u32 s35, s35, 1
    s_cmp_eq_u32 s35, 9
    s_cselect_b32 s49, 1152, 0
    s_cselect_b32 s35, 0, s35
    s_add_u32 s25, s25, 128
    s_sub_u32 s25, s25, s49
    s_add_u32 s26, s25, 36864
    s_waitcnt vmcnt(12)
    s_barrier
    s_cmp_eq_u32 s24, 0
    s_cbranch_scc0 L_gx_az
    s_cmp_lt_u32 s2, 17
    s_cselect_b32 s72, 2, 1
    v_mov_b32 v60, 0
    v_mov_b32 v61, s72
    v_cmp_eq_u32 vcc, 0, v0
    s_and_saveexec_b64 s[72:73], vcc
    global_atomic_add v60, v61, s[68:69] sc1
    s_mov_b64 exec, s[72:73]
L_gx_az:
    ds_read_b128 a[0:3], v14 offset:0
    ds_read_b128 a[4:7], v14 offset:4096
    ds_read_b128 a[8:11], v15 offset:0
    ds_read_b128 a[12:15], v15 offset:4096
    ds_read_b128 a[16:19], v16 offset:0
    ds_read_b128 a[20:23], v16 offset:4096
    ds_read_b128 a[24:27], v17 offset:0
    ds_read_b128 a[28:31], v17 offset:4096
    ds_read_b64_tr_b16 v[64:65], v11 offset:0
    ds_read_b64_tr_b16 v[66:67], v11 offset:512
    ds_read_b64_tr_b16 v[68:69], v11 offset:8192
    ds_read_b64_tr_b16 v[70:71], v11 offset:8704
    ds_read_b64_tr_b16 v[72:73], v12 offset:0
    ds_read_b64_tr_b16 v[74:75], v12 offset:512
    s_waitcnt lgkmcnt(6)
    ds_read_b64_tr_b16 v[76:77], v12 offset:8192
    ds_read_b64_tr_b16 v[78:79], v12 offset:8704
    ds_read_b64_tr_b16 v[80:81], v11 offset:2048
    ds_read_b64_tr_b16 v[82:83], v11 offset:2560
    s_lshl_b32 s38, s2, 2
    s_add_u32 s38, s38, s24
    s_mul_i32 s51, s38, 6144
    s_mov_b32 s52, s42
    s_mov_b32 s53, s43
    s_mov_b32 s54, 5308416
    s_mov_b32 s55, 0x20000
    s_mov_b32 s60, s44
    s_mov_b32 s61, s45
    s_mov_b32 s62, 5308416
    s_mov_b32 s63, 0x20000
    s_waitcnt lgkmcnt(6)
    v_mfma_f32_32x32x16_bf16 v[96:111], v[64:67], a[0:3], 0
    s_add_u32 m0, s30, 131072
    s_nop 0
    buffer_load_dwordx4 v1, s[12:15], s27 offen lds
    ds_read_b64_tr_b16 v[84:85], v11 offset:10240
    v_mfma_f32_32x32x16_bf16 v[128:143], v[64:67], a[4:7], 0
    buffer_load_dwordx4 v2, s[12:15], s27 offen offset:1024 lds
    ds_read_b64_tr_b16 v[86:87], v11 offset:10752
    v_mfma_f32_32x32x16_bf16 v[112:127], v[68:71], a[0:3], 0
    s_add_u32 m0, s30, 139264
    ds_read_b64_tr_b16 v[88:89], v12 offset:2048
    v_mfma_f32_32x32x16_bf16 v[144:159], v[68:71], a[4:7], 0
    buffer_load_dwordx4 v1, s[16:19], s27 offen lds
    ds_read_b64_tr_b16 v[90:91], v12 offset:2560
    s_waitcnt lgkmcnt(6)
    v_mfma_f32_32x32x16_bf16 v[160:175], v[72:75], a[0:3], 0
    buffer_load_dwordx4 v2, s[16:19], s27 offen offset:1024 lds
    ds_read_b64_tr_b16 v[92:93], v12 offset:10240
    v_mfma_f32_32x32x16_bf16 v[192:207], v[72:75], a[4:7], 0
    s_add_u32 s34, s34, 1
    s_cmp_eq_u32 s34, 9
    s_cselect_b32 s34, 0, s34
    s_mul_i32 s27, s34, 589824
    s_add_u32 s27, s27, s48
    s_add_u32 m0, s31, 65536
    ds_read_b64_tr_b16 v[94:95], v12 offset:10752
    v_mfma_f32_32x32x16_bf16 v[176:191], v[76:79], a[0:3], 0
    buffer_load_dwordx4 v3, s[8:11], s25 offen offset:0 lds
    ds_read_b64_tr_b16 v[64:65], v11 offset:4096
    v_mfma_f32_32x32x16_bf16 v[208:223], v[76:79], a[4:7], 0
    buffer_load_dwordx4 v4, s[8:11], s25 offen offset:1024 lds
    ds_read_b64_tr_b16 v[66:67], v11 offset:4608
    s_waitcnt lgkmcnt(6)
    v_mfma_f32_32x32x16_bf16 v[96:111], v[80:83], a[8:11], v[96:111]
    buffer_load_dwordx4 v5, s[8:11], s25 offen offset:2048 lds
    ds_read_b64_tr_b16 v[68:69], v11 offset:12288
    v_mfma_f32_32x32x16_bf16 v[128:143], v[80:83], a[12:15], v[128:143]
    buffer_load_dwordx4 v6, s[8:11], s25 offen offset:3072 lds
    ds_read_b64_tr_b16 v[70:71], v11 offset:12800
    v_mfma_f32_32x32x16_bf16 v[112:127], v[84:87], a[8:11], v[112:127]
    s_add_u32 m0, s31, 69632
    ds_read_b64_tr_b16 v[72:73], v12 offset:4096
    v_mfma_f32_32x32x16_bf16 v[144:159], v[84:87], a[12:15], v[144:159]
    buffer_load_dwordx4 v3, s[8:11], s26 offen offset:0 lds
    ds_read_b64_tr_b16 v[74:75], v12 offset:4608
    s_waitcnt lgkmcnt(6)
    v_mfma_f32_32x32x16_bf16 v[160:175], v[88:91], a[8:11], v[160:175]
    buffer_load_dwordx4 v4, s[8:11], s26 offen offset:1024 lds
    ds_read_b64_tr_b16 v[76:77], v12 offset:12288
    v_mfma_f32_32x32x16_bf16 v[192:207], v[88:91], a[12:15], v[192:207]
    buffer_load_dwordx4 v5, s[8:11], s26 offen offset:2048 lds
    ds_read_b64_tr_b16 v[78:79], v12 offset:12800
    v_mfma_f32_32x32x16_bf16 v[176:191], v[92:95], a[8:11], v[176:191]
    buffer_load_dwordx4 v6, s[8:11], s26 offen offset:3072 lds
    ds_read_b64_tr_b16 v[80:81], v11 offset:6144
    v_mfma_f32_32x32x16_bf16 v[208:223], v[92:95], a[12:15], v[208:223]
    s_add_u32 s35, s35, 1
    s_cmp_eq_u32 s35, 9
    s_cselect_b32 s49, 1152, 0
    s_cselect_b32 s35, 0, s35
    s_add_u32 s25, s25, 128
    s_sub_u32 s25, s25, s49
    s_add_u32 s26, s25, 36864
    ds_read_b64_tr_b16 v[82:83], v11 offset:6656
    s_waitcnt vmcnt(12)
    s_barrier
    s_waitcnt lgkmcnt(6)
    v_mfma_f32_32x32x16_bf16 v[96:111], v[64:67], a[16:19], v[96:111]
    ds_read_b128 a[32:35], v18 offset:0
    ds_read_b64_tr_b16 v[84:85], v11 offset:14336
    v_mfma_f32_32x32x16_bf16 v[128:143], v[64:67], a[20:23], v[128:143]
    ds_read_b128 a[36:39], v18 offset:4096
    ds_read_b64_tr_b16 v[86:87], v11 offset:14848
    v_mfma_f32_32x32x16_bf16 v[112:127], v[68:71], a[16:19], v[112:127]
    s_add_u32 m0, s30, 147456
    ds_read_b128 a[40:43], v19 offset:0
    ds_read_b64_tr_b16 v[88:89], v12 offset:6144
    v_mfma_f32_32x32x16_bf16 v[144:159], v[68:71], a[20:23], v[144:159]
    ds_read_b128 a[44:47], v19 offset:4096
    ds_read_b64_tr_b16 v[90:91], v12 offset:6656
    s_waitcnt lgkmcnt(10)
    v_mfma_f32_32x32x16_bf16 v[160:175], v[72:75], a[16:19], v[160:175]
    buffer_load_dwordx4 v1, s[12:15], s27 offen lds
    ds_read_b128 a[48:51], v20 offset:0
    ds_read_b64_tr_b16 v[92:93], v12 offset:14336
    v_mfma_f32_32x32x16_bf16 v[192:207], v[72:75], a[20:23], v[192:207]
    ds_read_b128 a[52:55], v20 offset:4096
    ds_read_b64_tr_b16 v[94:95], v12 offset:14848
    v_mfma_f32_32x32x16_bf16 v[176:191], v[76:79], a[16:19], v[176:191]
    buffer_load_dwordx4 v2, s[12:15], s27 offen offset:1024 lds
    ds_read_b128 a[56:59], v21 offset:0
    s_waitcnt lgkmcnt(14)
    ds_read_b64_tr_b16 v[64:65], v11 offset:16384
    v_mfma_f32_32x32x16_bf16 v[208:223], v[76:79], a[20:23], v[208:223]
    s_waitcnt lgkmcnt(14)
    ds_read_b128 a[60:63], v21 offset:4096
    s_waitcnt lgkmcnt(14)
    ds_read_b64_tr_b16 v[66:67], v11 offset:16896
    v_mfma_f32_32x32x16_bf16 v[96:111], v[80:83], a[24:27], v[96:111]
    s_add_u32 m0, s30, 155648
    s_waitcnt lgkmcnt(14)
    ds_read_b64_tr_b16 v[68:69], v11 offset:24576
    v_mfma_f32_32x32x16_bf16 v[128:143], v[80:83], a[28:31], v[128:143]
    s_waitcnt lgkmcnt(14)
    ds_read_b64_tr_b16 v[70:71], v11 offset:25088
    s_waitcnt lgkmcnt(12)
    v_mfma_f32_32x32x16_bf16 v[112:127], v[84:87], a[24:27], v[112:127]
    buffer_load_dwordx4 v1, s[16:19], s27 offen lds
    ds_read_b64_tr_b16 v[72:73], v12 offset:16384
    v_mfma_f32_32x32x16_bf16 v[144:159], v[84:87], a[28:31], v[144:159]
    ds_read_b64_tr_b16 v[74:75], v12 offset:16896
    s_waitcnt lgkmcnt(10)
    v_mfma_f32_32x32x16_bf16 v[160:175], v[88:91], a[24:27], v[160:175]
    buffer_load_dwordx4 v2, s[16:19], s27 offen offset:1024 lds
    ds_read_b64_tr_b16 v[76:77], v12 offset:24576
    v_mfma_f32_32x32x16_bf16 v[192:207], v[88:91], a[28:31], v[192:207]
    ds_read_b64_tr_b16 v[78:79], v12 offset:25088
    s_waitcnt lgkmcnt(8)
    v_mfma_f32_32x32x16_bf16 v[176:191], v[92:95], a[24:27], v[176:191]
    s_add_u32 s34, s34, 1
    s_cmp_eq_u32 s34, 9
    s_cselect_b32 s34, 0, s34
    s_mul_i32 s27, s34, 589824
    s_add_u32 s27, s27, s48
    ds_read_b64_tr_b16 v[80:81], v11 offset:18432
    v_mfma_f32_32x32x16_bf16 v[208:223], v[92:95], a[28:31], v[208:223]
    ds_read_b64_tr_b16 v[82:83], v11 offset:18944
    s_waitcnt lgkmcnt(6)
    v_mfma_f32_32x32x16_bf16 v[96:111], v[64:67], a[32:35], v[96:111]
    ds_read_b64_tr_b16 v[84:85], v11 offset:26624
    v_mfma_f32_32x32x16_bf16 v[128:143], v[64:67], a[36:39], v[128:143]
    ds_read_b64_tr_b16 v[86:87], v11 offset:27136
    v_mfma_f32_32x32x16_bf16 v[112:127], v[68:71], a[32:35], v[112:127]
    s_add_u32 m0, s31, 32768
    ds_read_b64_tr_b16 v[88:89], v12 offset:18432
    v_mfma_f32_32x32x16_bf16 v[144:159], v[68:71], a[36:39], v[144:159]
    buffer_load_dwordx4 v3, s[8:11], s25 offen offset:0 lds
    ds_read_b64_tr_b16 v[90:91], v12 offset:18944
    s_waitcnt lgkmcnt(6)
    v_mfma_f32_32x32x16_bf16 v[160:175], v[72:75], a[32:35], v[160:175]
    buffer_load_dwordx4 v4, s[8:11], s25 offen offset:1024 lds
    ds_read_b64_tr_b16 v[92:93], v12 offset:26624
    v_mfma_f32_32x32x16_bf16 v[192:207], v[72:75], a[36:39], v[192:207]
    buffer_load_dwordx4 v5, s[8:11], s25 offen offset:2048 lds
    ds_read_b64_tr_b16 v[94:95], v12 offset:27136
    v_mfma_f32_32x32x16_bf16 v[176:191], v[76:79], a[32:35], v[176:191]
    ds_read_b64_tr_b16 v[64:65], v11 offset:20480
    v_mfma_f32_32x32x16_bf16 v[208:223], v[76:79], a[36:39], v[208:223]
    buffer_load_dwordx4 v6, s[8:11], s25 offen offset:3072 lds
    ds_read_b64_tr_b16 v[66:67], v11 offset:20992
    s_waitcnt lgkmcnt(6)
    v_mfma_f32_32x32x16_bf16 v[96:111], v[80:83], a[40:43], v[96:111]
    s_add_u32 m0, s31, 36864
    ds_read_b64_tr_b16 v[68:69], v11 offset:28672
    v_mfma_f32_32x32x16_bf16 v[128:143], v[80:83], a[44:47], v[128:143]
    buffer_load_dwordx4 v3, s[8:11], s26 offen offset:0 lds
    ds_read_b64_tr_b16 v[70:71], v11 offset:29184
    v_mfma_f32_32x32x16_bf16 v[112:127], v[84:87], a[40:43], v[112:127]
    buffer_load_dwordx4 v4, s[8:11], s26 offen offset:1024 lds
    ds_read_b64_tr_b16 v[72:73], v12 offset:20480
    v_mfma_f32_32x32x16_bf16 v[144:159], v[84:87], a[44:47], v[144:159]
    ds_read_b64_tr_b16 v[74:75], v12 offset:20992
    s_waitcnt lgkmcnt(6)
    v_mfma_f32_32x32x16_bf16 v[160:175], v[88:91], a[40:43], v[160:175]
    buffer_load_dwordx4 v5, s[8:11], s26 offen offset:2048 lds
    ds_read_b64_tr_b16 v[76:77], v12 offset:28672
    v_mfma_f32_32x32x16_bf16 v[192:207], v[88:91], a[44:47], v[192:207]
    buffer_load_dwordx4 v6, s[8:11], s26 offen offset:3072 lds
    ds_read_b64_tr_b16 v[78:79], v12 offset:29184
    v_mfma_f32_32x32x16_bf16 v[176:191], v[92:95], a[40:43], v[176:191]
    s_add_u32 s35, s35, 1
    s_cmp_eq_u32 s35, 9
    s_cselect_b32 s49, 1152, 0
    s_cselect_b32 s35, 0, s35
    s_add_u32 s25, s25, 128
    s_sub_u32 s25, s25, s49
    s_add_u32 s26, s25, 36864
    ds_read_b64_tr_b16 v[80:81], v11 offset:22528
    v_mfma_f32_32x32x16_bf16 v[208:223], v[92:95], a[44:47], v[208:223]
    ds_read_b64_tr_b16 v[82:83], v11 offset:23040
    s_waitcnt vmcnt(12)
    s_barrier
    s_waitcnt lgkmcnt(6)
    v_mfma_f32_32x32x16_bf16 v[96:111], v[64:67], a[48:51], v[96:111]
    ds_read_b128 a[64:67], v14 offset:0
    ds_read_b64_tr_b16 v[84:85], v11 offset:30720
    v_mfma_f32_32x32x16_bf16 v[128:143], v[64:67], a[52:55], v[128:143]
    ds_read_b128 a[68:71], v14 offset:4096
    ds_read_b64_tr_b16 v[86:87], v11 offset:31232
    v_mfma_f32_32x32x16_bf16 v[112:127], v[68:71], a[48:51], v[112:127]
    s_add_u32 m0, s30, 98304
    ds_read_b128 a[72:75], v15 offset:0
    ds_read_b64_tr_b16 v[88:89], v12 offset:22528
    v_mfma_f32_32x32x16_bf16 v[144:159], v[68:71], a[52:55], v[144:159]
    ds_read_b128 a[76:79], v15 offset:4096
    ds_read_b64_tr_b16 v[90:91], v12 offset:23040
    s_waitcnt lgkmcnt(10)
    v_mfma_f32_32x32x16_bf16 v[160:175], v[72:75], a[48:51], v[160:175]
    buffer_load_dwordx4 v1, s[12:15], s27 offen lds
    ds_read_b128 a[80:83], v16 offset:0
    ds_read_b64_tr_b16 v[92:93], v12 offset:30720
    v_mfma_f32_32x32x16_bf16 v[192:207], v[72:75], a[52:55], v[192:207]
    ds_read_b128 a[84:87], v16 offset:4096
    ds_read_b64_tr_b16 v[94:95], v12 offset:31232
    v_mfma_f32_32x32x16_bf16 v[176:191], v[76:79], a[48:51], v[176:191]
    buffer_load_dwordx4 v2, s[12:15], s27 offen offset:1024 lds
    ds_read_b128 a[88:91], v17 offset:0
    s_waitcnt lgkmcnt(14)
    ds_read_b64_tr_b16 v[64:65], v11 offset:32768
    v_mfma_f32_32x32x16_bf16 v[208:223], v[76:79], a[52:55], v[208:223]
    s_waitcnt lgkmcnt(14)
    ds_read_b128 a[92:95], v17 offset:4096
    s_waitcnt lgkmcnt(14)
    ds_read_b64_tr_b16 v[66:67], v11 offset:33280
    v_mfma_f32_32x32x16_bf16 v[96:111], v[80:83], a[56:59], v[96:111]
    s_add_u32 m0, s30, 106496
    s_waitcnt lgkmcnt(14)
    ds_read_b64_tr_b16 v[68:69], v11 offset:40960
    v_mfma_f32_32x32x16_bf16 v[128:143], v[80:83], a[60:63], v[128:143]
    s_waitcnt lgkmcnt(14)
    ds_read_b64_tr_b16 v[70:71], v11 offset:41472
    s_waitcnt lgkmcnt(12)
    v_mfma_f32_32x32x16_bf16 v[112:127], v[84:87], a[56:59], v[112:127]
    buffer_load_dwordx4 v1, s[16:19], s27 offen lds
    ds_read_b64_tr_b16 v[72:73], v12 offset:32768
    v_mfma_f32_32x32x16_bf16 v[144:159], v[84:87], a[60:63], v[144:159]
    ds_read_b64_tr_b16 v[74:75], v12 offset:33280
    s_waitcnt lgkmcnt(10)
    v_mfma_f32_32x32x16_bf16 v[160:175], v[88:91], a[56:59], v[160:175]
    buffer_load_dwordx4 v2, s[16:19], s27 offen offset:1024 lds
    ds_read_b64_tr_b16 v[76:77], v12 offset:40960
    v_mfma_f32_32x32x16_bf16 v[192:207], v[88:91], a[60:63], v[192:207]
    ds_read_b64_tr_b16 v[78:79], v12 offset:41472
    s_waitcnt lgkmcnt(8)
    v_mfma_f32_32x32x16_bf16 v[176:191], v[92:95], a[56:59], v[176:191]
    s_add_u32 s34, s34, 1
    s_cmp_eq_u32 s34, 9
    s_cselect_b32 s34, 0, s34
    s_mul_i32 s27, s34, 589824
    s_add_u32 s27, s27, s48
    ds_read_b64_tr_b16 v[80:81], v11 offset:34816
    v_mfma_f32_32x32x16_bf16 v[208:223], v[92:95], a[60:63], v[208:223]
    ds_read_b64_tr_b16 v[82:83], v11 offset:35328
    s_waitcnt lgkmcnt(6)
    v_mfma_f32_32x32x16_bf16 v[96:111], v[64:67], a[64:67], v[96:111]
    ds_read_b64_tr_b16 v[84:85], v11 offset:43008
    v_mfma_f32_32x32x16_bf16 v[128:143], v[64:67], a[68:71], v[128:143]
    ds_read_b64_tr_b16 v[86:87], v11 offset:43520
    v_mfma_f32_32x32x16_bf16 v[112:127], v[68:71], a[64:67], v[112:127]
    s_add_u32 m0, s31, 65536
    ds_read_b64_tr_b16 v[88:89], v12 offset:34816
    v_mfma_f32_32x32x16_bf16 v[144:159], v[68:71], a[68:71], v[144:159]
    buffer_load_dwordx4 v3, s[8:11], s25 offen offset:0 lds
    ds_read_b64_tr_b16 v[90:91], v12 offset:35328
    s_waitcnt lgkmcnt(6)
    v_mfma_f32_32x32x16_bf16 v[160:175], v[72:75], a[64:67], v[160:175]
    buffer_load_dwordx4 v4, s[8:11], s25 offen offset:1024 lds
    ds_read_b64_tr_b16 v[92:93], v12 offset:43008
    v_mfma_f32_32x32x16_bf16 v[192:207], v[72:75], a[68:71], v[192:207]
    buffer_load_dwordx4 v5, s[8:11], s25 offen offset:2048 lds
    ds_read_b64_tr_b16 v[94:95], v12 offset:43520
    v_mfma_f32_32x32x16_bf16 v[176:191], v[76:79], a[64:67], v[176:191]
    ds_read_b64_tr_b16 v[64:65], v11 offset:36864
    v_mfma_f32_32x32x16_bf16 v[208:223], v[76:79], a[68:71], v[208:223]
    buffer_load_dwordx4 v6, s[8:11], s25 offen offset:3072 lds
    ds_read_b64_tr_b16 v[66:67], v11 offset:37376
    s_waitcnt lgkmcnt(6)
    v_mfma_f32_32x32x16_bf16 v[96:111], v[80:83], a[72:75], v[96:111]
    s_add_u32 m0, s31, 69632
    ds_read_b64_tr_b16 v[68:69], v11 offset:45056
    v_mfma_f32_32x32x16_bf16 v[128:143], v[80:83], a[76:79], v[128:143]
    buffer_load_dwordx4 v3, s[8:11], s26 offen offset:0 lds
    ds_read_b64_tr_b16 v[70:71], v11 offset:45568
    v_mfma_f32_32x32x16_bf16 v[112:127], v[84:87], a[72:75], v[112:127]
    buffer_load_dwordx4 v4, s[8:11], s26 offen offset:1024 lds
    ds_read_b64_tr_b16 v[72:73], v12 offset:36864
    v_mfma_f32_32x32x16_bf16 v[144:159], v[84:87], a[76:79], v[144:159]
    ds_read_b64_tr_b16 v[74:75], v12 offset:37376
    s_waitcnt lgkmcnt(6)
    v_mfma_f32_32x32x16_bf16 v[160:175], v[88:91], a[72:75], v[160:175]
    buffer_load_dwordx4 v5, s[8:11], s26 offen offset:2048 lds
    ds_read_b64_tr_b16 v[76:77], v12 offset:45056
    v_mfma_f32_32x32x16_bf16 v[192:207], v[88:91], a[76:79], v[192:207]
    buffer_load_dwordx4 v6, s[8:11], s26 offen offset:3072 lds
    ds_read_b64_tr_b16 v[78:79], v12 offset:45568
    v_mfma_f32_32x32x16_bf16 v[176:191], v[92:95], a[72:75], v[176:191]
    s_add_u32 s35, s35, 1
    s_cmp_eq_u32 s35, 9
    s_cselect_b32 s49, 1152, 0
    s_cselect_b32 s35, 0, s35
    s_add_u32 s25, s25, 128
    s_sub_u32 s25, s25, s49
    s_add_u32 s26, s25, 36864
    ds_read_b64_tr_b16 v[80:81], v11 offset:38912
    v_mfma_f32_32x32x16_bf16 v[208:223], v[92:95], a[76:79], v[208:223]
    ds_read_b64_tr_b16 v[82:83], v11 offset:39424
    s_waitcnt vmcnt(12)
    s_barrier
    s_waitcnt lgkmcnt(6)
    v_mfma_f32_32x32x16_bf16 v[96:111], v[64:67], a[80:83], v[96:111]
    ds_read_b128 a[96:99], v18 offset:0
    ds_read_b64_tr_b16 v[84:85], v11 offset:47104
    v_mfma_f32_32x32x16_bf16 v[128:143], v[64:67], a[84:87], v[128:143]
    ds_read_b128 a[100:103], v18 offset:4096
    ds_read_b64_tr_b16 v[86:87], v11 offset:47616
    v_mfma_f32_32x32x16_bf16 v[112:127], v[68:71], a[80:83], v[112:127]
    s_add_u32 m0, s30, 114688
    ds_read_b128 a[104:107], v19 offset:0
    ds_read_b64_tr_b16 v[88:89], v12 offset:38912
    v_mfma_f32_32x32x16_bf16 v[144:159], v[68:71], a[84:87], v[144:159]
    ds_read_b128 a[108:111], v19 offset:4096
    ds_read_b64_tr_b16 v[90:91], v12 offset:39424
    s_waitcnt lgkmcnt(10)
    v_mfma_f32_32x32x16_bf16 v[160:175], v[72:75], a[80:83], v[160:175]
    buffer_load_dwordx4 v1, s[12:15], s27 offen lds
    ds_read_b128 a[112:115], v20 offset:0
    ds_read_b64_tr_b16 v[92:93], v12 offset:47104
    v_mfma_f32_32x32x16_bf16 v[192:207], v[72:75], a[84:87], v[192:207]
    ds_read_b128 a[116:119], v20 offset:4096
    ds_read_b64_tr_b16 v[94:95], v12 offset:47616
    v_mfma_f32_32x32x16_bf16 v[176:191], v[76:79], a[80:83], v[176:191]
    buffer_load_dwordx4 v2, s[12:15], s27 offen offset:1024 lds
    ds_read_b128 a[120:123], v21 offset:0
    s_waitcnt lgkmcnt(14)
    ds_read_b64_tr_b16 v[64:65], v11 offset:49152
    v_mfma_f32_32x32x16_bf16 v[208:223], v[76:79], a[84:87], v[208:223]
    s_waitcnt lgkmcnt(14)
    ds_read_b128 a[124:127], v21 offset:4096
    s_waitcnt lgkmcnt(14)
    ds_read_b64_tr_b16 v[66:67], v11 offset:49664
    v_mfma_f32_32x32x16_bf16 v[96:111], v[80:83], a[88:91], v[96:111]
    s_add_u32 m0, s30, 122880
    s_waitcnt lgkmcnt(14)
    ds_read_b64_tr_b16 v[68:69], v11 offset:57344
    v_mfma_f32_32x32x16_bf16 v[128:143], v[80:83], a[92:95], v[128:143]
    s_waitcnt lgkmcnt(14)
    ds_read_b64_tr_b16 v[70:71], v11 offset:57856
    s_waitcnt lgkmcnt(12)
    v_mfma_f32_32x32x16_bf16 v[112:127], v[84:87], a[88:91], v[112:127]
    buffer_load_dwordx4 v1, s[16:19], s27 offen lds
    ds_read_b64_tr_b16 v[72:73], v12 offset:49152
    v_mfma_f32_32x32x16_bf16 v[144:159], v[84:87], a[92:95], v[144:159]
    ds_read_b64_tr_b16 v[74:75], v12 offset:49664
    s_waitcnt lgkmcnt(10)
    v_mfma_f32_32x32x16_bf16 v[160:175], v[88:91], a[88:91], v[160:175]
    buffer_load_dwordx4 v2, s[16:19], s27 offen offset:1024 lds
    ds_read_b64_tr_b16 v[76:77], v12 offset:57344
    v_mfma_f32_32x32x16_bf16 v[192:207], v[88:91], a[92:95], v[192:207]
    ds_read_b64_tr_b16 v[78:79], v12 offset:57856
    s_waitcnt lgkmcnt(8)
    v_mfma_f32_32x32x16_bf16 v[176:191], v[92:95], a[88:91], v[176:191]
    s_add_u32 s34, s34, 1
    s_cmp_eq_u32 s34, 9
    s_cselect_b32 s34, 0, s34
    s_mul_i32 s27, s34, 589824
    s_add_u32 s27, s27, s48
    ds_read_b64_tr_b16 v[80:81], v11 offset:51200
    v_mfma_f32_32x32x16_bf16 v[208:223], v[92:95], a[92:95], v[208:223]
    ds_read_b64_tr_b16 v[82:83], v11 offset:51712
    s_waitcnt lgkmcnt(6)
    v_mfma_f32_32x32x16_bf16 v[96:111], v[64:67], a[96:99], v[96:111]
    ds_read_b64_tr_b16 v[84:85], v11 offset:59392
    v_mfma_f32_32x32x16_bf16 v[128:143], v[64:67], a[100:103], v[128:143]
    ds_read_b64_tr_b16 v[86:87], v11 offset:59904
    v_mfma_f32_32x32x16_bf16 v[112:127], v[68:71], a[96:99], v[112:127]
    s_add_u32 m0, s31, 32768
    ds_read_b64_tr_b16 v[88:89], v12 offset:51200
    v_mfma_f32_32x32x16_bf16 v[144:159], v[68:71], a[100:103], v[144:159]
    buffer_load_dwordx4 v3, s[8:11], s25 offen offset:0 lds
    ds_read_b64_tr_b16 v[90:91], v12 offset:51712
    s_waitcnt lgkmcnt(6)
    v_mfma_f32_32x32x16_bf16 v[160:175], v[72:75], a[96:99], v[160:175]
    buffer_load_dwordx4 v4, s[8:11], s25 offen offset:1024 lds
    ds_read_b64_tr_b16 v[92:93], v12 offset:59392
    v_mfma_f32_32x32x16_bf16 v[192:207], v[72:75], a[100:103], v[192:207]
    buffer_load_dwordx4 v5, s[8:11], s25 offen offset:2048 lds
    ds_read_b64_tr_b16 v[94:95], v12 offset:59904
    v_mfma_f32_32x32x16_bf16 v[176:191], v[76:79], a[96:99], v[176:191]
    ds_read_b64_tr_b16 v[64:65], v11 offset:53248
    v_mfma_f32_32x32x16_bf16 v[208:223], v[76:79], a[100:103], v[208:223]
    buffer_load_dwordx4 v6, s[8:11], s25 offen offset:3072 lds
    ds_read_b64_tr_b16 v[66:67], v11 offset:53760
    s_waitcnt lgkmcnt(6)
    v_mfma_f32_32x32x16_bf16 v[96:111], v[80:83], a[104:107], v[96:111]
    s_add_u32 m0, s31, 36864
    ds_read_b64_tr_b16 v[68:69], v11 offset:61440
    v_mfma_f32_32x32x16_bf16 v[128:143], v[80:83], a[108:111], v[128:143]
    buffer_load_dwordx4 v3, s[8:11], s26 offen offset:0 lds
    ds_read_b64_tr_b16 v[70:71], v11 offset:61952
    v_mfma_f32_32x32x16_bf16 v[112:127], v[84:87], a[104:107], v[112:127]
    buffer_load_dwordx4 v4, s[8:11], s26 offen offset:1024 lds
    ds_read_b64_tr_b16 v[72:73], v12 offset:53248
    v_mfma_f32_32x32x16_bf16 v[144:159], v[84:87], a[108:111], v[144:159]
    ds_read_b64_tr_b16 v[74:75], v12 offset:53760
    s_waitcnt lgkmcnt(6)
    v_mfma_f32_32x32x16_bf16 v[160:175], v[88:91], a[104:107], v[160:175]
    buffer_load_dwordx4 v5, s[8:11], s26 offen offset:2048 lds
    ds_read_b64_tr_b16 v[76:77], v12 offset:61440
    v_mfma_f32_32x32x16_bf16 v[192:207], v[88:91], a[108:111], v[192:207]
    buffer_load_dwordx4 v6, s[8:11], s26 offen offset:3072 lds
    ds_read_b64_tr_b16 v[78:79], v12 offset:61952
    v_mfma_f32_32x32x16_bf16 v[176:191], v[92:95], a[104:107], v[176:191]
    s_add_u32 s35, s35, 1
    s_cmp_eq_u32 s35, 9
    s_cselect_b32 s49, 1152, 0
    s_cselect_b32 s35, 0, s35
    s_add_u32 s25, s25, 128
    s_sub_u32 s25, s25, s49
    s_add_u32 s26, s25, 36864
    ds_read_b64_tr_b16 v[80:81], v11 offset:55296
    v_mfma_f32_32x32x16_bf16 v[208:223], v[92:95], a[108:111], v[208:223]
    ds_read_b64_tr_b16 v[82:83], v11 offset:55808
    s_waitcnt vmcnt(12)
    s_barrier
    s_waitcnt lgkmcnt(6)
    v_mfma_f32_32x32x16_bf16 v[96:111], v[64:67], a[112:115], v[96:111]
    ds_read_b128 a[128:131], v14 offset:0
    ds_read_b64_tr_b16 v[84:85], v11 offset:63488
    v_mfma_f32_32x32x16_bf16 v[128:143], v[64:67], a[116:119], v[128:143]
    ds_read_b128 a[132:135], v14 offset:4096
    ds_read_b64_tr_b16 v[86:87], v11 offset:64000
    v_mfma_f32_32x32x16_bf16 v[112:127], v[68:71], a[112:115], v[112:127]
    s_add_u32 m0, s30, 131072
    ds_read_b128 a[136:139], v15 offset:0
    ds_read_b64_tr_b16 v[88:89], v12 offset:55296
    v_mfma_f32_32x32x16_bf16 v[144:159], v[68:71], a[116:119], v[144:159]
    ds_read_b128 a[140:143], v15 offset:4096
    ds_read_b64_tr_b16 v[90:91], v12 offset:55808
    s_waitcnt lgkmcnt(10)
    v_mfma_f32_32x32x16_bf16 v[160:175], v[72:75], a[112:115], v[160:175]
    buffer_load_dwordx4 v1, s[12:15], s27 offen lds
    ds_read_b128 a[144:147], v16 offset:0
    ds_read_b64_tr_b16 v[92:93], v12 offset:63488
    v_mfma_f32_32x32x16_bf16 v[192:207], v[72:75], a[116:119], v[192:207]
    ds_read_b128 a[148:151], v16 offset:4096
    ds_read_b64_tr_b16 v[94:95], v12 offset:64000
    v_mfma_f32_32x32x16_bf16 v[176:191], v[76:79], a[112:115], v[176:191]
    buffer_load_dwordx4 v2, s[12:15], s27 offen offset:1024 lds
    ds_read_b128 a[152:155], v17 offset:0
    s_waitcnt lgkmcnt(14)
    ds_read_b64_tr_b16 v[64:65], v11 offset:0
    v_mfma_f32_32x32x16_bf16 v[208:223], v[76:79], a[116:119], v[208:223]
    s_waitcnt lgkmcnt(14)
    ds_read_b128 a[156:159], v17 offset:4096
    s_waitcnt lgkmcnt(14)
    ds_read_b64_tr_b16 v[66:67], v11 offset:512
    v_mfma_f32_32x32x16_bf16 v[96:111], v[80:83], a[120:123], v[96:111]
    s_add_u32 m0, s30, 139264
    s_waitcnt lgkmcnt(14)
    ds_read_b64_tr_b16 v[68:69], v11 offset:8192
    v_mfma_f32_32x32x16_bf16 v[128:143], v[80:83], a[124:127], v[128:143]
    s_waitcnt lgkmcnt(14)
    ds_read_b64_tr_b16 v[70:71], v11 offset:8704
    s_waitcnt lgkmcnt(12)
    v_mfma_f32_32x32x16_bf16 v[112:127], v[84:87], a[120:123], v[112:127]
    buffer_load_dwordx4 v1, s[16:19], s27 offen lds
    ds_read_b64_tr_b16 v[72:73], v12 offset:0
    v_mfma_f32_32x32x16_bf16 v[144:159], v[84:87], a[124:127], v[144:159]
    ds_read_b64_tr_b16 v[74:75], v12 offset:512
    s_waitcnt lgkmcnt(10)
    v_mfma_f32_32x32x16_bf16 v[160:175], v[88:91], a[120:123], v[160:175]
    buffer_load_dwordx4 v2, s[16:19], s27 offen offset:1024 lds
    ds_read_b64_tr_b16 v[76:77], v12 offset:8192
    v_mfma_f32_32x32x16_bf16 v[192:207], v[88:91], a[124:127], v[192:207]
    ds_read_b64_tr_b16 v[78:79], v12 offset:8704
    s_waitcnt lgkmcnt(8)
    v_mfma_f32_32x32x16_bf16 v[176:191], v[92:95], a[120:123], v[176:191]
    s_add_u32 s34, s34, 1
    s_cmp_eq_u32 s34, 9
    s_cselect_b32 s34, 0, s34
    s_mul_i32 s27, s34, 589824
    s_add_u32 s27, s27, s48
    ds_read_b64_tr_b16 v[80:81], v11 offset:2048
    v_mfma_f32_32x32x16_bf16 v[208:223], v[92:95], a[124:127], v[208:223]
    ds_read_b64_tr_b16 v[82:83], v11 offset:2560
    s_waitcnt lgkmcnt(6)
    v_mfma_f32_32x32x16_bf16 v[96:111], v[64:67], a[128:131], v[96:111]
    ds_read_b64_tr_b16 v[84:85], v11 offset:10240
    v_mfma_f32_32x32x16_bf16 v[128:143], v[64:67], a[132:135], v[128:143]
    ds_read_b64_tr_b16 v[86:87], v11 offset:10752
    v_mfma_f32_32x32x16_bf16 v[112:127], v[68:71], a[128:131], v[112:127]
    s_add_u32 m0, s31, 65536
    ds_read_b64_tr_b16 v[88:89], v12 offset:2048
    v_mfma_f32_32x32x16_bf16 v[144:159], v[68:71], a[132:135], v[144:159]
    buffer_load_dwordx4 v3, s[8:11], s25 offen offset:0 lds
    ds_read_b64_tr_b16 v[90:91], v12 offset:2560
    s_waitcnt lgkmcnt(6)
    v_mfma_f32_32x32x16_bf16 v[160:175], v[72:75], a[128:131], v[160:175]
    buffer_load_dwordx4 v4, s[8:11], s25 offen offset:1024 lds
    ds_read_b64_tr_b16 v[92:93], v12 offset:10240
    v_mfma_f32_32x32x16_bf16 v[192:207], v[72:75], a[132:135], v[192:207]
    buffer_load_dwordx4 v5, s[8:11], s25 offen offset:2048 lds
    ds_read_b64_tr_b16 v[94:95], v12 offset:10752
    v_mfma_f32_32x32x16_bf16 v[176:191], v[76:79], a[128:131], v[176:191]
    ds_read_b64_tr_b16 v[64:65], v11 offset:4096
    v_mfma_f32_32x32x16_bf16 v[208:223], v[76:79], a[132:135], v[208:223]
    buffer_load_dwordx4 v6, s[8:11], s25 offen offset:3072 lds
    ds_read_b64_tr_b16 v[66:67], v11 offset:4608
    s_waitcnt lgkmcnt(6)
    v_mfma_f32_32x32x16_bf16 v[96:111], v[80:83], a[136:139], v[96:111]
    s_add_u32 m0, s31, 69632
    ds_read_b64_tr_b16 v[68:69], v11 offset:12288
    v_mfma_f32_32x32x16_bf16 v[128:143], v[80:83], a[140:143], v[128:143]
    buffer_load_dwordx4 v3, s[8:11], s26 offen offset:0 lds
    ds_read_b64_tr_b16 v[70:71], v11 offset:12800
    v_mfma_f32_32x32x16_bf16 v[112:127], v[84:87], a[136:139], v[112:127]
    buffer_load_dwordx4 v4, s[8:11], s26 offen offset:1024 lds
    ds_read_b64_tr_b16 v[72:73], v12 offset:4096
    v_mfma_f32_32x32x16_bf16 v[144:159], v[84:87], a[140:143], v[144:159]
    ds_read_b64_tr_b16 v[74:75], v12 offset:4608
    s_waitcnt lgkmcnt(6)
    v_mfma_f32_32x32x16_bf16 v[160:175], v[88:91], a[136:139], v[160:175]
    buffer_load_dwordx4 v5, s[8:11], s26 offen offset:2048 lds
    ds_read_b64_tr_b16 v[76:77], v12 offset:12288
    v_mfma_f32_32x32x16_bf16 v[192:207], v[88:91], a[140:143], v[192:207]
    buffer_load_dwordx4 v6, s[8:11], s26 offen offset:3072 lds
    ds_read_b64_tr_b16 v[78:79], v12 offset:12800
    v_mfma_f32_32x32x16_bf16 v[176:191], v[92:95], a[136:139], v[176:191]
    s_add_u32 s35, s35, 1
    s_cmp_eq_u32 s35, 9
    s_cselect_b32 s49, 1152, 0
    s_cselect_b32 s35, 0, s35
    s_add_u32 s25, s25, 128
    s_sub_u32 s25, s25, s49
    s_add_u32 s26, s25, 36864
    ds_read_b64_tr_b16 v[80:81], v11 offset:6144
    v_mfma_f32_32x32x16_bf16 v[208:223], v[92:95], a[140:143], v[208:223]
    ds_read_b64_tr_b16 v[82:83], v11 offset:6656
    s_waitcnt vmcnt(12)
    s_barrier
    s_waitcnt lgkmcnt(6)
    v_mfma_f32_32x32x16_bf16 v[96:111], v[64:67], a[144:147], v[96:111]
    ds_read_b128 a[160:163], v18 offset:0
    ds_read_b64_tr_b16 v[84:85], v11 offset:14336
    v_mfma_f32_32x32x16_bf16 v[128:143], v[64:67], a[148:151], v[128:143]
    ds_read_b128 a[164:167], v18 offset:4096
    ds_read_b64_tr_b16 v[86:87], v11 offset:14848
    v_mfma_f32_32x32x16_bf16 v[112:127], v[68:71], a[144:147], v[112:127]
    s_add_u32 m0, s30, 147456
    ds_read_b128 a[168:171], v19 offset:0
    ds_read_b64_tr_b16 v[88:89], v12 offset:6144
    v_mfma_f32_32x32x16_bf16 v[144:159], v[68:71], a[148:151], v[144:159]
    ds_read_b128 a[172:175], v19 offset:4096
    ds_read_b64_tr_b16 v[90:91], v12 offset:6656
    s_waitcnt lgkmcnt(10)
    v_mfma_f32_32x32x16_bf16 v[160:175], v[72:75], a[144:147], v[160:175]
    buffer_load_dwordx4 v1, s[12:15], s27 offen lds
    ds_read_b128 a[176:179], v20 offset:0
    ds_read_b64_tr_b16 v[92:93], v12 offset:14336
    v_mfma_f32_32x32x16_bf16 v[192:207], v[72:75], a[148:151], v[192:207]
    ds_read_b128 a[180:183], v20 offset:4096
    ds_read_b64_tr_b16 v[94:95], v12 offset:14848
    v_mfma_f32_32x32x16_bf16 v[176:191], v[76:79], a[144:147], v[176:191]
    buffer_load_dwordx4 v2, s[12:15], s27 offen offset:1024 lds
    ds_read_b128 a[184:187], v21 offset:0
    s_waitcnt lgkmcnt(14)
    ds_read_b64_tr_b16 v[64:65], v11 offset:16384
    v_mfma_f32_32x32x16_bf16 v[208:223], v[76:79], a[148:151], v[208:223]
    s_waitcnt lgkmcnt(14)
    ds_read_b128 a[188:191], v21 offset:4096
    s_waitcnt lgkmcnt(14)
    ds_read_b64_tr_b16 v[66:67], v11 offset:16896
    v_mfma_f32_32x32x16_bf16 v[96:111], v[80:83], a[152:155], v[96:111]
    s_add_u32 m0, s30, 155648
    s_waitcnt lgkmcnt(14)
    ds_read_b64_tr_b16 v[68:69], v11 offset:24576
    v_mfma_f32_32x32x16_bf16 v[128:143], v[80:83], a[156:159], v[128:143]
    s_waitcnt lgkmcnt(14)
    ds_read_b64_tr_b16 v[70:71], v11 offset:25088
    s_waitcnt lgkmcnt(12)
    v_mfma_f32_32x32x16_bf16 v[112:127], v[84:87], a[152:155], v[112:127]
    buffer_load_dwordx4 v1, s[16:19], s27 offen lds
    ds_read_b64_tr_b16 v[72:73], v12 offset:16384
    v_mfma_f32_32x32x16_bf16 v[144:159], v[84:87], a[156:159], v[144:159]
    ds_read_b64_tr_b16 v[74:75], v12 offset:16896
    s_waitcnt lgkmcnt(10)
    v_mfma_f32_32x32x16_bf16 v[160:175], v[88:91], a[152:155], v[160:175]
    buffer_load_dwordx4 v2, s[16:19], s27 offen offset:1024 lds
    ds_read_b64_tr_b16 v[76:77], v12 offset:24576
    v_mfma_f32_32x32x16_bf16 v[192:207], v[88:91], a[156:159], v[192:207]
    ds_read_b64_tr_b16 v[78:79], v12 offset:25088
    s_waitcnt lgkmcnt(8)
    v_mfma_f32_32x32x16_bf16 v[176:191], v[92:95], a[152:155], v[176:191]
    s_add_u32 s34, s34, 1
    s_cmp_eq_u32 s34, 9
    s_cselect_b32 s34, 0, s34
    s_mul_i32 s27, s34, 589824
    s_add_u32 s27, s27, s48
    ds_read_b64_tr_b16 v[80:81], v11 offset:18432
    v_mfma_f32_32x32x16_bf16 v[208:223], v[92:95], a[156:159], v[208:223]
    ds_read_b64_tr_b16 v[82:83], v11 offset:18944
    s_waitcnt lgkmcnt(6)
    v_mfma_f32_32x32x16_bf16 v[96:111], v[64:67], a[160:163], v[96:111]
    ds_read_b64_tr_b16 v[84:85], v11 offset:26624
    v_mfma_f32_32x32x16_bf16 v[128:143], v[64:67], a[164:167], v[128:143]
    ds_read_b64_tr_b16 v[86:87], v11 offset:27136
    v_mfma_f32_32x32x16_bf16 v[112:127], v[68:71], a[160:163], v[112:127]
    s_add_u32 m0, s31, 32768
    ds_read_b64_tr_b16 v[88:89], v12 offset:18432
    v_mfma_f32_32x32x16_bf16 v[144:159], v[68:71], a[164:167], v[144:159]
    buffer_load_dwordx4 v3, s[8:11], s25 offen offset:0 lds
    ds_read_b64_tr_b16 v[90:91], v12 offset:18944
    s_waitcnt lgkmcnt(6)
    v_mfma_f32_32x32x16_bf16 v[160:175], v[72:75], a[160:163], v[160:175]
    buffer_load_dwordx4 v4, s[8:11], s25 offen offset:1024 lds
    ds_read_b64_tr_b16 v[92:93], v12 offset:26624
    v_mfma_f32_32x32x16_bf16 v[192:207], v[72:75], a[164:167], v[192:207]
    buffer_load_dwordx4 v5, s[8:11], s25 offen offset:2048 lds
    ds_read_b64_tr_b16 v[94:95], v12 offset:27136
    v_mfma_f32_32x32x16_bf16 v[176:191], v[76:79], a[160:163], v[176:191]
    ds_read_b64_tr_b16 v[64:65], v11 offset:20480
    v_mfma_f32_32x32x16_bf16 v[208:223], v[76:79], a[164:167], v[208:223]
    buffer_load_dwordx4 v6, s[8:11], s25 offen offset:3072 lds
    ds_read_b64_tr_b16 v[66:67], v11 offset:20992
    s_waitcnt lgkmcnt(6)
    v_mfma_f32_32x32x16_bf16 v[96:111], v[80:83], a[168:171], v[96:111]
    s_add_u32 m0, s31, 36864
    ds_read_b64_tr_b16 v[68:69], v11 offset:28672
    v_mfma_f32_32x32x16_bf16 v[128:143], v[80:83], a[172:175], v[128:143]
    buffer_load_dwordx4 v3, s[8:11], s26 offen offset:0 lds
    ds_read_b64_tr_b16 v[70:71], v11 offset:29184
    v_mfma_f32_32x32x16_bf16 v[112:127], v[84:87], a[168:171], v[112:127]
    buffer_load_dwordx4 v4, s[8:11], s26 offen offset:1024 lds
    ds_read_b64_tr_b16 v[72:73], v12 offset:20480
    v_mfma_f32_32x32x16_bf16 v[144:159], v[84:87], a[172:175], v[144:159]
    ds_read_b64_tr_b16 v[74:75], v12 offset:20992
    s_waitcnt lgkmcnt(6)
    v_mfma_f32_32x32x16_bf16 v[160:175], v[88:91], a[168:171], v[160:175]
    buffer_load_dwordx4 v5, s[8:11], s26 offen offset:2048 lds
    ds_read_b64_tr_b16 v[76:77], v12 offset:28672
    v_mfma_f32_32x32x16_bf16 v[192:207], v[88:91], a[172:175], v[192:207]
    buffer_load_dwordx4 v6, s[8:11], s26 offen offset:3072 lds
    ds_read_b64_tr_b16 v[78:79], v12 offset:29184
    v_mfma_f32_32x32x16_bf16 v[176:191], v[92:95], a[168:171], v[176:191]
    s_add_u32 s35, s35, 1
    s_cmp_eq_u32 s35, 9
    s_cselect_b32 s49, 1152, 0
    s_cselect_b32 s35, 0, s35
    s_add_u32 s25, s25, 128
    s_sub_u32 s25, s25, s49
    s_add_u32 s26, s25, 36864
    ds_read_b64_tr_b16 v[80:81], v11 offset:22528
    v_mfma_f32_32x32x16_bf16 v[208:223], v[92:95], a[172:175], v[208:223]
    ds_read_b64_tr_b16 v[82:83], v11 offset:23040
    s_waitcnt vmcnt(12)
    s_barrier
    s_waitcnt lgkmcnt(6)
    v_mfma_f32_32x32x16_bf16 v[96:111], v[64:67], a[176:179], v[96:111]
    ds_read_b128 a[192:195], v14 offset:0
    ds_read_b64_tr_b16 v[84:85], v11 offset:30720
    v_mfma_f32_32x32x16_bf16 v[128:143], v[64:67], a[180:183], v[128:143]
    ds_read_b128 a[196:199], v14 offset:4096
    ds_read_b64_tr_b16 v[86:87], v11 offset:31232
    v_mfma_f32_32x32x16_bf16 v[112:127], v[68:71], a[176:179], v[112:127]
    s_add_u32 m0, s30, 98304
    ds_read_b128 a[200:203], v15 offset:0
    ds_read_b64_tr_b16 v[88:89], v12 offset:22528
    v_mfma_f32_32x32x16_bf16 v[144:159], v[68:71], a[180:183], v[144:159]
    ds_read_b128 a[204:207], v15 offset:4096
    ds_read_b64_tr_b16 v[90:91], v12 offset:23040
    s_waitcnt lgkmcnt(10)
    v_mfma_f32_32x32x16_bf16 v[160:175], v[72:75], a[176:179], v[160:175]
    buffer_load_dwordx4 v1, s[12:15], s27 offen lds
    ds_read_b128 a[208:211], v16 offset:0
    ds_read_b64_tr_b16 v[92:93], v12 offset:30720
    v_mfma_f32_32x32x16_bf16 v[192:207], v[72:75], a[180:183], v[192:207]
    ds_read_b128 a[212:215], v16 offset:4096
    ds_read_b64_tr_b16 v[94:95], v12 offset:31232
    v_mfma_f32_32x32x16_bf16 v[176:191], v[76:79], a[176:179], v[176:191]
    buffer_load_dwordx4 v2, s[12:15], s27 offen offset:1024 lds
    ds_read_b128 a[216:219], v17 offset:0
    s_waitcnt lgkmcnt(14)
    ds_read_b64_tr_b16 v[64:65], v11 offset:32768
    v_mfma_f32_32x32x16_bf16 v[208:223], v[76:79], a[180:183], v[208:223]
    s_waitcnt lgkmcnt(14)
    ds_read_b128 a[220:223], v17 offset:4096
    s_waitcnt lgkmcnt(14)
    ds_read_b64_tr_b16 v[66:67], v11 offset:33280
    v_mfma_f32_32x32x16_bf16 v[96:111], v[80:83], a[184:187], v[96:111]
    s_add_u32 m0, s30, 106496
    s_waitcnt lgkmcnt(14)
    ds_read_b64_tr_b16 v[68:69], v11 offset:40960
    v_mfma_f32_32x32x16_bf16 v[128:143], v[80:83], a[188:191], v[128:143]
    s_waitcnt lgkmcnt(14)
    ds_read_b64_tr_b16 v[70:71], v11 offset:41472
    s_waitcnt lgkmcnt(12)
    v_mfma_f32_32x32x16_bf16 v[112:127], v[84:87], a[184:187], v[112:127]
    buffer_load_dwordx4 v1, s[16:19], s27 offen lds
    ds_read_b64_tr_b16 v[72:73], v12 offset:32768
    v_mfma_f32_32x32x16_bf16 v[144:159], v[84:87], a[188:191], v[144:159]
    ds_read_b64_tr_b16 v[74:75], v12 offset:33280
    s_waitcnt lgkmcnt(10)
    v_mfma_f32_32x32x16_bf16 v[160:175], v[88:91], a[184:187], v[160:175]
    buffer_load_dwordx4 v2, s[16:19], s27 offen offset:1024 lds
    ds_read_b64_tr_b16 v[76:77], v12 offset:40960
    v_mfma_f32_32x32x16_bf16 v[192:207], v[88:91], a[188:191], v[192:207]
    ds_read_b64_tr_b16 v[78:79], v12 offset:41472
    s_waitcnt lgkmcnt(8)
    v_mfma_f32_32x32x16_bf16 v[176:191], v[92:95], a[184:187], v[176:191]
    s_add_u32 s34, s34, 1
    s_cmp_eq_u32 s34, 9
    s_cselect_b32 s34, 0, s34
    s_add_u32 s48, s48, 128
    s_mul_i32 s27, s34, 589824
    s_add_u32 s27, s27, s48
    ds_read_b64_tr_b16 v[80:81], v11 offset:34816
    v_mfma_f32_32x32x16_bf16 v[208:223], v[92:95], a[188:191], v[208:223]
    ds_read_b64_tr_b16 v[82:83], v11 offset:35328
    s_waitcnt lgkmcnt(6)
    v_mfma_f32_32x32x16_bf16 v[96:111], v[64:67], a[192:195], v[96:111]
    ds_read_b64_tr_b16 v[84:85], v11 offset:43008
    v_mfma_f32_32x32x16_bf16 v[128:143], v[64:67], a[196:199], v[128:143]
    ds_read_b64_tr_b16 v[86:87], v11 offset:43520
    v_mfma_f32_32x32x16_bf16 v[112:127], v[68:71], a[192:195], v[112:127]
    s_add_u32 m0, s31, 65536
    ds_read_b64_tr_b16 v[88:89], v12 offset:34816
    v_mfma_f32_32x32x16_bf16 v[144:159], v[68:71], a[196:199], v[144:159]
    buffer_load_dwordx4 v3, s[8:11], s25 offen offset:0 lds
    ds_read_b64_tr_b16 v[90:91], v12 offset:35328
    s_waitcnt lgkmcnt(6)
    v_mfma_f32_32x32x16_bf16 v[160:175], v[72:75], a[192:195], v[160:175]
    buffer_load_dwordx4 v4, s[8:11], s25 offen offset:1024 lds
    ds_read_b64_tr_b16 v[92:93], v12 offset:43008
    v_mfma_f32_32x32x16_bf16 v[192:207], v[72:75], a[196:199], v[192:207]
    buffer_load_dwordx4 v5, s[8:11], s25 offen offset:2048 lds
    ds_read_b64_tr_b16 v[94:95], v12 offset:43520
    v_mfma_f32_32x32x16_bf16 v[176:191], v[76:79], a[192:195], v[176:191]
    ds_read_b64_tr_b16 v[64:65], v11 offset:36864
    v_mfma_f32_32x32x16_bf16 v[208:223], v[76:79], a[196:199], v[208:223]
    buffer_load_dwordx4 v6, s[8:11], s25 offen offset:3072 lds
    ds_read_b64_tr_b16 v[66:67], v11 offset:37376
    s_waitcnt lgkmcnt(6)
    v_mfma_f32_32x32x16_bf16 v[96:111], v[80:83], a[200:203], v[96:111]
    s_add_u32 m0, s31, 69632
    ds_read_b64_tr_b16 v[68:69], v11 offset:45056
    v_mfma_f32_32x32x16_bf16 v[128:143], v[80:83], a[204:207], v[128:143]
    buffer_load_dwordx4 v3, s[8:11], s26 offen offset:0 lds
    ds_read_b64_tr_b16 v[70:71], v11 offset:45568
    v_mfma_f32_32x32x16_bf16 v[112:127], v[84:87], a[200:203], v[112:127]
    buffer_load_dwordx4 v4, s[8:11], s26 offen offset:1024 lds
    ds_read_b64_tr_b16 v[72:73], v12 offset:36864
    v_mfma_f32_32x32x16_bf16 v[144:159], v[84:87], a[204:207], v[144:159]
    ds_read_b64_tr_b16 v[74:75], v12 offset:37376
    s_waitcnt lgkmcnt(6)
    v_mfma_f32_32x32x16_bf16 v[160:175], v[88:91], a[200:203], v[160:175]
    buffer_load_dwordx4 v5, s[8:11], s26 offen offset:2048 lds
    ds_read_b64_tr_b16 v[76:77], v12 offset:45056
    v_mfma_f32_32x32x16_bf16 v[192:207], v[88:91], a[204:207], v[192:207]
    buffer_load_dwordx4 v6, s[8:11], s26 offen offset:3072 lds
    ds_read_b64_tr_b16 v[78:79], v12 offset:45568
    v_mfma_f32_32x32x16_bf16 v[176:191], v[92:95], a[200:203], v[176:191]
    s_add_u32 s35, s35, 1
    s_cmp_eq_u32 s35, 9
    s_cselect_b32 s49, 1152, 0
    s_cselect_b32 s35, 0, s35
    s_add_u32 s25, s25, 128
    s_sub_u32 s25, s25, s49
    s_add_u32 s26, s25, 36864
    ds_read_b64_tr_b16 v[80:81], v11 offset:38912
    v_mfma_f32_32x32x16_bf16 v[208:223], v[92:95], a[204:207], v[208:223]
    ds_read_b64_tr_b16 v[82:83], v11 offset:39424
    s_waitcnt vmcnt(12)
    s_barrier
    s_waitcnt lgkmcnt(6)
    v_mfma_f32_32x32x16_bf16 v[96:111], v[64:67], a[208:211], v[96:111]
    ds_read_b128 a[224:227], v18 offset:0
    ds_read_b64_tr_b16 v[84:85], v11 offset:47104
    v_mfma_f32_32x32x16_bf16 v[128:143], v[64:67], a[212:215], v[128:143]
    s_add_u32 m0, s30, 0
    ds_read_b128 a[228:231], v18 offset:4096
    ds_read_b64_tr_b16 v[86:87], v11 offset:47616
    v_mfma_f32_32x32x16_bf16 v[112:127], v[68:71], a[208:211], v[112:127]
    buffer_load_dwordx4 v1, s[12:15], s27 offen lds
    ds_read_b128 a[232:235], v19 offset:0
    ds_read_b64_tr_b16 v[88:89], v12 offset:38912
    v_mfma_f32_32x32x16_bf16 v[144:159], v[68:71], a[212:215], v[144:159]
    buffer_load_dwordx4 v2, s[12:15], s27 offen offset:1024 lds
    ds_read_b128 a[236:239], v19 offset:4096
    ds_read_b64_tr_b16 v[90:91], v12 offset:39424
    s_waitcnt lgkmcnt(10)
    v_mfma_f32_32x32x16_bf16 v[160:175], v[72:75], a[208:211], v[160:175]
    s_add_u32 m0, s30, 8192
    ds_read_b128 a[240:243], v20 offset:0
    ds_read_b64_tr_b16 v[92:93], v12 offset:47104
    v_mfma_f32_32x32x16_bf16 v[192:207], v[72:75], a[212:215], v[192:207]
    buffer_load_dwordx4 v1, s[16:19], s27 offen lds
    ds_read_b128 a[244:247], v20 offset:4096
    ds_read_b64_tr_b16 v[94:95], v12 offset:47616
    v_mfma_f32_32x32x16_bf16 v[176:191], v[76:79], a[208:211], v[176:191]
    buffer_load_dwordx4 v2, s[16:19], s27 offen offset:1024 lds
    ds_read_b128 a[248:251], v21 offset:0
    s_waitcnt lgkmcnt(14)
    ds_read_b64_tr_b16 v[64:65], v11 offset:49152
    v_mfma_f32_32x32x16_bf16 v[208:223], v[76:79], a[212:215], v[208:223]
    s_add_u32 s34, s34, 1
    s_cmp_eq_u32 s34, 9
    s_cselect_b32 s34, 0, s34
    s_mul_i32 s27, s34, 589824
    s_add_u32 s27, s27, s48
    s_add_u32 m0, s30, 16384
    s_waitcnt lgkmcnt(14)
    ds_read_b128 a[252:255], v21 offset:4096
    s_waitcnt lgkmcnt(14)
    ds_read_b64_tr_b16 v[66:67], v11 offset:49664
    v_mfma_f32_32x32x16_bf16 v[96:111], v[80:83], a[216:219], v[96:111]
    s_waitcnt lgkmcnt(14)
    ds_read_b64_tr_b16 v[68:69], v11 offset:57344
    v_mfma_f32_32x32x16_bf16 v[128:143], v[80:83], a[220:223], v[128:143]
    buffer_load_dwordx4 v1, s[12:15], s27 offen lds
    s_waitcnt lgkmcnt(14)
    ds_read_b64_tr_b16 v[70:71], v11 offset:57856
    s_waitcnt lgkmcnt(12)
    v_mfma_f32_32x32x16_bf16 v[112:127], v[84:87], a[216:219], v[112:127]
    buffer_load_dwordx4 v2, s[12:15], s27 offen offset:1024 lds
    ds_read_b64_tr_b16 v[72:73], v12 offset:49152
    v_mfma_f32_32x32x16_bf16 v[144:159], v[84:87], a[220:223], v[144:159]
    s_add_u32 m0, s30, 24576
    ds_read_b64_tr_b16 v[74:75], v12 offset:49664
    s_waitcnt lgkmcnt(10)
    v_mfma_f32_32x32x16_bf16 v[160:175], v[88:91], a[216:219], v[160:175]
    buffer_load_dwordx4 v1, s[16:19], s27 offen lds
    ds_read_b64_tr_b16 v[76:77], v12 offset:57344
    v_mfma_f32_32x32x16_bf16 v[192:207], v[88:91], a[220:223], v[192:207]
    buffer_load_dwordx4 v2, s[16:19], s27 offen offset:1024 lds
    ds_read_b64_tr_b16 v[78:79], v12 offset:57856
    s_waitcnt lgkmcnt(8)
    v_mfma_f32_32x32x16_bf16 v[176:191], v[92:95], a[216:219], v[176:191]
    s_add_u32 s34, s34, 1
    s_cmp_eq_u32 s34, 9
    s_cselect_b32 s34, 0, s34
    s_mul_i32 s27, s34, 589824
    s_add_u32 s27, s27, s48
    ds_read_b64_tr_b16 v[80:81], v11 offset:51200
    v_mfma_f32_32x32x16_bf16 v[208:223], v[92:95], a[220:223], v[208:223]
    ds_read_b64_tr_b16 v[82:83], v11 offset:51712
    s_waitcnt lgkmcnt(6)
    v_mfma_f32_32x32x16_bf16 v[96:111], v[64:67], a[224:227], v[96:111]
    ds_read_b64_tr_b16 v[84:85], v11 offset:59392
    v_mfma_f32_32x32x16_bf16 v[128:143], v[64:67], a[228:231], v[128:143]
    ds_read_b64_tr_b16 v[86:87], v11 offset:59904
    v_mfma_f32_32x32x16_bf16 v[112:127], v[68:71], a[224:227], v[112:127]
    ds_read_b64_tr_b16 v[88:89], v12 offset:51200
    v_mfma_f32_32x32x16_bf16 v[144:159], v[68:71], a[228:231], v[144:159]
    ds_read_b64_tr_b16 v[90:91], v12 offset:51712
    s_waitcnt lgkmcnt(6)
    v_mfma_f32_32x32x16_bf16 v[160:175], v[72:75], a[224:227], v[160:175]
    ds_read_b64_tr_b16 v[92:93], v12 offset:59392
    v_mfma_f32_32x32x16_bf16 v[192:207], v[72:75], a[228:231], v[192:207]
    ds_read_b64_tr_b16 v[94:95], v12 offset:59904
    v_mfma_f32_32x32x16_bf16 v[176:191], v[76:79], a[224:227], v[176:191]
    ds_read_b64_tr_b16 v[64:65], v11 offset:53248
    v_mfma_f32_32x32x16_bf16 v[208:223], v[76:79], a[228:231], v[208:223]
    ds_read_b64_tr_b16 v[66:67], v11 offset:53760
    s_waitcnt lgkmcnt(6)
    v_mfma_f32_32x32x16_bf16 v[96:111], v[80:83], a[232:235], v[96:111]
    ds_read_b64_tr_b16 v[68:69], v11 offset:61440
    v_mfma_f32_32x32x16_bf16 v[128:143], v[80:83], a[236:239], v[128:143]
    ds_read_b64_tr_b16 v[70:71], v11 offset:61952
    v_mfma_f32_32x32x16_bf16 v[112:127], v[84:87], a[232:235], v[112:127]
    ds_read_b64_tr_b16 v[72:73], v12 offset:53248
    v_mfma_f32_32x32x16_bf16 v[144:159], v[84:87], a[236:239], v[144:159]
    ds_read_b64_tr_b16 v[74:75], v12 offset:53760
    s_waitcnt lgkmcnt(6)
    v_mfma_f32_32x32x16_bf16 v[160:175], v[88:91], a[232:235], v[160:175]
    ds_read_b64_tr_b16 v[76:77], v12 offset:61440
    v_mfma_f32_32x32x16_bf16 v[192:207], v[88:91], a[236:239], v[192:207]
    ds_read_b64_tr_b16 v[78:79], v12 offset:61952
    v_mfma_f32_32x32x16_bf16 v[176:191], v[92:95], a[232:235], v[176:191]
    ds_read_b64_tr_b16 v[80:81], v11 offset:55296
    v_mfma_f32_32x32x16_bf16 v[208:223], v[92:95], a[236:239], v[208:223]
    ds_read_b64_tr_b16 v[82:83], v11 offset:55808
    s_waitcnt vmcnt(8)
    s_barrier
    s_waitcnt lgkmcnt(6)
    v_mfma_f32_32x32x16_bf16 v[96:111], v[64:67], a[240:243], v[96:111]
    ds_read_b128 v[224:227], v14 offset:0
    ds_read_b64_tr_b16 v[84:85], v11 offset:63488
    v_mfma_f32_32x32x16_bf16 v[128:143], v[64:67], a[244:247], v[128:143]
    s_add_u32 m0, s30, 32768
    ds_read_b128 v[228:231], v14 offset:4096
    ds_read_b64_tr_b16 v[86:87], v11 offset:64000
    v_mfma_f32_32x32x16_bf16 v[112:127], v[68:71], a[240:243], v[112:127]
    buffer_load_dwordx4 v1, s[12:15], s27 offen lds
    ds_read_b128 v[232:235], v15 offset:0
    ds_read_b64_tr_b16 v[88:89], v12 offset:55296
    v_mfma_f32_32x32x16_bf16 v[144:159], v[68:71], a[244:247], v[144:159]
    buffer_load_dwordx4 v2, s[12:15], s27 offen offset:1024 lds
    ds_read_b128 v[236:239], v15 offset:4096
    ds_read_b64_tr_b16 v[90:91], v12 offset:55808
    s_waitcnt lgkmcnt(10)
    v_mfma_f32_32x32x16_bf16 v[160:175], v[72:75], a[240:243], v[160:175]
    s_add_u32 m0, s30, 40960
    ds_read_b128 v[240:243], v16 offset:0
    ds_read_b64_tr_b16 v[92:93], v12 offset:63488
    v_mfma_f32_32x32x16_bf16 v[192:207], v[72:75], a[244:247], v[192:207]
    buffer_load_dwordx4 v1, s[16:19], s27 offen lds
    ds_read_b128 v[244:247], v16 offset:4096
    ds_read_b64_tr_b16 v[94:95], v12 offset:64000
    v_mfma_f32_32x32x16_bf16 v[176:191], v[76:79], a[240:243], v[176:191]
    buffer_load_dwordx4 v2, s[16:19], s27 offen offset:1024 lds
    ds_read_b128 v[248:251], v17 offset:0
    s_waitcnt lgkmcnt(14)
    ds_read_b64_tr_b16 v[64:65], v11 offset:0
    v_mfma_f32_32x32x16_bf16 v[208:223], v[76:79], a[244:247], v[208:223]
    s_add_u32 s34, s34, 1
    s_cmp_eq_u32 s34, 9
    s_cselect_b32 s34, 0, s34
    s_mul_i32 s27, s34, 589824
    s_add_u32 s27, s27, s48
    s_add_u32 m0, s30, 49152
    s_waitcnt lgkmcnt(14)
    ds_read_b128 v[252:255], v17 offset:4096
    s_waitcnt lgkmcnt(14)
    ds_read_b64_tr_b16 v[66:67], v11 offset:512
    v_mfma_f32_32x32x16_bf16 v[96:111], v[80:83], a[248:251], v[96:111]
    s_waitcnt lgkmcnt(14)
    ds_read_b64_tr_b16 v[68:69], v11 offset:8192
    v_mfma_f32_32x32x16_bf16 v[128:143], v[80:83], a[252:255], v[128:143]
    buffer_load_dwordx4 v1, s[12:15], s27 offen lds
    s_waitcnt lgkmcnt(14)
    ds_read_b64_tr_b16 v[70:71], v11 offset:8704
    s_waitcnt lgkmcnt(12)
    v_mfma_f32_32x32x16_bf16 v[112:127], v[84:87], a[248:251], v[112:127]
    buffer_load_dwordx4 v2, s[12:15], s27 offen offset:1024 lds
    ds_read_b64_tr_b16 v[72:73], v12 offset:0
    v_mfma_f32_32x32x16_bf16 v[144:159], v[84:87], a[252:255], v[144:159]
    s_add_u32 m0, s30, 57344
    ds_read_b64_tr_b16 v[74:75], v12 offset:512
    s_waitcnt lgkmcnt(10)
    v_mfma_f32_32x32x16_bf16 v[160:175], v[88:91], a[248:251], v[160:175]
    buffer_load_dwordx4 v1, s[16:19], s27 offen lds
    ds_read_b64_tr_b16 v[76:77], v12 offset:8192
    v_mfma_f32_32x32x16_bf16 v[192:207], v[88:91], a[252:255], v[192:207]
    buffer_load_dwordx4 v2, s[16:19], s27 offen offset:1024 lds
    ds_read_b64_tr_b16 v[78:79], v12 offset:8704
    s_waitcnt lgkmcnt(8)
    v_mfma_f32_32x32x16_bf16 v[176:191], v[92:95], a[248:251], v[176:191]
    s_add_u32 s34, s34, 1
    s_cmp_eq_u32 s34, 9
    s_cselect_b32 s34, 0, s34
    s_mul_i32 s27, s34, 589824
    s_add_u32 s27, s27, s48
    ds_read_b64_tr_b16 v[80:81], v11 offset:2048
    v_mfma_f32_32x32x16_bf16 v[208:223], v[92:95], a[252:255], v[208:223]
    ds_read_b64_tr_b16 v[82:83], v11 offset:2560
    s_waitcnt lgkmcnt(6)
    v_mfma_f32_32x32x16_bf16 v[96:111], v[64:67], v[224:227], v[96:111]
    ds_read_b64_tr_b16 v[84:85], v11 offset:10240
    v_mfma_f32_32x32x16_bf16 v[128:143], v[64:67], v[228:231], v[128:143]
    ds_read_b64_tr_b16 v[86:87], v11 offset:10752
    v_mfma_f32_32x32x16_bf16 v[112:127], v[68:71], v[224:227], v[112:127]
    ds_read_b64_tr_b16 v[88:89], v12 offset:2048
    v_mfma_f32_32x32x16_bf16 v[144:159], v[68:71], v[228:231], v[144:159]
    ds_read_b64_tr_b16 v[90:91], v12 offset:2560
    s_waitcnt lgkmcnt(6)
    v_mfma_f32_32x32x16_bf16 v[160:175], v[72:75], v[224:227], v[160:175]
    ds_read_b64_tr_b16 v[92:93], v12 offset:10240
    v_mfma_f32_32x32x16_bf16 v[192:207], v[72:75], v[228:231], v[192:207]
    ds_read_b64_tr_b16 v[94:95], v12 offset:10752
    v_mfma_f32_32x32x16_bf16 v[176:191], v[76:79], v[224:227], v[176:191]
    ds_read_b64_tr_b16 v[64:65], v11 offset:4096
    v_mfma_f32_32x32x16_bf16 v[208:223], v[76:79], v[228:231], v[208:223]
    ds_read_b64_tr_b16 v[66:67], v11 offset:4608
    s_waitcnt lgkmcnt(6)
    v_mfma_f32_32x32x16_bf16 v[96:111], v[80:83], v[232:235], v[96:111]
    ds_read_b64_tr_b16 v[68:69], v11 offset:12288
    v_mfma_f32_32x32x16_bf16 v[128:143], v[80:83], v[236:239], v[128:143]
    ds_read_b64_tr_b16 v[70:71], v11 offset:12800
    v_mfma_f32_32x32x16_bf16 v[112:127], v[84:87], v[232:235], v[112:127]
    ds_read_b64_tr_b16 v[72:73], v12 offset:4096
    v_mfma_f32_32x32x16_bf16 v[144:159], v[84:87], v[236:239], v[144:159]
    ds_read_b64_tr_b16 v[74:75], v12 offset:4608
    s_waitcnt lgkmcnt(6)
    v_mfma_f32_32x32x16_bf16 v[160:175], v[88:91], v[232:235], v[160:175]
    ds_read_b64_tr_b16 v[76:77], v12 offset:12288
    v_mfma_f32_32x32x16_bf16 v[192:207], v[88:91], v[236:239], v[192:207]
    ds_read_b64_tr_b16 v[78:79], v12 offset:12800
    v_mfma_f32_32x32x16_bf16 v[176:191], v[92:95], v[232:235], v[176:191]
    ds_read_b64_tr_b16 v[80:81], v11 offset:6144
    v_mfma_f32_32x32x16_bf16 v[208:223], v[92:95], v[236:239], v[208:223]
    ds_read_b64_tr_b16 v[82:83], v11 offset:6656
    s_barrier
    s_waitcnt lgkmcnt(6)
    v_mfma_f32_32x32x16_bf16 v[96:111], v[64:67], v[240:243], v[96:111]
    ds_read_b64_tr_b16 v[84:85], v11 offset:14336
    v_mfma_f32_32x32x16_bf16 v[128:143], v[64:67], v[244:247], v[128:143]
    s_add_u32 m0, s30, 65536
    ds_read_b64_tr_b16 v[86:87], v11 offset:14848
    v_mfma_f32_32x32x16_bf16 v[112:127], v[68:71], v[240:243], v[112:127]
    buffer_load_dwordx4 v1, s[12:15], s27 offen lds
    ds_read_b64_tr_b16 v[88:89], v12 offset:6144
    v_mfma_f32_32x32x16_bf16 v[144:159], v[68:71], v[244:247], v[144:159]
    buffer_load_dwordx4 v2, s[12:15], s27 offen offset:1024 lds
    ds_read_b64_tr_b16 v[90:91], v12 offset:6656
    s_waitcnt lgkmcnt(6)
    v_mfma_f32_32x32x16_bf16 v[160:175], v[72:75], v[240:243], v[160:175]
    s_add_u32 m0, s30, 73728
    ds_read_b64_tr_b16 v[92:93], v12 offset:14336
    v_mfma_f32_32x32x16_bf16 v[192:207], v[72:75], v[244:247], v[192:207]
    buffer_load_dwordx4 v1, s[16:19], s27 offen lds
    ds_read_b64_tr_b16 v[94:95], v12 offset:14848
    v_mfma_f32_32x32x16_bf16 v[176:191], v[76:79], v[240:243], v[176:191]
    buffer_load_dwordx4 v2, s[16:19], s27 offen offset:1024 lds
    v_mfma_f32_32x32x16_bf16 v[208:223], v[76:79], v[244:247], v[208:223]
    s_add_u32 s34, s34, 1
    s_cmp_eq_u32 s34, 9
    s_cselect_b32 s34, 0, s34
    s_mul_i32 s27, s34, 589824
    s_add_u32 s27, s27, s48
    s_add_u32 m0, s30, 81920
    s_waitcnt lgkmcnt(4)
    v_mfma_f32_32x32x16_bf16 v[96:111], v[80:83], v[248:251], v[96:111]
    v_mfma_f32_32x32x16_bf16 v[128:143], v[80:83], v[252:255], v[128:143]
    buffer_load_dwordx4 v1, s[12:15], s27 offen lds
    v_mfma_f32_32x32x16_bf16 v[112:127], v[84:87], v[248:251], v[112:127]
    buffer_load_dwordx4 v2, s[12:15], s27 offen offset:1024 lds
    v_mfma_f32_32x32x16_bf16 v[144:159], v[84:87], v[252:255], v[144:159]
    s_add_u32 m0, s30, 90112
    s_waitcnt lgkmcnt(0)
    v_mfma_f32_32x32x16_bf16 v[160:175], v[88:91], v[248:251], v[160:175]
    buffer_load_dwordx4 v1, s[16:19], s27 offen lds
    v_mfma_f32_32x32x16_bf16 v[192:207], v[88:91], v[252:255], v[192:207]
    buffer_load_dwordx4 v2, s[16:19], s27 offen offset:1024 lds
    v_mfma_f32_32x32x16_bf16 v[176:191], v[92:95], v[248:251], v[176:191]
    s_add_u32 s34, s34, 1
    s_cmp_eq_u32 s34, 9
    s_cselect_b32 s34, 0, s34
    s_mul_i32 s27, s34, 589824
    s_add_u32 s27, s27, s48
    v_mfma_f32_32x32x16_bf16 v[208:223], v[92:95], v[252:255], v[208:223]
    v_mov_b32 v50, 0xbdd2d3e8
    v_mov_b32 v51, 0xbdd2d3e8
    v_mov_b32 v52, 0xc0135761
    v_mov_b32 v53, 0xc0135761
    v_mov_b32 v54, 1.0
    v_mov_b32 v55, 1.0
    s_nop 7
    v_pk_mul_f32 v[32:33], v[96:97], v[96:97]
    v_pk_mul_f32 v[36:37], v[98:99], v[98:99]
    v_pk_mul_f32 v[40:41], v[100:101], v[100:101]
    v_pk_mul_f32 v[44:45], v[102:103], v[102:103]
    v_pk_fma_f32 v[32:33], v[32:33], v[50:51], v[52:53]
    v_pk_fma_f32 v[36:37], v[36:37], v[50:51], v[52:53]
    v_pk_fma_f32 v[40:41], v[40:41], v[50:51], v[52:53]
    v_pk_fma_f32 v[44:45], v[44:45], v[50:51], v[52:53]
    v_pk_mul_f32 v[32:33], v[32:33], v[96:97]
    v_pk_mul_f32 v[36:37], v[36:37], v[98:99]
    v_pk_mul_f32 v[40:41], v[40:41], v[100:101]
    v_pk_mul_f32 v[44:45], v[44:45], v[102:103]
    v_exp_f32 v32, v32
    v_exp_f32 v36, v36
    v_exp_f32 v40, v40
    v_exp_f32 v44, v44
    v_exp_f32 v33, v33
    v_exp_f32 v37, v37
    v_exp_f32 v41, v41
    v_exp_f32 v45, v45
    v_pk_mul_f32 v[34:35], v[96:97], v[112:113]
    v_pk_mul_f32 v[38:39], v[98:99], v[114:115]
    v_pk_mul_f32 v[42:43], v[100:101], v[116:117]
    v_pk_mul_f32 v[46:47], v[102:103], v[118:119]
    v_pk_add_f32 v[32:33], v[32:33], v[54:55]
    v_pk_add_f32 v[36:37], v[36:37], v[54:55]
    v_pk_add_f32 v[40:41], v[40:41], v[54:55]
    v_pk_add_f32 v[44:45], v[44:45], v[54:55]
    v_rcp_f32 v32, v32
    v_rcp_f32 v36, v36
    v_rcp_f32 v40, v40
    v_rcp_f32 v44, v44
    v_rcp_f32 v33, v33
    v_rcp_f32 v37, v37
    v_rcp_f32 v41, v41
    v_rcp_f32 v45, v45
    v_pk_mul_f32 v[34:35], v[34:35], v[32:33]
    v_pk_mul_f32 v[38:39], v[38:39], v[36:37]
    v_pk_mul_f32 v[42:43], v[42:43], v[40:41]
    v_pk_mul_f32 v[46:47], v[46:47], v[44:45]
    v_cvt_pk_bf16_f32 v24, v34, v35
    v_cvt_pk_bf16_f32 v25, v38, v39
    v_cvt_pk_bf16_f32 v26, v42, v43
    v_cvt_pk_bf16_f32 v27, v46, v47
    buffer_store_dwordx4 v[24:27], v22, s[20:23], s28 offen offset:0 sc1
    v_pk_mul_f32 v[32:33], v[104:105], v[104:105]
    v_pk_mul_f32 v[36:37], v[106:107], v[106:107]
    v_pk_mul_f32 v[40:41], v[108:109], v[108:109]
    v_pk_mul_f32 v[44:45], v[110:111], v[110:111]
    v_pk_fma_f32 v[32:33], v[32:33], v[50:51], v[52:53]
    v_pk_fma_f32 v[36:37], v[36:37], v[50:51], v[52:53]
    v_pk_fma_f32 v[40:41], v[40:41], v[50:51], v[52:53]
    v_pk_fma_f32 v[44:45], v[44:45], v[50:51], v[52:53]
    v_pk_mul_f32 v[32:33], v[32:33], v[104:105]
    v_pk_mul_f32 v[36:37], v[36:37], v[106:107]
    v_pk_mul_f32 v[40:41], v[40:41], v[108:109]
    v_pk_mul_f32 v[44:45], v[44:45], v[110:111]
    v_exp_f32 v32, v32
    v_exp_f32 v36, v36
    v_exp_f32 v40, v40
    v_exp_f32 v44, v44
    v_exp_f32 v33, v33
    v_exp_f32 v37, v37
    v_exp_f32 v41, v41
    v_exp_f32 v45, v45
    v_pk_mul_f32 v[34:35], v[104:105], v[120:121]
    v_pk_mul_f32 v[38:39], v[106:107], v[122:123]
    v_pk_mul_f32 v[42:43], v[108:109], v[124:125]
    v_pk_mul_f32 v[46:47], v[110:111], v[126:127]
    v_pk_add_f32 v[32:33], v[32:33], v[54:55]
    v_pk_add_f32 v[36:37], v[36:37], v[54:55]
    v_pk_add_f32 v[40:41], v[40:41], v[54:55]
    v_pk_add_f32 v[44:45], v[44:45], v[54:55]
    v_rcp_f32 v32, v32
    v_rcp_f32 v36, v36
    v_rcp_f32 v40, v40
    v_rcp_f32 v44, v44
    v_rcp_f32 v33, v33
    v_rcp_f32 v37, v37
    v_rcp_f32 v41, v41
    v_rcp_f32 v45, v45
    v_pk_mul_f32 v[34:35], v[34:35], v[32:33]
    v_pk_mul_f32 v[38:39], v[38:39], v[36:37]
    v_pk_mul_f32 v[42:43], v[42:43], v[40:41]
    v_pk_mul_f32 v[46:47], v[46:47], v[44:45]
    v_cvt_pk_bf16_f32 v28, v34, v35
    v_cvt_pk_bf16_f32 v29, v38, v39
    v_cvt_pk_bf16_f32 v30, v42, v43
    v_cvt_pk_bf16_f32 v31, v46, v47
    buffer_store_dwordx4 v[28:31], v22, s[20:23], s28 offen offset:1024 sc1
    s_add_u32 s28, s28, 331776
    v_pk_mul_f32 v[32:33], v[128:129], v[128:129]
    v_pk_mul_f32 v[36:37], v[130:131], v[130:131]
    v_pk_mul_f32 v[40:41], v[132:133], v[132:133]
    v_pk_mul_f32 v[44:45], v[134:135], v[134:135]
    v_pk_fma_f32 v[32:33], v[32:33], v[50:51], v[52:53]
    v_pk_fma_f32 v[36:37], v[36:37], v[50:51], v[52:53]
    v_pk_fma_f32 v[40:41], v[40:41], v[50:51], v[52:53]
    v_pk_fma_f32 v[44:45], v[44:45], v[50:51], v[52:53]
    v_pk_mul_f32 v[32:33], v[32:33], v[128:129]
    v_pk_mul_f32 v[36:37], v[36:37], v[130:131]
    v_pk_mul_f32 v[40:41], v[40:41], v[132:133]
    v_pk_mul_f32 v[44:45], v[44:45], v[134:135]
    v_exp_f32 v32, v32
    v_exp_f32 v36, v36
    v_exp_f32 v40, v40
    v_exp_f32 v44, v44
    v_exp_f32 v33, v33
    v_exp_f32 v37, v37
    v_exp_f32 v41, v41
    v_exp_f32 v45, v45
    v_pk_mul_f32 v[34:35], v[128:129], v[144:145]
    v_pk_mul_f32 v[38:39], v[130:131], v[146:147]
    v_pk_mul_f32 v[42:43], v[132:133], v[148:149]
    v_pk_mul_f32 v[46:47], v[134:135], v[150:151]
    v_pk_add_f32 v[32:33], v[32:33], v[54:55]
    v_pk_add_f32 v[36:37], v[36:37], v[54:55]
    v_pk_add_f32 v[40:41], v[40:41], v[54:55]
    v_pk_add_f32 v[44:45], v[44:45], v[54:55]
    v_rcp_f32 v32, v32
    v_rcp_f32 v36, v36
    v_rcp_f32 v40, v40
    v_rcp_f32 v44, v44
    v_rcp_f32 v33, v33
    v_rcp_f32 v37, v37
    v_rcp_f32 v41, v41
    v_rcp_f32 v45, v45
    v_pk_mul_f32 v[34:35], v[34:35], v[32:33]
    v_pk_mul_f32 v[38:39], v[38:39], v[36:37]
    v_pk_mul_f32 v[42:43], v[42:43], v[40:41]
    v_pk_mul_f32 v[46:47], v[46:47], v[44:45]
    v_cvt_pk_bf16_f32 v24, v34, v35
    v_cvt_pk_bf16_f32 v25, v38, v39
    v_cvt_pk_bf16_f32 v26, v42, v43
    v_cvt_pk_bf16_f32 v27, v46, v47
    buffer_store_dwordx4 v[24:27], v22, s[20:23], s28 offen offset:0 sc1
    v_pk_mul_f32 v[32:33], v[136:137], v[136:137]
    v_pk_mul_f32 v[36:37], v[138:139], v[138:139]
    v_pk_mul_f32 v[40:41], v[140:141], v[140:141]
    v_pk_mul_f32 v[44:45], v[142:143], v[142:143]
    v_pk_fma_f32 v[32:33], v[32:33], v[50:51], v[52:53]
    v_pk_fma_f32 v[36:37], v[36:37], v[50:51], v[52:53]
    v_pk_fma_f32 v[40:41], v[40:41], v[50:51], v[52:53]
    v_pk_fma_f32 v[44:45], v[44:45], v[50:51], v[52:53]
    v_pk_mul_f32 v[32:33], v[32:33], v[136:137]
    v_pk_mul_f32 v[36:37], v[36:37], v[138:139]
    v_pk_mul_f32 v[40:41], v[40:41], v[140:141]
    v_pk_mul_f32 v[44:45], v[44:45], v[142:143]
    v_exp_f32 v32, v32
    v_exp_f32 v36, v36
    v_exp_f32 v40, v40
    v_exp_f32 v44, v44
    v_exp_f32 v33, v33
    v_exp_f32 v37, v37
    v_exp_f32 v41, v41
    v_exp_f32 v45, v45
    v_pk_mul_f32 v[34:35], v[136:137], v[152:153]
    v_pk_mul_f32 v[38:39], v[138:139], v[154:155]
    v_pk_mul_f32 v[42:43], v[140:141], v[156:157]
    v_pk_mul_f32 v[46:47], v[142:143], v[158:159]
    v_pk_add_f32 v[32:33], v[32:33], v[54:55]
    v_pk_add_f32 v[36:37], v[36:37], v[54:55]
    v_pk_add_f32 v[40:41], v[40:41], v[54:55]
    v_pk_add_f32 v[44:45], v[44:45], v[54:55]
    v_rcp_f32 v32, v32
    v_rcp_f32 v36, v36
    v_rcp_f32 v40, v40
    v_rcp_f32 v44, v44
    v_rcp_f32 v33, v33
    v_rcp_f32 v37, v37
    v_rcp_f32 v41, v41
    v_rcp_f32 v45, v45
    v_pk_mul_f32 v[34:35], v[34:35], v[32:33]
    v_pk_mul_f32 v[38:39], v[38:39], v[36:37]
    v_pk_mul_f32 v[42:43], v[42:43], v[40:41]
    v_pk_mul_f32 v[46:47], v[46:47], v[44:45]
    v_cvt_pk_bf16_f32 v28, v34, v35
    v_cvt_pk_bf16_f32 v29, v38, v39
    v_cvt_pk_bf16_f32 v30, v42, v43
    v_cvt_pk_bf16_f32 v31, v46, v47
    buffer_store_dwordx4 v[28:31], v22, s[20:23], s28 offen offset:1024 sc1
    s_sub_u32 s28, s28, 329728
    v_add_u32 v11, 0, v7
    v_add_u32 v12, 65536, v7
    v_add_u32 v13, 131072, v7
    s_waitcnt vmcnt(16)
    s_barrier
    ds_read_b64_tr_b16 v[64:65], v11 offset:0
    ds_read_b64_tr_b16 v[66:67], v11 offset:512
    ds_read_b64_tr_b16 v[68:69], v11 offset:8192
    ds_read_b64_tr_b16 v[70:71], v11 offset:8704
    ds_read_b64_tr_b16 v[72:73], v11 offset:2048
    ds_read_b64_tr_b16 v[74:75], v11 offset:2560
    ds_read_b64_tr_b16 v[76:77], v11 offset:10240
    ds_read_b64_tr_b16 v[78:79], v11 offset:10752
    ds_read_b64_tr_b16 v[80:81], v11 offset:4096
    ds_read_b64_tr_b16 v[82:83], v11 offset:4608
    s_lshr_b32 s91, s4, 1
    s_mov_b32 s90, 0
    s_and_b32 s38, s4, 1
    s_mul_i32 s38, s38, 24
    s_add_u32 s92, s38, s6
    s_mov_b32 s93, s24
    s_mul_i32 s38, s36, 43
    s_lshr_b32 s38, s38, 8
    s_lshl_b32 s39, s37, 2
    s_add_u32 s94, s38, s39
    s_add_u32 s94, s94, 8
    s_mul_i32 s38, s92, 171
    s_lshr_b32 s38, s38, 10
    s_lshl_b32 s38, s38, 2
    s_add_u32 s96, s38, s91
    s_add_u32 s95, s96, 8
    s_add_u32 s96, s96, 48
    s_mov_b32 s97, 6
    s_lshl_b32 s38, s96, 7
    v_mov_b32 v48, s38
    s_add_u32 s64, s70, 22806528
    s_addc_u32 s65, s71, 0
    v_mov_b32 v61, 0
    global_load_dword v60, v61, s[68:69] sc1
    s_mov_b32 s29, 0
L_gx_loop:
    s_waitcnt lgkmcnt(6)
    v_mfma_f32_32x32x16_bf16 v[96:111], v[64:67], a[0:3], 0
    buffer_load_dwordx4 v[56:59], v22, s[56:59], s32 offen
    s_add_u32 s32, s32, 1024
    ds_read_b64_tr_b16 v[84:85], v11 offset:12288
    v_mfma_f32_32x32x16_bf16 v[128:143], v[64:67], a[4:7], 0
    buffer_load_dwordx4 v[56:59], v22, s[56:59], s32 offen
    s_add_u32 s32, s32, 1024
    ds_read_b64_tr_b16 v[86:87], v11 offset:12800
    v_mfma_f32_32x32x16_bf16 v[112:127], v[68:71], a[0:3], 0
    v_mul_f32 v32, v160, v160
    v_mul_f32 v33, v161, v161
    s_add_u32 m0, s30, 98304
    ds_read_b64_tr_b16 v[88:89], v11 offset:6144
    v_mfma_f32_32x32x16_bf16 v[144:159], v[68:71], a[4:7], 0
    v_mul_f32 v34, v162, v162
    v_mul_f32 v35, v163, v163
    v_fmaak_f32 v32, v23, v32, 0xc0135761
    ds_read_b64_tr_b16 v[90:91], v11 offset:6656
    s_waitcnt lgkmcnt(6)
    v_mfma_f32_32x32x16_bf16 v[96:111], v[72:75], a[8:11], v[96:111]
    v_fmaak_f32 v33, v23, v33, 0xc0135761
    v_fmaak_f32 v34, v23, v34, 0xc0135761
    buffer_load_dwordx4 v1, s[12:15], s27 offen lds
    ds_read_b64_tr_b16 v[92:93], v11 offset:14336
    v_mfma_f32_32x32x16_bf16 v[128:143], v[72:75], a[12:15], v[128:143]
    v_fmaak_f32 v35, v23, v35, 0xc0135761
    v_mul_f32 v32, v32, v160
    v_mul_f32 v33, v33, v161
    ds_read_b64_tr_b16 v[94:95], v11 offset:14848
    v_mfma_f32_32x32x16_bf16 v[112:127], v[76:79], a[8:11], v[112:127]
    v_mul_f32 v34, v34, v162
    v_mul_f32 v35, v35, v163
    buffer_load_dwordx4 v2, s[12:15], s27 offen offset:1024 lds
    ds_read_b64_tr_b16 v[64:65], v11 offset:16384
    v_mfma_f32_32x32x16_bf16 v[144:159], v[76:79], a[12:15], v[144:159]
    v_exp_f32 v32, v32
    ds_read_b64_tr_b16 v[66:67], v11 offset:16896
    s_waitcnt lgkmcnt(6)
    v_mfma_f32_32x32x16_bf16 v[96:111], v[80:83], a[16:19], v[96:111]
    v_exp_f32 v33, v33
    s_add_u32 m0, s30, 106496
    ds_read_b64_tr_b16 v[68:69], v11 offset:24576
    v_mfma_f32_32x32x16_bf16 v[128:143], v[80:83], a[20:23], v[128:143]
    v_exp_f32 v34, v34
    ds_read_b64_tr_b16 v[70:71], v11 offset:25088
    v_mfma_f32_32x32x16_bf16 v[112:127], v[84:87], a[16:19], v[112:127]
    v_exp_f32 v35, v35
    buffer_load_dwordx4 v1, s[16:19], s27 offen lds
    ds_read_b64_tr_b16 v[72:73], v11 offset:18432
    v_mfma_f32_32x32x16_bf16 v[144:159], v[84:87], a[20:23], v[144:159]
    v_mul_f32 v40, v160, v176
    v_mul_f32 v41, v161, v177
    v_mul_f32 v42, v162, v178
    ds_read_b64_tr_b16 v[74:75], v11 offset:18944
    s_waitcnt lgkmcnt(6)
    v_mfma_f32_32x32x16_bf16 v[96:111], v[88:91], a[24:27], v[96:111]
    v_mul_f32 v43, v163, v179
    v_add_f32 v32, 1.0, v32
    buffer_load_dwordx4 v2, s[16:19], s27 offen offset:1024 lds
    ds_read_b64_tr_b16 v[76:77], v11 offset:26624
    v_mfma_f32_32x32x16_bf16 v[128:143], v[88:91], a[28:31], v[128:143]
    v_add_f32 v33, 1.0, v33
    v_add_f32 v34, 1.0, v34
    v_add_f32 v35, 1.0, v35
    ds_read_b64_tr_b16 v[78:79], v11 offset:27136
    v_mfma_f32_32x32x16_bf16 v[112:127], v[92:95], a[24:27], v[112:127]
    s_add_u32 s34, s34, 1
    s_cmp_eq_u32 s34, 9
    s_cselect_b32 s34, 0, s34
    s_mul_i32 s27, s34, 589824
    s_add_u32 s27, s27, s48
    s_add_u32 m0, s30, 114688
    ds_read_b64_tr_b16 v[80:81], v11 offset:20480
    v_mfma_f32_32x32x16_bf16 v[144:159], v[92:95], a[28:31], v[144:159]
    v_rcp_f32 v32, v32
    ds_read_b64_tr_b16 v[82:83], v11 offset:20992
    s_waitcnt lgkmcnt(6)
    v_mfma_f32_32x32x16_bf16 v[96:111], v[64:67], a[32:35], v[96:111]
    v_rcp_f32 v33, v33
    ds_read_b64_tr_b16 v[84:85], v11 offset:28672
    v_mfma_f32_32x32x16_bf16 v[128:143], v[64:67], a[36:39], v[128:143]
    v_rcp_f32 v34, v34
    buffer_load_dwordx4 v1, s[12:15], s27 offen lds
    ds_read_b64_tr_b16 v[86:87], v11 offset:29184
    v_mfma_f32_32x32x16_bf16 v[112:127], v[68:71], a[32:35], v[112:127]
    v_rcp_f32 v35, v35
    v_mul_f32 v40, v40, v32
    ds_read_b64_tr_b16 v[88:89], v11 offset:22528
    v_mfma_f32_32x32x16_bf16 v[144:159], v[68:71], a[36:39], v[144:159]
    v_mul_f32 v41, v41, v33
    v_mul_f32 v42, v42, v34
    buffer_load_dwordx4 v2, s[12:15], s27 offen offset:1024 lds
    ds_read_b64_tr_b16 v[90:91], v11 offset:23040
    s_waitcnt lgkmcnt(6)
    v_mfma_f32_32x32x16_bf16 v[96:111], v[72:75], a[40:43], v[96:111]
    v_mul_f32 v43, v43, v35
    v_cvt_pk_bf16_f32 v24, v40, v41
    v_cvt_pk_bf16_f32 v25, v42, v43
    ds_read_b64_tr_b16 v[92:93], v11 offset:30720
    v_mfma_f32_32x32x16_bf16 v[128:143], v[72:75], a[44:47], v[128:143]
    v_mul_f32 v36, v164, v164
    v_mul_f32 v37, v165, v165
    s_add_u32 m0, s30, 122880
    ds_read_b64_tr_b16 v[94:95], v11 offset:31232
    v_mfma_f32_32x32x16_bf16 v[112:127], v[76:79], a[40:43], v[112:127]
    v_mul_f32 v38, v166, v166
    v_mul_f32 v39, v167, v167
    v_fmaak_f32 v36, v23, v36, 0xc0135761
    ds_read_b64_tr_b16 v[64:65], v11 offset:32768
    v_mfma_f32_32x32x16_bf16 v[144:159], v[76:79], a[44:47], v[144:159]
    v_fmaak_f32 v37, v23, v37, 0xc0135761
    v_fmaak_f32 v38, v23, v38, 0xc0135761
    buffer_load_dwordx4 v1, s[16:19], s27 offen lds
    ds_read_b64_tr_b16 v[66:67], v11 offset:33280
    s_waitcnt lgkmcnt(6)
    v_mfma_f32_32x32x16_bf16 v[96:111], v[80:83], a[48:51], v[96:111]
    v_fmaak_f32 v39, v23, v39, 0xc0135761
    v_mul_f32 v36, v36, v164
    v_mul_f32 v37, v37, v165
    ds_read_b64_tr_b16 v[68:69], v11 offset:40960
    v_mfma_f32_32x32x16_bf16 v[128:143], v[80:83], a[52:55], v[128:143]
    v_mul_f32 v38, v38, v166
    v_mul_f32 v39, v39, v167
    buffer_load_dwordx4 v2, s[16:19], s27 offen offset:1024 lds
    ds_read_b64_tr_b16 v[70:71], v11 offset:41472
    v_mfma_f32_32x32x16_bf16 v[112:127], v[84:87], a[48:51], v[112:127]
    v_exp_f32 v36, v36
    ds_read_b64_tr_b16 v[72:73], v11 offset:34816
    v_mfma_f32_32x32x16_bf16 v[144:159], v[84:87], a[52:55], v[144:159]
    s_add_u32 s34, s34, 1
    s_cmp_eq_u32 s34, 9
    s_cselect_b32 s34, 0, s34
    s_mul_i32 s27, s34, 589824
    s_add_u32 s27, s27, s48
    s_add_u32 m0, s30, 131072
    ds_read_b64_tr_b16 v[74:75], v11 offset:35328
    s_waitcnt lgkmcnt(6)
    v_mfma_f32_32x32x16_bf16 v[96:111], v[88:91], a[56:59], v[96:111]
    v_exp_f32 v37, v37
    ds_read_b64_tr_b16 v[76:77], v11 offset:43008
    v_mfma_f32_32x32x16_bf16 v[128:143], v[88:91], a[60:63], v[128:143]
    v_exp_f32 v38, v38
    ds_read_b64_tr_b16 v[78:79], v11 offset:43520
    v_mfma_f32_32x32x16_bf16 v[112:127], v[92:95], a[56:59], v[112:127]
    v_exp_f32 v39, v39
    buffer_load_dwordx4 v1, s[12:15], s27 offen lds
    ds_read_b64_tr_b16 v[80:81], v11 offset:36864
    v_mfma_f32_32x32x16_bf16 v[144:159], v[92:95], a[60:63], v[144:159]
    v_mul_f32 v44, v164, v180
    v_mul_f32 v45, v165, v181
    v_mul_f32 v46, v166, v182
    ds_read_b64_tr_b16 v[82:83], v11 offset:37376
    s_waitcnt lgkmcnt(6)
    v_mfma_f32_32x32x16_bf16 v[96:111], v[64:67], a[64:67], v[96:111]
    v_mul_f32 v47, v167, v183
    v_add_f32 v36, 1.0, v36
    buffer_load_dwordx4 v2, s[12:15], s27 offen offset:1024 lds
    ds_read_b64_tr_b16 v[84:85], v11 offset:45056
    v_mfma_f32_32x32x16_bf16 v[128:143], v[64:67], a[68:71], v[128:143]
    v_add_f32 v37, 1.0, v37
    v_add_f32 v38, 1.0, v38
    v_add_f32 v39, 1.0, v39
    ds_read_b64_tr_b16 v[86:87], v11 offset:45568
    v_mfma_f32_32x32x16_bf16 v[112:127], v[68:71], a[64:67], v[112:127]
    v_rcp_f32 v36, v36
    s_add_u32 m0, s30, 139264
    ds_read_b64_tr_b16 v[88:89], v11 offset:38912
    v_mfma_f32_32x32x16_bf16 v[144:159], v[68:71], a[68:71], v[144:159]
    v_rcp_f32 v37, v37
    ds_read_b64_tr_b16 v[90:91], v11 offset:39424
    s_waitcnt lgkmcnt(6)
    v_mfma_f32_32x32x16_bf16 v[96:111], v[72:75], a[72:75], v[96:111]
    v_rcp_f32 v38, v38
    buffer_load_dwordx4 v1, s[16:19], s27 offen lds
    ds_read_b64_tr_b16 v[92:93], v11 offset:47104
    v_mfma_f32_32x32x16_bf16 v[128:143], v[72:75], a[76:79], v[128:143]
    v_rcp_f32 v39, v39
    v_mul_f32 v44, v44, v36
    ds_read_b64_tr_b16 v[94:95], v11 offset:47616
    s_waitcnt vmcnt(14)
    s_barrier
    v_mfma_f32_32x32x16_bf16 v[112:127], v[76:79], a[72:75], v[112:127]
    v_mul_f32 v45, v45, v37
    v_mul_f32 v46, v46, v38
    buffer_load_dwordx4 v2, s[16:19], s27 offen offset:1024 lds
    ds_read_b64_tr_b16 v[64:65], v11 offset:49152
    v_mfma_f32_32x32x16_bf16 v[144:159], v[76:79], a[76:79], v[144:159]
    v_mul_f32 v47, v47, v39
    v_cvt_pk_bf16_f32 v26, v44, v45
    v_cvt_pk_bf16_f32 v27, v46, v47
    ds_read_b64_tr_b16 v[66:67], v11 offset:49664
    s_waitcnt lgkmcnt(6)
    v_mfma_f32_32x32x16_bf16 v[96:111], v[80:83], a[80:83], v[96:111]
    s_add_u32 s34, s34, 1
    s_cmp_eq_u32 s34, 9
    s_cselect_b32 s34, 0, s34
    s_add_u32 s48, s48, 128
    s_mul_i32 s27, s34, 589824
    s_add_u32 s27, s27, s48
    s_cmp_eq_u32 s29, 1
    s_cselect_b32 s49, 0x40000000, 0
    s_add_u32 s48, s48, s49
    s_add_u32 s27, s27, s49
    ds_read_b64_tr_b16 v[68:69], v11 offset:57344
    v_mfma_f32_32x32x16_bf16 v[128:143], v[80:83], a[84:87], v[128:143]
    buffer_store_dwordx4 v[24:27], v22, s[20:23], s28 offen offset:0 sc1
    v_mul_f32 v32, v168, v168
    v_mul_f32 v33, v169, v169
    ds_read_b64_tr_b16 v[70:71], v11 offset:57856
    v_mfma_f32_32x32x16_bf16 v[112:127], v[84:87], a[80:83], v[112:127]
    v_mul_f32 v34, v170, v170
    v_mul_f32 v35, v171, v171
    v_fmaak_f32 v32, v23, v32, 0xc0135761
    ds_read_b64_tr_b16 v[72:73], v11 offset:51200
    v_mfma_f32_32x32x16_bf16 v[144:159], v[84:87], a[84:87], v[144:159]
    v_fmaak_f32 v33, v23, v33, 0xc0135761
    v_fmaak_f32 v34, v23, v34, 0xc0135761
    v_fmaak_f32 v35, v23, v35, 0xc0135761
    ds_read_b64_tr_b16 v[74:75], v11 offset:51712
    s_waitcnt lgkmcnt(6)
    v_mfma_f32_32x32x16_bf16 v[96:111], v[88:91], a[88:91], v[96:111]
    v_mul_f32 v32, v32, v168
    v_mul_f32 v33, v33, v169
    v_mul_f32 v34, v34, v170
    ds_read_b64_tr_b16 v[76:77], v11 offset:59392
    v_mfma_f32_32x32x16_bf16 v[128:143], v[88:91], a[92:95], v[128:143]
    v_mul_f32 v35, v35, v171
    v_exp_f32 v32, v32
    ds_read_b64_tr_b16 v[78:79], v11 offset:59904
    v_mfma_f32_32x32x16_bf16 v[112:127], v[92:95], a[88:91], v[112:127]
    v_exp_f32 v33, v33
    ds_read_b64_tr_b16 v[80:81], v11 offset:53248
    v_mfma_f32_32x32x16_bf16 v[144:159], v[92:95], a[92:95], v[144:159]
    v_exp_f32 v34, v34
    ds_read_b64_tr_b16 v[82:83], v11 offset:53760
    s_waitcnt lgkmcnt(6)
    v_mfma_f32_32x32x16_bf16 v[96:111], v[64:67], a[96:99], v[96:111]
    v_exp_f32 v35, v35
    v_mul_f32 v40, v168, v184
    ds_read_b64_tr_b16 v[84:85], v11 offset:61440
    v_mfma_f32_32x32x16_bf16 v[128:143], v[64:67], a[100:103], v[128:143]
    v_mul_f32 v41, v169, v185
    v_mul_f32 v42, v170, v186
    v_mul_f32 v43, v171, v187
    ds_read_b64_tr_b16 v[86:87], v11 offset:61952
    v_mfma_f32_32x32x16_bf16 v[112:127], v[68:71], a[96:99], v[112:127]
    v_add_f32 v32, 1.0, v32
    v_add_f32 v33, 1.0, v33
    v_add_f32 v34, 1.0, v34
    ds_read_b64_tr_b16 v[88:89], v11 offset:55296
    v_mfma_f32_32x32x16_bf16 v[144:159], v[68:71], a[100:103], v[144:159]
    v_add_f32 v35, 1.0, v35
    v_rcp_f32 v32, v32
    ds_read_b64_tr_b16 v[90:91], v11 offset:55808
    s_waitcnt lgkmcnt(6)
    v_mfma_f32_32x32x16_bf16 v[96:111], v[72:75], a[104:107], v[96:111]
    v_rcp_f32 v33, v33
    ds_read_b64_tr_b16 v[92:93], v11 offset:63488
    v_mfma_f32_32x32x16_bf16 v[128:143], v[72:75], a[108:111], v[128:143]
    v_rcp_f32 v34, v34
    ds_read_b64_tr_b16 v[94:95], v11 offset:64000
    v_mfma_f32_32x32x16_bf16 v[112:127], v[76:79], a[104:107], v[112:127]
    v_rcp_f32 v35, v35
    v_mul_f32 v40, v40, v32
    ds_read_b64_tr_b16 v[64:65], v12 offset:0
    v_mfma_f32_32x32x16_bf16 v[144:159], v[76:79], a[108:111], v[144:159]
    v_mul_f32 v41, v41, v33
    v_mul_f32 v42, v42, v34
    v_mul_f32 v43, v43, v35
    ds_read_b64_tr_b16 v[66:67], v12 offset:512
    s_waitcnt lgkmcnt(6)
    v_mfma_f32_32x32x16_bf16 v[96:111], v[80:83], a[112:115], v[96:111]
    v_cvt_pk_bf16_f32 v28, v40, v41
    v_cvt_pk_bf16_f32 v29, v42, v43
    v_mul_f32 v36, v172, v172
    ds_read_b64_tr_b16 v[68:69], v12 offset:8192
    v_mfma_f32_32x32x16_bf16 v[128:143], v[80:83], a[116:119], v[128:143]
    v_mul_f32 v37, v173, v173
    v_mul_f32 v38, v174, v174
    v_mul_f32 v39, v175, v175
    ds_read_b64_tr_b16 v[70:71], v12 offset:8704
    v_mfma_f32_32x32x16_bf16 v[112:127], v[84:87], a[112:115], v[112:127]
    v_fmaak_f32 v36, v23, v36, 0xc0135761
    v_fmaak_f32 v37, v23, v37, 0xc0135761
    v_fmaak_f32 v38, v23, v38, 0xc0135761
    ds_read_b64_tr_b16 v[72:73], v12 offset:2048
    v_mfma_f32_32x32x16_bf16 v[144:159], v[84:87], a[116:119], v[144:159]
    v_fmaak_f32 v39, v23, v39, 0xc0135761
    v_mul_f32 v36, v36, v172
    v_mul_f32 v37, v37, v173
    ds_read_b64_tr_b16 v[74:75], v12 offset:2560
    s_waitcnt lgkmcnt(6)
    v_mfma_f32_32x32x16_bf16 v[96:111], v[88:91], a[120:123], v[96:111]
    v_mul_f32 v38, v38, v174
    v_mul_f32 v39, v39, v175
    ds_read_b64_tr_b16 v[76:77], v12 offset:10240
    v_mfma_f32_32x32x16_bf16 v[128:143], v[88:91], a[124:127], v[128:143]
    v_exp_f32 v36, v36
    ds_read_b64_tr_b16 v[78:79], v12 offset:10752
    v_mfma_f32_32x32x16_bf16 v[112:127], v[92:95], a[120:123], v[112:127]
    v_exp_f32 v37, v37
    ds_read_b64_tr_b16 v[80:81], v12 offset:4096
    v_mfma_f32_32x32x16_bf16 v[144:159], v[92:95], a[124:127], v[144:159]
    v_exp_f32 v38, v38
    ds_read_b64_tr_b16 v[82:83], v12 offset:4608
    s_waitcnt lgkmcnt(6)
    v_mfma_f32_32x32x16_bf16 v[96:111], v[64:67], a[128:131], v[96:111]
    v_exp_f32 v39, v39
    v_mul_f32 v44, v172, v188
    ds_read_b64_tr_b16 v[84:85], v12 offset:12288
    v_mfma_f32_32x32x16_bf16 v[128:143], v[64:67], a[132:135], v[128:143]
    v_mul_f32 v45, v173, v189
    v_mul_f32 v46, v174, v190
    v_mul_f32 v47, v175, v191
    ds_read_b64_tr_b16 v[86:87], v12 offset:12800
    v_mfma_f32_32x32x16_bf16 v[112:127], v[68:71], a[128:131], v[112:127]
    v_add_f32 v36, 1.0, v36
    v_add_f32 v37, 1.0, v37
    v_add_f32 v38, 1.0, v38
    ds_read_b64_tr_b16 v[88:89], v12 offset:6144
    v_mfma_f32_32x32x16_bf16 v[144:159], v[68:71], a[132:135], v[144:159]
    v_add_f32 v39, 1.0, v39
    v_rcp_f32 v36, v36
    ds_read_b64_tr_b16 v[90:91], v12 offset:6656
    s_waitcnt lgkmcnt(6)
    v_mfma_f32_32x32x16_bf16 v[96:111], v[72:75], a[136:139], v[96:111]
    v_rcp_f32 v37, v37
    ds_read_b64_tr_b16 v[92:93], v12 offset:14336
    v_mfma_f32_32x32x16_bf16 v[128:143], v[72:75], a[140:143], v[128:143]
    v_rcp_f32 v38, v38
    ds_read_b64_tr_b16 v[94:95], v12 offset:14848
    v_mfma_f32_32x32x16_bf16 v[112:127], v[76:79], a[136:139], v[112:127]
    v_rcp_f32 v39, v39
    v_mul_f32 v44, v44, v36
    ds_read_b64_tr_b16 v[64:65], v12 offset:16384
    v_mfma_f32_32x32x16_bf16 v[144:159], v[76:79], a[140:143], v[144:159]
    v_mul_f32 v45, v45, v37
    v_mul_f32 v46, v46, v38
    v_mul_f32 v47, v47, v39
    ds_read_b64_tr_b16 v[66:67], v12 offset:16896
    s_waitcnt lgkmcnt(6)
    v_mfma_f32_32x32x16_bf16 v[96:111], v[80:83], a[144:147], v[96:111]
    v_cvt_pk_bf16_f32 v30, v44, v45
    v_cvt_pk_bf16_f32 v31, v46, v47
    buffer_store_dwordx4 v[28:31], v22, s[20:23], s28 offen offset:1024 sc1
    ds_read_b64_tr_b16 v[68:69], v12 offset:24576
    v_mfma_f32_32x32x16_bf16 v[128:143], v[80:83], a[148:151], v[128:143]
    s_add_u32 s28, s28, 331776
    v_mul_f32 v32, v192, v192
    v_mul_f32 v33, v193, v193
    ds_read_b64_tr_b16 v[70:71], v12 offset:25088
    v_mfma_f32_32x32x16_bf16 v[112:127], v[84:87], a[144:147], v[112:127]
    v_mul_f32 v34, v194, v194
    v_mul_f32 v35, v195, v195
    v_fmaak_f32 v32, v23, v32, 0xc0135761
    ds_read_b64_tr_b16 v[72:73], v12 offset:18432
    v_mfma_f32_32x32x16_bf16 v[144:159], v[84:87], a[148:151], v[144:159]
    v_fmaak_f32 v33, v23, v33, 0xc0135761
    v_fmaak_f32 v34, v23, v34, 0xc0135761
    ds_read_b64_tr_b16 v[74:75], v12 offset:18944
    s_waitcnt lgkmcnt(6)
    v_mfma_f32_32x32x16_bf16 v[96:111], v[88:91], a[152:155], v[96:111]
    v_fmaak_f32 v35, v23, v35, 0xc0135761
    v_mul_f32 v32, v32, v192
    v_mul_f32 v33, v33, v193
    ds_read_b64_tr_b16 v[76:77], v12 offset:26624
    v_mfma_f32_32x32x16_bf16 v[128:143], v[88:91], a[156:159], v[128:143]
    v_mul_f32 v34, v34, v194
    v_mul_f32 v35, v35, v195
    ds_read_b64_tr_b16 v[78:79], v12 offset:27136
    v_mfma_f32_32x32x16_bf16 v[112:127], v[92:95], a[152:155], v[112:127]
    v_exp_f32 v32, v32
    ds_read_b64_tr_b16 v[80:81], v12 offset:20480
    v_mfma_f32_32x32x16_bf16 v[144:159], v[92:95], a[156:159], v[144:159]
    v_exp_f32 v33, v33
    ds_read_b64_tr_b16 v[82:83], v12 offset:20992
    s_waitcnt lgkmcnt(6)
    v_mfma_f32_32x32x16_bf16 v[96:111], v[64:67], a[160:163], v[96:111]
    v_exp_f32 v34, v34
    ds_read_b64_tr_b16 v[84:85], v12 offset:28672
    v_mfma_f32_32x32x16_bf16 v[128:143], v[64:67], a[164:167], v[128:143]
    v_exp_f32 v35, v35
    v_mul_f32 v40, v192, v208
    ds_read_b64_tr_b16 v[86:87], v12 offset:29184
    v_mfma_f32_32x32x16_bf16 v[112:127], v[68:71], a[160:163], v[112:127]
    v_mul_f32 v41, v193, v209
    v_mul_f32 v42, v194, v210
    v_mul_f32 v43, v195, v211
    ds_read_b64_tr_b16 v[88:89], v12 offset:22528
    v_mfma_f32_32x32x16_bf16 v[144:159], v[68:71], a[164:167], v[144:159]
    v_add_f32 v32, 1.0, v32
    v_add_f32 v33, 1.0, v33
    ds_read_b64_tr_b16 v[90:91], v12 offset:23040
    s_waitcnt lgkmcnt(6)
    v_mfma_f32_32x32x16_bf16 v[96:111], v[72:75], a[168:171], v[96:111]
    v_add_f32 v34, 1.0, v34
    v_add_f32 v35, 1.0, v35
    ds_read_b64_tr_b16 v[92:93], v12 offset:30720
    v_mfma_f32_32x32x16_bf16 v[128:143], v[72:75], a[172:175], v[128:143]
    v_rcp_f32 v32, v32
    ds_read_b64_tr_b16 v[94:95], v12 offset:31232
    s_waitcnt vmcnt(2)
    s_barrier
    v_mfma_f32_32x32x16_bf16 v[112:127], v[76:79], a[168:171], v[112:127]
    v_rcp_f32 v33, v33
    ds_read_b64_tr_b16 v[64:65], v12 offset:32768
    v_mfma_f32_32x32x16_bf16 v[144:159], v[76:79], a[172:175], v[144:159]
    v_rcp_f32 v34, v34
    ds_read_b64_tr_b16 v[66:67], v12 offset:33280
    s_waitcnt lgkmcnt(6)
    v_mfma_f32_32x32x16_bf16 v[96:111], v[80:83], a[176:179], v[96:111]
    v_rcp_f32 v35, v35
    v_mul_f32 v40, v40, v32
    ds_read_b64_tr_b16 v[68:69], v12 offset:40960
    v_mfma_f32_32x32x16_bf16 v[128:143], v[80:83], a[180:183], v[128:143]
    v_mul_f32 v41, v41, v33
    v_mul_f32 v42, v42, v34
    v_mul_f32 v43, v43, v35
    ds_read_b64_tr_b16 v[70:71], v12 offset:41472
    v_mfma_f32_32x32x16_bf16 v[112:127], v[84:87], a[176:179], v[112:127]
    v_cvt_pk_bf16_f32 v24, v40, v41
    v_cvt_pk_bf16_f32 v25, v42, v43
    v_mul_f32 v36, v196, v196
    ds_read_b64_tr_b16 v[72:73], v12 offset:34816
    v_mfma_f32_32x32x16_bf16 v[144:159], v[84:87], a[180:183], v[144:159]
    v_mul_f32 v37, v197, v197
    v_mul_f32 v38, v198, v198
    v_mul_f32 v39, v199, v199
    ds_read_b64_tr_b16 v[74:75], v12 offset:35328
    s_waitcnt lgkmcnt(6)
    v_mfma_f32_32x32x16_bf16 v[96:111], v[88:91], a[184:187], v[96:111]
    v_fmaak_f32 v36, v23, v36, 0xc0135761
    v_fmaak_f32 v37, v23, v37, 0xc0135761
    ds_read_b64_tr_b16 v[76:77], v12 offset:43008
    v_mfma_f32_32x32x16_bf16 v[128:143], v[88:91], a[188:191], v[128:143]
    v_fmaak_f32 v38, v23, v38, 0xc0135761
    v_fmaak_f32 v39, v23, v39, 0xc0135761
    ds_read_b64_tr_b16 v[78:79], v12 offset:43520
    v_mfma_f32_32x32x16_bf16 v[112:127], v[92:95], a[184:187], v[112:127]
    v_mul_f32 v36, v36, v196
    v_mul_f32 v37, v37, v197
    v_mul_f32 v38, v38, v198
    ds_read_b64_tr_b16 v[80:81], v12 offset:36864
    v_mfma_f32_32x32x16_bf16 v[144:159], v[92:95], a[188:191], v[144:159]
    v_mul_f32 v39, v39, v199
    ds_read_b64_tr_b16 v[82:83], v12 offset:37376
    s_waitcnt lgkmcnt(6)
    v_mfma_f32_32x32x16_bf16 v[96:111], v[64:67], a[192:195], v[96:111]
    v_exp_f32 v36, v36
    ds_read_b64_tr_b16 v[84:85], v12 offset:45056
    v_mfma_f32_32x32x16_bf16 v[128:143], v[64:67], a[196:199], v[128:143]
    v_exp_f32 v37, v37
    ds_read_b64_tr_b16 v[86:87], v12 offset:45568
    v_mfma_f32_32x32x16_bf16 v[112:127], v[68:71], a[192:195], v[112:127]
    v_exp_f32 v38, v38
    ds_read_b64_tr_b16 v[88:89], v12 offset:38912
    v_mfma_f32_32x32x16_bf16 v[144:159], v[68:71], a[196:199], v[144:159]
    v_exp_f32 v39, v39
    v_mul_f32 v44, v196, v212
    ds_read_b64_tr_b16 v[90:91], v12 offset:39424
    s_waitcnt lgkmcnt(6)
    v_mfma_f32_32x32x16_bf16 v[96:111], v[72:75], a[200:203], v[96:111]
    v_mul_f32 v45, v197, v213
    v_mul_f32 v46, v198, v214
    v_mul_f32 v47, v199, v215
    ds_read_b64_tr_b16 v[92:93], v12 offset:47104
    v_mfma_f32_32x32x16_bf16 v[128:143], v[72:75], a[204:207], v[128:143]
    v_add_f32 v36, 1.0, v36
    v_add_f32 v37, 1.0, v37
    v_add_f32 v38, 1.0, v38
    ds_read_b64_tr_b16 v[94:95], v12 offset:47616
    v_mfma_f32_32x32x16_bf16 v[112:127], v[76:79], a[200:203], v[112:127]
    v_add_f32 v39, 1.0, v39
    v_rcp_f32 v36, v36
    ds_read_b64_tr_b16 v[64:65], v12 offset:49152
    v_mfma_f32_32x32x16_bf16 v[144:159], v[76:79], a[204:207], v[144:159]
    v_rcp_f32 v37, v37
    ds_read_b64_tr_b16 v[66:67], v12 offset:49664
    s_waitcnt lgkmcnt(6)
    v_mfma_f32_32x32x16_bf16 v[96:111], v[80:83], a[208:211], v[96:111]
    v_rcp_f32 v38, v38
    ds_read_b64_tr_b16 v[68:69], v12 offset:57344
    v_mfma_f32_32x32x16_bf16 v[128:143], v[80:83], a[212:215], v[128:143]
    v_rcp_f32 v39, v39
    v_mul_f32 v44, v44, v36
    ds_read_b64_tr_b16 v[70:71], v12 offset:57856
    v_mfma_f32_32x32x16_bf16 v[112:127], v[84:87], a[208:211], v[112:127]
    v_mul_f32 v45, v45, v37
    v_mul_f32 v46, v46, v38
    v_mul_f32 v47, v47, v39
    ds_read_b64_tr_b16 v[72:73], v12 offset:51200
    v_mfma_f32_32x32x16_bf16 v[144:159], v[84:87], a[212:215], v[144:159]
    v_cvt_pk_bf16_f32 v26, v44, v45
    v_cvt_pk_bf16_f32 v27, v46, v47
    ds_read_b64_tr_b16 v[74:75], v12 offset:51712
    s_waitcnt lgkmcnt(6)
    v_mfma_f32_32x32x16_bf16 v[96:111], v[88:91], a[216:219], v[96:111]
    buffer_store_dwordx4 v[24:27], v22, s[20:23], s28 offen offset:0 sc1
    v_mul_f32 v32, v200, v200
    ds_read_b64_tr_b16 v[76:77], v12 offset:59392
    v_mfma_f32_32x32x16_bf16 v[128:143], v[88:91], a[220:223], v[128:143]
    v_mul_f32 v33, v201, v201
    v_mul_f32 v34, v202, v202
    v_mul_f32 v35, v203, v203
    ds_read_b64_tr_b16 v[78:79], v12 offset:59904
    v_mfma_f32_32x32x16_bf16 v[112:127], v[92:95], a[216:219], v[112:127]
    v_fmaak_f32 v32, v23, v32, 0xc0135761
    v_fmaak_f32 v33, v23, v33, 0xc0135761
    ds_read_b64_tr_b16 v[80:81], v12 offset:53248
    v_mfma_f32_32x32x16_bf16 v[144:159], v[92:95], a[220:223], v[144:159]
    v_fmaak_f32 v34, v23, v34, 0xc0135761
    v_fmaak_f32 v35, v23, v35, 0xc0135761
    v_mul_f32 v32, v32, v200
    ds_read_b64_tr_b16 v[82:83], v12 offset:53760
    s_waitcnt lgkmcnt(6)
    v_mfma_f32_32x32x16_bf16 v[96:111], v[64:67], a[224:227], v[96:111]
    v_mul_f32 v33, v33, v201
    v_mul_f32 v34, v34, v202
    ds_read_b64_tr_b16 v[84:85], v12 offset:61440
    v_mfma_f32_32x32x16_bf16 v[128:143], v[64:67], a[228:231], v[128:143]
    v_mul_f32 v35, v35, v203
    ds_read_b64_tr_b16 v[86:87], v12 offset:61952
    v_mfma_f32_32x32x16_bf16 v[112:127], v[68:71], a[224:227], v[112:127]
    v_exp_f32 v32, v32
    ds_read_b64_tr_b16 v[88:89], v12 offset:55296
    v_mfma_f32_32x32x16_bf16 v[144:159], v[68:71], a[228:231], v[144:159]
    v_exp_f32 v33, v33
    ds_read_b64_tr_b16 v[90:91], v12 offset:55808
    s_waitcnt lgkmcnt(6)
    v_mfma_f32_32x32x16_bf16 v[96:111], v[72:75], a[232:235], v[96:111]
    v_exp_f32 v34, v34
    ds_read_b64_tr_b16 v[92:93], v12 offset:63488
    v_mfma_f32_32x32x16_bf16 v[128:143], v[72:75], a[236:239], v[128:143]
    v_exp_f32 v35, v35
    v_mul_f32 v40, v200, v216
    ds_read_b64_tr_b16 v[94:95], v12 offset:64000
    v_mfma_f32_32x32x16_bf16 v[112:127], v[76:79], a[232:235], v[112:127]
    v_mul_f32 v41, v201, v217
    v_mul_f32 v42, v202, v218
    v_mul_f32 v43, v203, v219
    ds_read_b64_tr_b16 v[64:65], v13 offset:0
    v_mfma_f32_32x32x16_bf16 v[144:159], v[76:79], a[236:239], v[144:159]
    v_add_f32 v32, 1.0, v32
    v_add_f32 v33, 1.0, v33
    v_add_f32 v34, 1.0, v34
    ds_read_b64_tr_b16 v[66:67], v13 offset:512
    s_waitcnt lgkmcnt(6)
    v_mfma_f32_32x32x16_bf16 v[96:111], v[80:83], a[240:243], v[96:111]
    v_add_f32 v35, 1.0, v35
    v_rcp_f32 v32, v32
    ds_read_b64_tr_b16 v[68:69], v13 offset:8192
    v_mfma_f32_32x32x16_bf16 v[128:143], v[80:83], a[244:247], v[128:143]
    v_rcp_f32 v33, v33
    ds_read_b64_tr_b16 v[70:71], v13 offset:8704
    v_mfma_f32_32x32x16_bf16 v[112:127], v[84:87], a[240:243], v[112:127]
    v_rcp_f32 v34, v34
    ds_read_b64_tr_b16 v[72:73], v13 offset:2048
    v_mfma_f32_32x32x16_bf16 v[144:159], v[84:87], a[244:247], v[144:159]
    v_rcp_f32 v35, v35
    v_mul_f32 v40, v40, v32
    ds_read_b64_tr_b16 v[74:75], v13 offset:2560
    s_waitcnt lgkmcnt(6)
    v_mfma_f32_32x32x16_bf16 v[96:111], v[88:91], a[248:251], v[96:111]
    v_mul_f32 v41, v41, v33
    v_mul_f32 v42, v42, v34
    v_mul_f32 v43, v43, v35
    ds_read_b64_tr_b16 v[76:77], v13 offset:10240
    v_mfma_f32_32x32x16_bf16 v[128:143], v[88:91], a[252:255], v[128:143]
    v_cvt_pk_bf16_f32 v28, v40, v41
    v_cvt_pk_bf16_f32 v29, v42, v43
    ds_read_b64_tr_b16 v[78:79], v13 offset:10752
    v_mfma_f32_32x32x16_bf16 v[112:127], v[92:95], a[248:251], v[112:127]
    v_mul_f32 v36, v204, v204
    v_mul_f32 v37, v205, v205
    v_mul_f32 v38, v206, v206
    ds_read_b64_tr_b16 v[80:81], v13 offset:4096
    v_mfma_f32_32x32x16_bf16 v[144:159], v[92:95], a[252:255], v[144:159]
    v_mul_f32 v39, v207, v207
    v_fmaak_f32 v36, v23, v36, 0xc0135761
    ds_read_b64_tr_b16 v[82:83], v13 offset:4608
    s_waitcnt lgkmcnt(6)
    v_mfma_f32_32x32x16_bf16 v[96:111], v[64:67], v[224:227], v[96:111]
    v_fmaak_f32 v37, v23, v37, 0xc0135761
    v_fmaak_f32 v38, v23, v38, 0xc0135761
    ds_read_b64_tr_b16 v[84:85], v13 offset:12288
    v_mfma_f32_32x32x16_bf16 v[128:143], v[64:67], v[228:231], v[128:143]
    v_fmaak_f32 v39, v23, v39, 0xc0135761
    v_mul_f32 v36, v36, v204
    v_mul_f32 v37, v37, v205
    ds_read_b64_tr_b16 v[86:87], v13 offset:12800
    v_mfma_f32_32x32x16_bf16 v[112:127], v[68:71], v[224:227], v[112:127]
    v_mul_f32 v38, v38, v206
    v_mul_f32 v39, v39, v207
    ds_read_b64_tr_b16 v[88:89], v13 offset:6144
    v_mfma_f32_32x32x16_bf16 v[144:159], v[68:71], v[228:231], v[144:159]
    v_exp_f32 v36, v36
    ds_read_b64_tr_b16 v[90:91], v13 offset:6656
    s_waitcnt lgkmcnt(6)
    v_mfma_f32_32x32x16_bf16 v[96:111], v[72:75], v[232:235], v[96:111]
    v_exp_f32 v37, v37
    ds_read_b64_tr_b16 v[92:93], v13 offset:14336
    v_mfma_f32_32x32x16_bf16 v[128:143], v[72:75], v[236:239], v[128:143]
    v_exp_f32 v38, v38
    ds_read_b64_tr_b16 v[94:95], v13 offset:14848
    v_add_u32 v11, 0, v8
    v_add_u32 v12, 65536, v8
    v_add_u32 v13, 131072, v8
    v_mfma_f32_32x32x16_bf16 v[112:127], v[76:79], v[232:235], v[112:127]
    v_exp_f32 v39, v39
    v_mul_f32 v44, v204, v220
    ds_read_b64_tr_b16 v[64:65], v11 offset:0
    v_mfma_f32_32x32x16_bf16 v[144:159], v[76:79], v[236:239], v[144:159]
    v_mul_f32 v45, v205, v221
    v_mul_f32 v46, v206, v222
    v_mul_f32 v47, v207, v223
    ds_read_b64_tr_b16 v[66:67], v11 offset:512
    s_waitcnt lgkmcnt(6)
    v_mfma_f32_32x32x16_bf16 v[96:111], v[80:83], v[240:243], v[96:111]
    v_add_f32 v36, 1.0, v36
    v_add_f32 v37, 1.0, v37
    v_add_f32 v38, 1.0, v38
    ds_read_b64_tr_b16 v[68:69], v11 offset:8192
    v_mfma_f32_32x32x16_bf16 v[128:143], v[80:83], v[244:247], v[128:143]
    v_add_f32 v39, 1.0, v39
    ds_read_b64_tr_b16 v[70:71], v11 offset:8704
    v_mfma_f32_32x32x16_bf16 v[112:127], v[84:87], v[240:243], v[112:127]
    v_rcp_f32 v36, v36
    ds_read_b64_tr_b16 v[72:73], v11 offset:2048
    v_mfma_f32_32x32x16_bf16 v[144:159], v[84:87], v[244:247], v[144:159]
    v_rcp_f32 v37, v37
    ds_read_b64_tr_b16 v[74:75], v11 offset:2560
    s_waitcnt lgkmcnt(6)
    v_mfma_f32_32x32x16_bf16 v[96:111], v[88:91], v[248:251], v[96:111]
    v_rcp_f32 v38, v38
    ds_read_b64_tr_b16 v[76:77], v11 offset:10240
    v_mfma_f32_32x32x16_bf16 v[128:143], v[88:91], v[252:255], v[128:143]
    v_rcp_f32 v39, v39
    v_mul_f32 v44, v44, v36
    ds_read_b64_tr_b16 v[78:79], v11 offset:10752
    v_mfma_f32_32x32x16_bf16 v[112:127], v[92:95], v[248:251], v[112:127]
    v_mul_f32 v45, v45, v37
    v_mul_f32 v46, v46, v38
    v_mul_f32 v47, v47, v39
    ds_read_b64_tr_b16 v[80:81], v11 offset:4096
    v_mfma_f32_32x32x16_bf16 v[144:159], v[92:95], v[252:255], v[144:159]
    v_cvt_pk_bf16_f32 v30, v44, v45
    v_cvt_pk_bf16_f32 v31, v46, v47
    buffer_store_dwordx4 v[28:31], v22, s[20:23], s28 offen offset:1024 sc1
    ds_read_b64_tr_b16 v[82:83], v11 offset:4608
    s_sub_u32 s28, s28, 329728
    s_waitcnt lgkmcnt(6)
    v_mfma_f32_32x32x16_bf16 v[160:175], v[64:67], a[0:3], 0
    buffer_load_dwordx4 v[56:59], v22, s[56:59], s32 offen
    s_add_u32 s32, s32, 1024
    ds_read_b64_tr_b16 v[84:85], v11 offset:12288
    v_mfma_f32_32x32x16_bf16 v[192:207], v[64:67], a[4:7], 0
    buffer_load_dwordx4 v[56:59], v22, s[56:59], s32 offen
    s_add_u32 s32, s32, 1024
    ds_read_b64_tr_b16 v[86:87], v11 offset:12800
    v_mfma_f32_32x32x16_bf16 v[176:191], v[68:71], a[0:3], 0
    v_mul_f32 v32, v96, v96
    v_mul_f32 v33, v97, v97
    v_mul_f32 v34, v98, v98
    ds_read_b64_tr_b16 v[88:89], v11 offset:6144
    v_mfma_f32_32x32x16_bf16 v[208:223], v[68:71], a[4:7], 0
    v_mul_f32 v35, v99, v99
    v_fmaak_f32 v32, v23, v32, 0xc0135761
    ds_read_b64_tr_b16 v[90:91], v11 offset:6656
    s_waitcnt lgkmcnt(6)
    v_mfma_f32_32x32x16_bf16 v[160:175], v[72:75], a[8:11], v[160:175]
    v_fmaak_f32 v33, v23, v33, 0xc0135761
    v_fmaak_f32 v34, v23, v34, 0xc0135761
    v_fmaak_f32 v35, v23, v35, 0xc0135761
    ds_read_b64_tr_b16 v[92:93], v11 offset:14336
    v_mfma_f32_32x32x16_bf16 v[192:207], v[72:75], a[12:15], v[192:207]
    v_mul_f32 v32, v32, v96
    v_mul_f32 v33, v33, v97
    ds_read_b64_tr_b16 v[94:95], v11 offset:14848
    v_mfma_f32_32x32x16_bf16 v[176:191], v[76:79], a[8:11], v[176:191]
    v_mul_f32 v34, v34, v98
    v_mul_f32 v35, v35, v99
    ds_read_b64_tr_b16 v[64:65], v11 offset:16384
    v_mfma_f32_32x32x16_bf16 v[208:223], v[76:79], a[12:15], v[208:223]
    v_exp_f32 v32, v32
    ds_read_b64_tr_b16 v[66:67], v11 offset:16896
    s_waitcnt lgkmcnt(6)
    v_mfma_f32_32x32x16_bf16 v[160:175], v[80:83], a[16:19], v[160:175]
    v_exp_f32 v33, v33
    ds_read_b64_tr_b16 v[68:69], v11 offset:24576
    v_mfma_f32_32x32x16_bf16 v[192:207], v[80:83], a[20:23], v[192:207]
    v_exp_f32 v34, v34
    ds_read_b64_tr_b16 v[70:71], v11 offset:25088
    v_mfma_f32_32x32x16_bf16 v[176:191], v[84:87], a[16:19], v[176:191]
    v_exp_f32 v35, v35
    v_mul_f32 v40, v96, v112
    ds_read_b64_tr_b16 v[72:73], v11 offset:18432
    v_mfma_f32_32x32x16_bf16 v[208:223], v[84:87], a[20:23], v[208:223]
    v_mul_f32 v41, v97, v113
    v_mul_f32 v42, v98, v114
    v_mul_f32 v43, v99, v115
    ds_read_b64_tr_b16 v[74:75], v11 offset:18944
    s_waitcnt lgkmcnt(6)
    v_mfma_f32_32x32x16_bf16 v[160:175], v[88:91], a[24:27], v[160:175]
    v_add_f32 v32, 1.0, v32
    v_add_f32 v33, 1.0, v33
    v_add_f32 v34, 1.0, v34
    ds_read_b64_tr_b16 v[76:77], v11 offset:26624
    v_mfma_f32_32x32x16_bf16 v[192:207], v[88:91], a[28:31], v[192:207]
    v_add_f32 v35, 1.0, v35
    ds_read_b64_tr_b16 v[78:79], v11 offset:27136
    v_mfma_f32_32x32x16_bf16 v[176:191], v[92:95], a[24:27], v[176:191]
    v_rcp_f32 v32, v32
    ds_read_b64_tr_b16 v[80:81], v11 offset:20480
    v_mfma_f32_32x32x16_bf16 v[208:223], v[92:95], a[28:31], v[208:223]
    v_rcp_f32 v33, v33
    ds_read_b64_tr_b16 v[82:83], v11 offset:20992
    s_waitcnt lgkmcnt(6)
    v_mfma_f32_32x32x16_bf16 v[160:175], v[64:67], a[32:35], v[160:175]
    v_rcp_f32 v34, v34
    ds_read_b64_tr_b16 v[84:85], v11 offset:28672
    v_mfma_f32_32x32x16_bf16 v[192:207], v[64:67], a[36:39], v[192:207]
    v_rcp_f32 v35, v35
    v_mul_f32 v40, v40, v32
    ds_read_b64_tr_b16 v[86:87], v11 offset:29184
    v_mfma_f32_32x32x16_bf16 v[176:191], v[68:71], a[32:35], v[176:191]
    v_mul_f32 v41, v41, v33
    v_mul_f32 v42, v42, v34
    v_mul_f32 v43, v43, v35
    ds_read_b64_tr_b16 v[88:89], v11 offset:22528
    v_mfma_f32_32x32x16_bf16 v[208:223], v[68:71], a[36:39], v[208:223]
    v_cvt_pk_bf16_f32 v24, v40, v41
    v_cvt_pk_bf16_f32 v25, v42, v43
    v_mul_f32 v36, v100, v100
    ds_read_b64_tr_b16 v[90:91], v11 offset:23040
    s_waitcnt lgkmcnt(6)
    v_mfma_f32_32x32x16_bf16 v[160:175], v[72:75], a[40:43], v[160:175]
    v_mul_f32 v37, v101, v101
    v_mul_f32 v38, v102, v102
    v_mul_f32 v39, v103, v103
    ds_read_b64_tr_b16 v[92:93], v11 offset:30720
    v_mfma_f32_32x32x16_bf16 v[192:207], v[72:75], a[44:47], v[192:207]
    v_fmaak_f32 v36, v23, v36, 0xc0135761
    v_fmaak_f32 v37, v23, v37, 0xc0135761
    ds_read_b64_tr_b16 v[94:95], v11 offset:31232
    v_mfma_f32_32x32x16_bf16 v[176:191], v[76:79], a[40:43], v[176:191]
    v_fmaak_f32 v38, v23, v38, 0xc0135761
    v_fmaak_f32 v39, v23, v39, 0xc0135761
    v_mul_f32 v36, v36, v100
    ds_read_b64_tr_b16 v[64:65], v11 offset:32768
    v_mfma_f32_32x32x16_bf16 v[208:223], v[76:79], a[44:47], v[208:223]
    v_mul_f32 v37, v37, v101
    v_mul_f32 v38, v38, v102
    ds_read_b64_tr_b16 v[66:67], v11 offset:33280
    s_waitcnt lgkmcnt(6)
    v_mfma_f32_32x32x16_bf16 v[160:175], v[80:83], a[48:51], v[160:175]
    v_mul_f32 v39, v39, v103
    v_exp_f32 v36, v36
    ds_read_b64_tr_b16 v[68:69], v11 offset:40960
    v_mfma_f32_32x32x16_bf16 v[192:207], v[80:83], a[52:55], v[192:207]
    v_exp_f32 v37, v37
    ds_read_b64_tr_b16 v[70:71], v11 offset:41472
    v_mfma_f32_32x32x16_bf16 v[176:191], v[84:87], a[48:51], v[176:191]
    v_exp_f32 v38, v38
    ds_read_b64_tr_b16 v[72:73], v11 offset:34816
    v_mfma_f32_32x32x16_bf16 v[208:223], v[84:87], a[52:55], v[208:223]
    v_exp_f32 v39, v39
    v_mul_f32 v44, v100, v116
    ds_read_b64_tr_b16 v[74:75], v11 offset:35328
    s_waitcnt lgkmcnt(6)
    v_mfma_f32_32x32x16_bf16 v[160:175], v[88:91], a[56:59], v[160:175]
    v_mul_f32 v45, v101, v117
    v_mul_f32 v46, v102, v118
    ds_read_b64_tr_b16 v[76:77], v11 offset:43008
    v_mfma_f32_32x32x16_bf16 v[192:207], v[88:91], a[60:63], v[192:207]
    v_mul_f32 v47, v103, v119
    v_add_f32 v36, 1.0, v36
    v_add_f32 v37, 1.0, v37
    ds_read_b64_tr_b16 v[78:79], v11 offset:43520
    v_mfma_f32_32x32x16_bf16 v[176:191], v[92:95], a[56:59], v[176:191]
    v_add_f32 v38, 1.0, v38
    v_add_f32 v39, 1.0, v39
    ds_read_b64_tr_b16 v[80:81], v11 offset:36864
    v_mfma_f32_32x32x16_bf16 v[208:223], v[92:95], a[60:63], v[208:223]
    v_rcp_f32 v36, v36
    ds_read_b64_tr_b16 v[82:83], v11 offset:37376
    s_waitcnt lgkmcnt(6)
    v_mfma_f32_32x32x16_bf16 v[160:175], v[64:67], a[64:67], v[160:175]
    v_rcp_f32 v37, v37
    ds_read_b64_tr_b16 v[84:85], v11 offset:45056
    v_mfma_f32_32x32x16_bf16 v[192:207], v[64:67], a[68:71], v[192:207]
    v_rcp_f32 v38, v38
    ds_read_b64_tr_b16 v[86:87], v11 offset:45568
    v_mfma_f32_32x32x16_bf16 v[176:191], v[68:71], a[64:67], v[176:191]
    v_rcp_f32 v39, v39
    v_mul_f32 v44, v44, v36
    ds_read_b64_tr_b16 v[88:89], v11 offset:38912
    v_mfma_f32_32x32x16_bf16 v[208:223], v[68:71], a[68:71], v[208:223]
    v_mul_f32 v45, v45, v37
    v_mul_f32 v46, v46, v38
    v_mul_f32 v47, v47, v39
    ds_read_b64_tr_b16 v[90:91], v11 offset:39424
    s_waitcnt lgkmcnt(6)
    v_mfma_f32_32x32x16_bf16 v[160:175], v[72:75], a[72:75], v[160:175]
    v_cvt_pk_bf16_f32 v26, v44, v45
    v_cvt_pk_bf16_f32 v27, v46, v47
    ds_read_b64_tr_b16 v[92:93], v11 offset:47104
    v_mfma_f32_32x32x16_bf16 v[192:207], v[72:75], a[76:79], v[192:207]
    buffer_store_dwordx4 v[24:27], v22, s[20:23], s28 offen offset:0 sc1
    v_mul_f32 v32, v104, v104
    v_mul_f32 v33, v105, v105
    ds_read_b64_tr_b16 v[94:95], v11 offset:47616
    v_mfma_f32_32x32x16_bf16 v[176:191], v[76:79], a[72:75], v[176:191]
    v_mul_f32 v34, v106, v106
    v_mul_f32 v35, v107, v107
    ds_read_b64_tr_b16 v[64:65], v11 offset:49152
    v_mfma_f32_32x32x16_bf16 v[208:223], v[76:79], a[76:79], v[208:223]
    v_fmaak_f32 v32, v23, v32, 0xc0135761
    v_fmaak_f32 v33, v23, v33, 0xc0135761
    v_fmaak_f32 v34, v23, v34, 0xc0135761
    ds_read_b64_tr_b16 v[66:67], v11 offset:49664
    s_waitcnt lgkmcnt(6)
    v_mfma_f32_32x32x16_bf16 v[160:175], v[80:83], a[80:83], v[160:175]
    v_fmaak_f32 v35, v23, v35, 0xc0135761
    v_mul_f32 v32, v32, v104
    ds_read_b64_tr_b16 v[68:69], v11 offset:57344
    v_mfma_f32_32x32x16_bf16 v[192:207], v[80:83], a[84:87], v[192:207]
    v_mul_f32 v33, v33, v105
    v_mul_f32 v34, v34, v106
    ds_read_b64_tr_b16 v[70:71], v11 offset:57856
    v_mfma_f32_32x32x16_bf16 v[176:191], v[84:87], a[80:83], v[176:191]
    v_mul_f32 v35, v35, v107
    v_exp_f32 v32, v32
    ds_read_b64_tr_b16 v[72:73], v11 offset:51200
    v_mfma_f32_32x32x16_bf16 v[208:223], v[84:87], a[84:87], v[208:223]
    v_exp_f32 v33, v33
    ds_read_b64_tr_b16 v[74:75], v11 offset:51712
    s_waitcnt lgkmcnt(6)
    v_mfma_f32_32x32x16_bf16 v[160:175], v[88:91], a[88:91], v[160:175]
    v_exp_f32 v34, v34
    ds_read_b64_tr_b16 v[76:77], v11 offset:59392
    v_mfma_f32_32x32x16_bf16 v[192:207], v[88:91], a[92:95], v[192:207]
    v_exp_f32 v35, v35
    v_mul_f32 v40, v104, v120
    ds_read_b64_tr_b16 v[78:79], v11 offset:59904
    v_mfma_f32_32x32x16_bf16 v[176:191], v[92:95], a[88:91], v[176:191]
    v_mul_f32 v41, v105, v121
    v_mul_f32 v42, v106, v122
    ds_read_b64_tr_b16 v[80:81], v11 offset:53248
    v_mfma_f32_32x32x16_bf16 v[208:223], v[92:95], a[92:95], v[208:223]
    v_mul_f32 v43, v107, v123
    v_add_f32 v32, 1.0, v32
    v_add_f32 v33, 1.0, v33
    ds_read_b64_tr_b16 v[82:83], v11 offset:53760
    s_barrier
    s_waitcnt lgkmcnt(6)
    v_mfma_f32_32x32x16_bf16 v[160:175], v[64:67], a[96:99], v[160:175]
    v_add_f32 v34, 1.0, v34
    v_add_f32 v35, 1.0, v35
    ds_read_b64_tr_b16 v[84:85], v11 offset:61440
    v_mfma_f32_32x32x16_bf16 v[192:207], v[64:67], a[100:103], v[192:207]
    v_rcp_f32 v32, v32
    s_add_u32 m0, s30, 0
    ds_read_b64_tr_b16 v[86:87], v11 offset:61952
    v_mfma_f32_32x32x16_bf16 v[176:191], v[68:71], a[96:99], v[176:191]
    v_rcp_f32 v33, v33
    buffer_load_dwordx4 v1, s[12:15], s27 offen lds
    ds_read_b64_tr_b16 v[88:89], v11 offset:55296
    v_mfma_f32_32x32x16_bf16 v[208:223], v[68:71], a[100:103], v[208:223]
    v_rcp_f32 v34, v34
    ds_read_b64_tr_b16 v[90:91], v11 offset:55808
    s_waitcnt lgkmcnt(6)
    v_mfma_f32_32x32x16_bf16 v[160:175], v[72:75], a[104:107], v[160:175]
    v_rcp_f32 v35, v35
    buffer_load_dwordx4 v2, s[12:15], s27 offen offset:1024 lds
    ds_read_b64_tr_b16 v[92:93], v11 offset:63488
    v_mfma_f32_32x32x16_bf16 v[192:207], v[72:75], a[108:111], v[192:207]
    v_mul_f32 v40, v40, v32
    v_mul_f32 v41, v41, v33
    v_mul_f32 v42, v42, v34
    ds_read_b64_tr_b16 v[94:95], v11 offset:64000
    v_mfma_f32_32x32x16_bf16 v[176:191], v[76:79], a[104:107], v[176:191]
    v_mul_f32 v43, v43, v35
    v_cvt_pk_bf16_f32 v28, v40, v41
    s_add_u32 m0, s30, 8192
    ds_read_b64_tr_b16 v[64:65], v12 offset:0
    v_mfma_f32_32x32x16_bf16 v[208:223], v[76:79], a[108:111], v[208:223]
    v_cvt_pk_bf16_f32 v29, v42, v43
    v_mul_f32 v36, v108, v108
    v_mul_f32 v37, v109, v109
    ds_read_b64_tr_b16 v[66:67], v12 offset:512
    s_waitcnt lgkmcnt(6)
    v_mfma_f32_32x32x16_bf16 v[160:175], v[80:83], a[112:115], v[160:175]
    v_mul_f32 v38, v110, v110
    v_mul_f32 v39, v111, v111
    buffer_load_dwordx4 v1, s[16:19], s27 offen lds
    ds_read_b64_tr_b16 v[68:69], v12 offset:8192
    v_mfma_f32_32x32x16_bf16 v[192:207], v[80:83], a[116:119], v[192:207]
    v_fmaak_f32 v36, v23, v36, 0xc0135761
    v_fmaak_f32 v37, v23, v37, 0xc0135761
    v_fmaak_f32 v38, v23, v38, 0xc0135761
    ds_read_b64_tr_b16 v[70:71], v12 offset:8704
    v_mfma_f32_32x32x16_bf16 v[176:191], v[84:87], a[112:115], v[176:191]
    v_fmaak_f32 v39, v23, v39, 0xc0135761
    v_mul_f32 v36, v36, v108
    buffer_load_dwordx4 v2, s[16:19], s27 offen offset:1024 lds
    ds_read_b64_tr_b16 v[72:73], v12 offset:2048
    v_mfma_f32_32x32x16_bf16 v[208:223], v[84:87], a[116:119], v[208:223]
    v_mul_f32 v37, v37, v109
    v_mul_f32 v38, v38, v110
    v_mul_f32 v39, v39, v111
    ds_read_b64_tr_b16 v[74:75], v12 offset:2560
    s_waitcnt lgkmcnt(6)
    v_mfma_f32_32x32x16_bf16 v[160:175], v[88:91], a[120:123], v[160:175]
    s_add_u32 s34, s34, 1
    s_cmp_eq_u32 s34, 9
    s_cselect_b32 s34, 0, s34
    s_mul_i32 s27, s34, 589824
    s_add_u32 s27, s27, s48
    s_add_u32 m0, s30, 16384
    ds_read_b64_tr_b16 v[76:77], v12 offset:10240
    v_mfma_f32_32x32x16_bf16 v[192:207], v[88:91], a[124:127], v[192:207]
    v_exp_f32 v36, v36
    ds_read_b64_tr_b16 v[78:79], v12 offset:10752
    v_mfma_f32_32x32x16_bf16 v[176:191], v[92:95], a[120:123], v[176:191]
    v_exp_f32 v37, v37
    buffer_load_dwordx4 v1, s[12:15], s27 offen lds
    ds_read_b64_tr_b16 v[80:81], v12 offset:4096
    v_mfma_f32_32x32x16_bf16 v[208:223], v[92:95], a[124:127], v[208:223]
    v_exp_f32 v38, v38
    ds_read_b64_tr_b16 v[82:83], v12 offset:4608
    s_waitcnt lgkmcnt(6)
    v_mfma_f32_32x32x16_bf16 v[160:175], v[64:67], a[128:131], v[160:175]
    v_exp_f32 v39, v39
    buffer_load_dwordx4 v2, s[12:15], s27 offen offset:1024 lds
    ds_read_b64_tr_b16 v[84:85], v12 offset:12288
    v_mfma_f32_32x32x16_bf16 v[192:207], v[64:67], a[132:135], v[192:207]
    v_mul_f32 v44, v108, v124
    v_mul_f32 v45, v109, v125
    v_mul_f32 v46, v110, v126
    ds_read_b64_tr_b16 v[86:87], v12 offset:12800
    v_mfma_f32_32x32x16_bf16 v[176:191], v[68:71], a[128:131], v[176:191]
    v_mul_f32 v47, v111, v127
    v_add_f32 v36, 1.0, v36
    s_add_u32 m0, s30, 24576
    ds_read_b64_tr_b16 v[88:89], v12 offset:6144
    v_mfma_f32_32x32x16_bf16 v[208:223], v[68:71], a[132:135], v[208:223]
    v_add_f32 v37, 1.0, v37
    v_add_f32 v38, 1.0, v38
    v_add_f32 v39, 1.0, v39
    ds_read_b64_tr_b16 v[90:91], v12 offset:6656
    s_waitcnt lgkmcnt(6)
    v_mfma_f32_32x32x16_bf16 v[160:175], v[72:75], a[136:139], v[160:175]
    v_rcp_f32 v36, v36
    buffer_load_dwordx4 v1, s[16:19], s27 offen lds
    ds_read_b64_tr_b16 v[92:93], v12 offset:14336
    v_mfma_f32_32x32x16_bf16 v[192:207], v[72:75], a[140:143], v[192:207]
    v_rcp_f32 v37, v37
    ds_read_b64_tr_b16 v[94:95], v12 offset:14848
    v_mfma_f32_32x32x16_bf16 v[176:191], v[76:79], a[136:139], v[176:191]
    v_rcp_f32 v38, v38
    buffer_load_dwordx4 v2, s[16:19], s27 offen offset:1024 lds
    ds_read_b64_tr_b16 v[64:65], v12 offset:16384
    v_mfma_f32_32x32x16_bf16 v[208:223], v[76:79], a[140:143], v[208:223]
    v_rcp_f32 v39, v39
    v_mul_f32 v44, v44, v36
    ds_read_b64_tr_b16 v[66:67], v12 offset:16896
    s_waitcnt lgkmcnt(6)
    v_mfma_f32_32x32x16_bf16 v[160:175], v[80:83], a[144:147], v[160:175]
    s_add_u32 s34, s34, 1
    s_cmp_eq_u32 s34, 9
    s_cselect_b32 s34, 0, s34
    s_mul_i32 s27, s34, 589824
    s_add_u32 s27, s27, s48
    s_add_u32 m0, s30, 32768
    ds_read_b64_tr_b16 v[68:69], v12 offset:24576
    v_mfma_f32_32x32x16_bf16 v[192:207], v[80:83], a[148:151], v[192:207]
    v_mul_f32 v45, v45, v37
    v_mul_f32 v46, v46, v38
    v_mul_f32 v47, v47, v39
    ds_read_b64_tr_b16 v[70:71], v12 offset:25088
    v_mfma_f32_32x32x16_bf16 v[176:191], v[84:87], a[144:147], v[176:191]
    v_cvt_pk_bf16_f32 v30, v44, v45
    v_cvt_pk_bf16_f32 v31, v46, v47
    buffer_load_dwordx4 v1, s[12:15], s27 offen lds
    ds_read_b64_tr_b16 v[72:73], v12 offset:18432
    v_mfma_f32_32x32x16_bf16 v[208:223], v[84:87], a[148:151], v[208:223]
    buffer_store_dwordx4 v[28:31], v22, s[20:23], s28 offen offset:1024 sc1
    s_add_u32 s28, s28, 331776
    v_mul_f32 v32, v128, v128
    ds_read_b64_tr_b16 v[74:75], v12 offset:18944
    s_waitcnt lgkmcnt(6)
    v_mfma_f32_32x32x16_bf16 v[160:175], v[88:91], a[152:155], v[160:175]
    v_mul_f32 v33, v129, v129
    v_mul_f32 v34, v130, v130
    buffer_load_dwordx4 v2, s[12:15], s27 offen offset:1024 lds
    ds_read_b64_tr_b16 v[76:77], v12 offset:26624
    v_mfma_f32_32x32x16_bf16 v[192:207], v[88:91], a[156:159], v[192:207]
    v_mul_f32 v35, v131, v131
    v_fmaak_f32 v32, v23, v32, 0xc0135761
    v_fmaak_f32 v33, v23, v33, 0xc0135761
    ds_read_b64_tr_b16 v[78:79], v12 offset:27136
    v_mfma_f32_32x32x16_bf16 v[176:191], v[92:95], a[152:155], v[176:191]
    v_fmaak_f32 v34, v23, v34, 0xc0135761
    v_fmaak_f32 v35, v23, v35, 0xc0135761
    s_add_u32 m0, s30, 40960
    ds_read_b64_tr_b16 v[80:81], v12 offset:20480
    v_mfma_f32_32x32x16_bf16 v[208:223], v[92:95], a[156:159], v[208:223]
    v_mul_f32 v32, v32, v128
    v_mul_f32 v33, v33, v129
    v_mul_f32 v34, v34, v130
    ds_read_b64_tr_b16 v[82:83], v12 offset:20992
    s_waitcnt lgkmcnt(6)
    v_mfma_f32_32x32x16_bf16 v[160:175], v[64:67], a[160:163], v[160:175]
    v_mul_f32 v35, v35, v131
    buffer_load_dwordx4 v1, s[16:19], s27 offen lds
    ds_read_b64_tr_b16 v[84:85], v12 offset:28672
    v_mfma_f32_32x32x16_bf16 v[192:207], v[64:67], a[164:167], v[192:207]
    v_exp_f32 v32, v32
    ds_read_b64_tr_b16 v[86:87], v12 offset:29184
    v_mfma_f32_32x32x16_bf16 v[176:191], v[68:71], a[160:163], v[176:191]
    v_exp_f32 v33, v33
    buffer_load_dwordx4 v2, s[16:19], s27 offen offset:1024 lds
    ds_read_b64_tr_b16 v[88:89], v12 offset:22528
    v_mfma_f32_32x32x16_bf16 v[208:223], v[68:71], a[164:167], v[208:223]
    v_exp_f32 v34, v34
    ds_read_b64_tr_b16 v[90:91], v12 offset:23040
    s_waitcnt lgkmcnt(6)
    v_mfma_f32_32x32x16_bf16 v[160:175], v[72:75], a[168:171], v[160:175]
    s_add_u32 s34, s34, 1
    s_cmp_eq_u32 s34, 9
    s_cselect_b32 s34, 0, s34
    s_mul_i32 s27, s34, 589824
    s_add_u32 s27, s27, s48
    ds_read_b64_tr_b16 v[92:93], v12 offset:30720
    v_mfma_f32_32x32x16_bf16 v[192:207], v[72:75], a[172:175], v[192:207]
    v_exp_f32 v35, v35
    v_mul_f32 v40, v128, v144
    ds_read_b64_tr_b16 v[94:95], v12 offset:31232
    v_mfma_f32_32x32x16_bf16 v[176:191], v[76:79], a[168:171], v[176:191]
    v_mul_f32 v41, v129, v145
    v_mul_f32 v42, v130, v146
    v_mul_f32 v43, v131, v147
    ds_read_b64_tr_b16 v[64:65], v12 offset:32768
    v_mfma_f32_32x32x16_bf16 v[208:223], v[76:79], a[172:175], v[208:223]
    v_add_f32 v32, 1.0, v32
    v_add_f32 v33, 1.0, v33
    v_add_f32 v34, 1.0, v34
    ds_read_b64_tr_b16 v[66:67], v12 offset:33280
    s_waitcnt lgkmcnt(6)
    v_mfma_f32_32x32x16_bf16 v[160:175], v[80:83], a[176:179], v[160:175]
    v_add_f32 v35, 1.0, v35
    v_rcp_f32 v32, v32
    ds_read_b64_tr_b16 v[68:69], v12 offset:40960
    v_mfma_f32_32x32x16_bf16 v[192:207], v[80:83], a[180:183], v[192:207]
    v_rcp_f32 v33, v33
    ds_read_b64_tr_b16 v[70:71], v12 offset:41472
    v_mfma_f32_32x32x16_bf16 v[176:191], v[84:87], a[176:179], v[176:191]
    v_rcp_f32 v34, v34
    ds_read_b64_tr_b16 v[72:73], v12 offset:34816
    v_mfma_f32_32x32x16_bf16 v[208:223], v[84:87], a[180:183], v[208:223]
    v_rcp_f32 v35, v35
    v_mul_f32 v40, v40, v32
    ds_read_b64_tr_b16 v[74:75], v12 offset:35328
    s_waitcnt lgkmcnt(6)
    v_mfma_f32_32x32x16_bf16 v[160:175], v[88:91], a[184:187], v[160:175]
    v_mul_f32 v41, v41, v33
    v_mul_f32 v42, v42, v34
    v_mul_f32 v43, v43, v35
    ds_read_b64_tr_b16 v[76:77], v12 offset:43008
    v_mfma_f32_32x32x16_bf16 v[192:207], v[88:91], a[188:191], v[192:207]
    v_cvt_pk_bf16_f32 v24, v40, v41
    v_cvt_pk_bf16_f32 v25, v42, v43
    v_mul_f32 v36, v132, v132
    ds_read_b64_tr_b16 v[78:79], v12 offset:43520
    v_mfma_f32_32x32x16_bf16 v[176:191], v[92:95], a[184:187], v[176:191]
    v_mul_f32 v37, v133, v133
    v_mul_f32 v38, v134, v134
    v_mul_f32 v39, v135, v135
    ds_read_b64_tr_b16 v[80:81], v12 offset:36864
    v_mfma_f32_32x32x16_bf16 v[208:223], v[92:95], a[188:191], v[208:223]
    v_fmaak_f32 v36, v23, v36, 0xc0135761
    v_fmaak_f32 v37, v23, v37, 0xc0135761
    v_fmaak_f32 v38, v23, v38, 0xc0135761
    ds_read_b64_tr_b16 v[82:83], v12 offset:37376
    s_waitcnt vmcnt(16)
    s_barrier
    s_cmp_eq_u32 s29, 1
    s_cbranch_scc0 L_gx_nosig
    s_cmp_eq_u32 s24, 0
    s_cbranch_scc0 L_gx_nosig
    v_readfirstlane_b32 s38, v60
    s_mov_b32 s39, 0
L_gx_zr:
    s_cmp_ge_u32 s38, 273
    s_cbranch_scc1 L_gx_zok
    s_add_u32 s39, s39, 1
    s_cmp_gt_u32 s39, 200000
    s_cbranch_scc1 L_gx_zok
    s_sleep 6
    v_mov_b32 v61, 0
    global_load_dword v60, v61, s[68:69] sc1
    s_waitcnt vmcnt(0)
    v_readfirstlane_b32 s38, v60
    s_branch L_gx_zr
L_gx_zok:
    s_mul_i32 s38, s36, 43
    s_lshr_b32 s38, s38, 8
    s_lshl_b32 s39, s37, 2
    s_add_u32 s38, s38, s39
    s_add_u32 s38, s38, 48
    s_lshl_b32 s38, s38, 7
    s_add_u32 s72, s70, 22806528
    s_addc_u32 s73, s71, 0
    v_mov_b32 v61, s38
    v_mov_b32 v62, 1
    v_cmp_eq_u32 vcc, 0, v0
    s_and_saveexec_b64 s[74:75], vcc
    global_atomic_add v61, v62, s[72:73] sc1
    s_mov_b64 exec, s[74:75]
L_gx_nosig:
    s_nop 0
    s_waitcnt lgkmcnt(6)
    v_mfma_f32_32x32x16_bf16 v[160:175], v[64:67], a[192:195], v[160:175]
    v_fmaak_f32 v39, v23, v39, 0xc0135761
    v_mul_f32 v36, v36, v132
    v_mul_f32 v37, v37, v133
    ds_read_b64_tr_b16 v[84:85], v12 offset:45056
    v_mfma_f32_32x32x16_bf16 v[192:207], v[64:67], a[196:199], v[192:207]
    v_mul_f32 v38, v38, v134
    v_mul_f32 v39, v39, v135
    s_add_u32 m0, s30, 49152
    ds_read_b64_tr_b16 v[86:87], v12 offset:45568
    v_mfma_f32_32x32x16_bf16 v[176:191], v[68:71], a[192:195], v[176:191]
    v_exp_f32 v36, v36
    buffer_load_dwordx4 v1, s[12:15], s27 offen lds
    ds_read_b64_tr_b16 v[88:89], v12 offset:38912
    v_mfma_f32_32x32x16_bf16 v[208:223], v[68:71], a[196:199], v[208:223]
    v_exp_f32 v37, v37
    ds_read_b64_tr_b16 v[90:91], v12 offset:39424
    s_waitcnt lgkmcnt(6)
    v_mfma_f32_32x32x16_bf16 v[160:175], v[72:75], a[200:203], v[160:175]
    v_exp_f32 v38, v38
    buffer_load_dwordx4 v2, s[12:15], s27 offen offset:1024 lds
    ds_read_b64_tr_b16 v[92:93], v12 offset:47104
    v_mfma_f32_32x32x16_bf16 v[192:207], v[72:75], a[204:207], v[192:207]
    v_exp_f32 v39, v39
    v_mul_f32 v44, v132, v148
    ds_read_b64_tr_b16 v[94:95], v12 offset:47616
    v_mfma_f32_32x32x16_bf16 v[176:191], v[76:79], a[200:203], v[176:191]
    v_mul_f32 v45, v133, v149
    v_mul_f32 v46, v134, v150
    s_add_u32 m0, s30, 57344
    ds_read_b64_tr_b16 v[64:65], v12 offset:49152
    v_mfma_f32_32x32x16_bf16 v[208:223], v[76:79], a[204:207], v[208:223]
    v_mul_f32 v47, v135, v151
    v_add_f32 v36, 1.0, v36
    v_add_f32 v37, 1.0, v37
    ds_read_b64_tr_b16 v[66:67], v12 offset:49664
    s_waitcnt lgkmcnt(6)
    v_mfma_f32_32x32x16_bf16 v[160:175], v[80:83], a[208:211], v[160:175]
    v_add_f32 v38, 1.0, v38
    v_add_f32 v39, 1.0, v39
    buffer_load_dwordx4 v1, s[16:19], s27 offen lds
    ds_read_b64_tr_b16 v[68:69], v12 offset:57344
    v_mfma_f32_32x32x16_bf16 v[192:207], v[80:83], a[212:215], v[192:207]
    v_rcp_f32 v36, v36
    ds_read_b64_tr_b16 v[70:71], v12 offset:57856
    v_mfma_f32_32x32x16_bf16 v[176:191], v[84:87], a[208:211], v[176:191]
    v_rcp_f32 v37, v37
    buffer_load_dwordx4 v2, s[16:19], s27 offen offset:1024 lds
    ds_read_b64_tr_b16 v[72:73], v12 offset:51200
    v_mfma_f32_32x32x16_bf16 v[208:223], v[84:87], a[212:215], v[208:223]
    v_rcp_f32 v38, v38
    ds_read_b64_tr_b16 v[74:75], v12 offset:51712
    s_waitcnt lgkmcnt(6)
    v_mfma_f32_32x32x16_bf16 v[160:175], v[88:91], a[216:219], v[160:175]
    s_add_u32 s34, s34, 1
    s_cmp_eq_u32 s34, 9
    s_cselect_b32 s34, 0, s34
    s_mul_i32 s27, s34, 589824
    s_add_u32 s27, s27, s48
    s_add_u32 m0, s30, 65536
    ds_read_b64_tr_b16 v[76:77], v12 offset:59392
    v_mfma_f32_32x32x16_bf16 v[192:207], v[88:91], a[220:223], v[192:207]
    v_rcp_f32 v39, v39
    v_mul_f32 v44, v44, v36
    ds_read_b64_tr_b16 v[78:79], v12 offset:59904
    v_mfma_f32_32x32x16_bf16 v[176:191], v[92:95], a[216:219], v[176:191]
    v_mul_f32 v45, v45, v37
    v_mul_f32 v46, v46, v38
    buffer_load_dwordx4 v1, s[12:15], s27 offen lds
    ds_read_b64_tr_b16 v[80:81], v12 offset:53248
    v_mfma_f32_32x32x16_bf16 v[208:223], v[92:95], a[220:223], v[208:223]
    v_mul_f32 v47, v47, v39
    v_cvt_pk_bf16_f32 v26, v44, v45
    v_cvt_pk_bf16_f32 v27, v46, v47
    ds_read_b64_tr_b16 v[82:83], v12 offset:53760
    s_waitcnt lgkmcnt(6)
    v_mfma_f32_32x32x16_bf16 v[160:175], v[64:67], a[224:227], v[160:175]
    buffer_store_dwordx4 v[24:27], v22, s[20:23], s28 offen offset:0 sc1
    v_mul_f32 v32, v136, v136
    buffer_load_dwordx4 v2, s[12:15], s27 offen offset:1024 lds
    ds_read_b64_tr_b16 v[84:85], v12 offset:61440
    v_mfma_f32_32x32x16_bf16 v[192:207], v[64:67], a[228:231], v[192:207]
    v_mul_f32 v33, v137, v137
    v_mul_f32 v34, v138, v138
    v_mul_f32 v35, v139, v139
    ds_read_b64_tr_b16 v[86:87], v12 offset:61952
    v_mfma_f32_32x32x16_bf16 v[176:191], v[68:71], a[224:227], v[176:191]
    v_fmaak_f32 v32, v23, v32, 0xc0135761
    v_fmaak_f32 v33, v23, v33, 0xc0135761
    s_add_u32 m0, s30, 73728
    ds_read_b64_tr_b16 v[88:89], v12 offset:55296
    v_mfma_f32_32x32x16_bf16 v[208:223], v[68:71], a[228:231], v[208:223]
    v_fmaak_f32 v34, v23, v34, 0xc0135761
    v_fmaak_f32 v35, v23, v35, 0xc0135761
    v_mul_f32 v32, v32, v136
    ds_read_b64_tr_b16 v[90:91], v12 offset:55808
    s_waitcnt lgkmcnt(6)
    v_mfma_f32_32x32x16_bf16 v[160:175], v[72:75], a[232:235], v[160:175]
    v_mul_f32 v33, v33, v137
    v_mul_f32 v34, v34, v138
    buffer_load_dwordx4 v1, s[16:19], s27 offen lds
    ds_read_b64_tr_b16 v[92:93], v12 offset:63488
    v_mfma_f32_32x32x16_bf16 v[192:207], v[72:75], a[236:239], v[192:207]
    v_mul_f32 v35, v35, v139
    v_exp_f32 v32, v32
    ds_read_b64_tr_b16 v[94:95], v12 offset:64000
    v_mfma_f32_32x32x16_bf16 v[176:191], v[76:79], a[232:235], v[176:191]
    v_exp_f32 v33, v33
    buffer_load_dwordx4 v2, s[16:19], s27 offen offset:1024 lds
    ds_read_b64_tr_b16 v[64:65], v13 offset:0
    v_mfma_f32_32x32x16_bf16 v[208:223], v[76:79], a[236:239], v[208:223]
    v_exp_f32 v34, v34
    ds_read_b64_tr_b16 v[66:67], v13 offset:512
    s_waitcnt lgkmcnt(6)
    v_mfma_f32_32x32x16_bf16 v[160:175], v[80:83], a[240:243], v[160:175]
    v_exp_f32 v35, v35
    s_add_u32 s34, s34, 1
    s_cmp_eq_u32 s34, 9
    s_cselect_b32 s34, 0, s34
    s_mul_i32 s27, s34, 589824
    s_add_u32 s27, s27, s48
    s_add_u32 m0, s30, 81920
    ds_read_b64_tr_b16 v[68:69], v13 offset:8192
    v_mfma_f32_32x32x16_bf16 v[192:207], v[80:83], a[244:247], v[192:207]
    v_mul_f32 v40, v136, v152
    v_mul_f32 v41, v137, v153
    v_mul_f32 v42, v138, v154
    ds_read_b64_tr_b16 v[70:71], v13 offset:8704
    v_mfma_f32_32x32x16_bf16 v[176:191], v[84:87], a[240:243], v[176:191]
    v_mul_f32 v43, v139, v155
    v_add_f32 v32, 1.0, v32
    buffer_load_dwordx4 v1, s[12:15], s27 offen lds
    ds_read_b64_tr_b16 v[72:73], v13 offset:2048
    v_mfma_f32_32x32x16_bf16 v[208:223], v[84:87], a[244:247], v[208:223]
    v_add_f32 v33, 1.0, v33
    v_add_f32 v34, 1.0, v34
    v_add_f32 v35, 1.0, v35
    ds_read_b64_tr_b16 v[74:75], v13 offset:2560
    s_waitcnt lgkmcnt(6)
    v_mfma_f32_32x32x16_bf16 v[160:175], v[88:91], a[248:251], v[160:175]
    v_rcp_f32 v32, v32
    buffer_load_dwordx4 v2, s[12:15], s27 offen offset:1024 lds
    ds_read_b64_tr_b16 v[76:77], v13 offset:10240
    v_mfma_f32_32x32x16_bf16 v[192:207], v[88:91], a[252:255], v[192:207]
    v_rcp_f32 v33, v33
    ds_read_b64_tr_b16 v[78:79], v13 offset:10752
    v_mfma_f32_32x32x16_bf16 v[176:191], v[92:95], a[248:251], v[176:191]
    v_rcp_f32 v34, v34
    s_add_u32 m0, s30, 90112
    ds_read_b64_tr_b16 v[80:81], v13 offset:4096
    v_mfma_f32_32x32x16_bf16 v[208:223], v[92:95], a[252:255], v[208:223]
    v_rcp_f32 v35, v35
    v_mul_f32 v40, v40, v32
    ds_read_b64_tr_b16 v[82:83], v13 offset:4608
    s_waitcnt lgkmcnt(6)
    v_mfma_f32_32x32x16_bf16 v[160:175], v[64:67], v[224:227], v[160:175]
    v_mul_f32 v41, v41, v33
    v_mul_f32 v42, v42, v34
    buffer_load_dwordx4 v1, s[16:19], s27 offen lds
    ds_read_b64_tr_b16 v[84:85], v13 offset:12288
    v_mfma_f32_32x32x16_bf16 v[192:207], v[64:67], v[228:231], v[192:207]
    v_mul_f32 v43, v43, v35
    v_cvt_pk_bf16_f32 v28, v40, v41
    v_cvt_pk_bf16_f32 v29, v42, v43
    ds_read_b64_tr_b16 v[86:87], v13 offset:12800
    v_mfma_f32_32x32x16_bf16 v[176:191], v[68:71], v[224:227], v[176:191]
    v_mul_f32 v36, v140, v140
    v_mul_f32 v37, v141, v141
    buffer_load_dwordx4 v2, s[16:19], s27 offen offset:1024 lds
    ds_read_b64_tr_b16 v[88:89], v13 offset:6144
    v_mfma_f32_32x32x16_bf16 v[208:223], v[68:71], v[228:231], v[208:223]
    v_mul_f32 v38, v142, v142
    v_mul_f32 v39, v143, v143
    v_fmaak_f32 v36, v23, v36, 0xc0135761
    ds_read_b64_tr_b16 v[90:91], v13 offset:6656
    s_waitcnt lgkmcnt(6)
    v_mfma_f32_32x32x16_bf16 v[160:175], v[72:75], v[232:235], v[160:175]
    v_fmaak_f32 v37, v23, v37, 0xc0135761
    v_fmaak_f32 v38, v23, v38, 0xc0135761
    s_add_u32 s34, s34, 1
    s_cmp_eq_u32 s34, 9
    s_cselect_b32 s34, 0, s34
    s_mul_i32 s27, s34, 589824
    s_add_u32 s27, s27, s48
    ds_read_b64_tr_b16 v[92:93], v13 offset:14336
    v_mfma_f32_32x32x16_bf16 v[192:207], v[72:75], v[236:239], v[192:207]
    v_fmaak_f32 v39, v23, v39, 0xc0135761
    v_mul_f32 v36, v36, v140
    v_mul_f32 v37, v37, v141
    ds_read_b64_tr_b16 v[94:95], v13 offset:14848
    s_waitcnt vmcnt(13)
    s_barrier
    v_add_u32 v11, 0, v7
    v_add_u32 v12, 65536, v7
    v_add_u32 v13, 131072, v7
    v_mfma_f32_32x32x16_bf16 v[176:191], v[76:79], v[232:235], v[176:191]
    v_mul_f32 v38, v38, v142
    v_mul_f32 v39, v39, v143
    ds_read_b64_tr_b16 v[64:65], v11 offset:0
    v_mfma_f32_32x32x16_bf16 v[208:223], v[76:79], v[236:239], v[208:223]
    v_exp_f32 v36, v36
    ds_read_b64_tr_b16 v[66:67], v11 offset:512
    s_waitcnt lgkmcnt(6)
    v_mfma_f32_32x32x16_bf16 v[160:175], v[80:83], v[240:243], v[160:175]
    v_exp_f32 v37, v37
    ds_read_b64_tr_b16 v[68:69], v11 offset:8192
    v_mfma_f32_32x32x16_bf16 v[192:207], v[80:83], v[244:247], v[192:207]
    v_exp_f32 v38, v38
    ds_read_b64_tr_b16 v[70:71], v11 offset:8704
    v_mfma_f32_32x32x16_bf16 v[176:191], v[84:87], v[240:243], v[176:191]
    global_load_dword v49, v48, s[64:65] sc1
    v_exp_f32 v39, v39
    v_mul_f32 v44, v140, v156
    ds_read_b64_tr_b16 v[72:73], v11 offset:2048
    v_mfma_f32_32x32x16_bf16 v[208:223], v[84:87], v[244:247], v[208:223]
    v_mul_f32 v45, v141, v157
    v_mul_f32 v46, v142, v158
    v_mul_f32 v47, v143, v159
    ds_read_b64_tr_b16 v[74:75], v11 offset:2560
    s_waitcnt lgkmcnt(6)
    v_mfma_f32_32x32x16_bf16 v[160:175], v[88:91], v[248:251], v[160:175]
    v_add_f32 v36, 1.0, v36
    v_add_f32 v37, 1.0, v37
    v_add_f32 v38, 1.0, v38
    ds_read_b64_tr_b16 v[76:77], v11 offset:10240
    v_mfma_f32_32x32x16_bf16 v[192:207], v[88:91], v[252:255], v[192:207]
    v_add_f32 v39, 1.0, v39
    v_rcp_f32 v36, v36
    ds_read_b64_tr_b16 v[78:79], v11 offset:10752
    v_mfma_f32_32x32x16_bf16 v[176:191], v[92:95], v[248:251], v[176:191]
    v_rcp_f32 v37, v37
    ds_read_b64_tr_b16 v[80:81], v11 offset:4096
    v_mfma_f32_32x32x16_bf16 v[208:223], v[92:95], v[252:255], v[208:223]
    v_rcp_f32 v38, v38
    ds_read_b64_tr_b16 v[82:83], v11 offset:4608
    v_rcp_f32 v39, v39
    v_mul_f32 v44, v44, v36
    v_mul_f32 v45, v45, v37
    v_mul_f32 v46, v46, v38
    v_mul_f32 v47, v47, v39
    v_cvt_pk_bf16_f32 v30, v44, v45
    v_cvt_pk_bf16_f32 v31, v46, v47
    buffer_store_dwordx4 v[28:31], v22, s[20:23], s28 offen offset:1024 sc1
    s_sub_u32 s28, s28, 329728
    s_barrier
    s_add_u32 s29, s29, 1
    s_cmp_lt_u32 s29, 2
    s_cbranch_scc1 L_gx_loop
    s_waitcnt lgkmcnt(0)
    s_waitcnt vmcnt(1)
    s_barrier
    v_mov_b32 v25, v49
    s_add_u32 s64, s70, 22806528
    s_addc_u32 s65, s71, 0
    s_load_dwordx2 s[40:41], s[0:1], 24
    s_load_dwordx2 s[42:43], s[0:1], 56
    s_load_dwordx2 s[44:45], s[0:1], 72
    s_mul_i32 s5, s92, 171
    s_lshr_b32 s5, s5, 9
    s_mul_i32 s6, s5, 3
    s_sub_u32 s6, s92, s6
    v_and_b32 v1, 63, v0
    v_lshlrev_b32 v20, 4, v1
    s_mul_i32 s48, s93, 192
    s_cmp_eq_u32 s90, 1
    s_cselect_b64 s[50:51], -1, 0
    v_add_u32 v4, s48, v1
    v_mul_u32_u24 v5, 0xaab, v4
    v_lshrrev_b32 v5, 16, v5
    v_mul_u32_u24 v6, 24, v5
    v_sub_u32 v6, v4, v6
    v_bfe_u32 v7, v5, 1, 1
    v_bfe_u32 v4, v5, 3, 1
    v_lshlrev_b32 v4, 1, v4
    v_or_b32 v7, v7, v4
    v_lshrrev_b32 v4, 1, v6
    v_xor_b32 v4, v4, v7
    v_lshlrev_b32 v4, 5, v4
    v_and_b32 v6, 1, v6
    v_lshlrev_b32 v6, 4, v6
    v_add3_u32 v4, v4, v6, 0
    v_add_u32 v31, 4096, v4
    v_and_b32 v6, 16, v5
    v_bfe_u32 v7, v5, 3, 1
    v_lshl_add_u32 v6, v7, 2, v6
    v_and_b32 v7, 3, v5
    v_add_u32 v6, v6, v7
    v_bfe_u32 v7, v5, 2, 1
    v_lshl_add_u32 v6, v7, 3, v6
    v_mul_u32_u24 v6, 0x480, v6
    v_add_u32 v17, v6, v31
    v_add_u32 v4, s48, v1
    v_add_u32 v4, 64, v4
    v_mul_u32_u24 v5, 0xaab, v4
    v_lshrrev_b32 v5, 16, v5
    v_mul_u32_u24 v6, 24, v5
    v_sub_u32 v6, v4, v6
    v_bfe_u32 v7, v5, 1, 1
    v_bfe_u32 v4, v5, 3, 1
    v_lshlrev_b32 v4, 1, v4
    v_or_b32 v7, v7, v4
    v_lshrrev_b32 v4, 1, v6
    v_xor_b32 v4, v4, v7
    v_lshlrev_b32 v4, 5, v4
    v_and_b32 v6, 1, v6
    v_lshlrev_b32 v6, 4, v6
    v_add3_u32 v4, v4, v6, 0
    v_add_u32 v31, 3072, v4
    v_and_b32 v6, 16, v5
    v_bfe_u32 v7, v5, 3, 1
    v_lshl_add_u32 v6, v7, 2, v6
    v_and_b32 v7, 3, v5
    v_add_u32 v6, v6, v7
    v_bfe_u32 v7, v5, 2, 1
    v_lshl_add_u32 v6, v7, 3, v6
    v_mul_u32_u24 v6, 0x480, v6
    v_add_u32 v18, v6, v31
    v_add_u32 v4, s48, v1
    v_add_u32 v4, 128, v4
    v_mul_u32_u24 v5, 0xaab, v4
    v_lshrrev_b32 v5, 16, v5
    v_mul_u32_u24 v6, 24, v5
    v_sub_u32 v6, v4, v6
    v_bfe_u32 v7, v5, 1, 1
    v_bfe_u32 v4, v5, 3, 1
    v_lshlrev_b32 v4, 1, v4
    v_or_b32 v7, v7, v4
    v_lshrrev_b32 v4, 1, v6
    v_xor_b32 v4, v4, v7
    v_lshlrev_b32 v4, 5, v4
    v_and_b32 v6, 1, v6
    v_lshlrev_b32 v6, 4, v6
    v_add3_u32 v4, v4, v6, 0
    v_add_u32 v31, 2048, v4
    v_and_b32 v6, 16, v5
    v_bfe_u32 v7, v5, 3, 1
    v_lshl_add_u32 v6, v7, 2, v6
    v_and_b32 v7, 3, v5
    v_add_u32 v6, v6, v7
    v_bfe_u32 v7, v5, 2, 1
    v_lshl_add_u32 v6, v7, 3, v6
    v_mul_u32_u24 v6, 0x480, v6
    v_add_u32 v19, v6, v31
    v_lshrrev_b32 v2, 4, v1
    v_and_b32 v3, 15, v1
    v_lshrrev_b32 v4, 2, v3
    v_and_b32 v5, 3, v3
    v_lshlrev_b32 v6, 3, v2
    v_add_u32 v6, v6, v4
    v_mul_u32_u24 v6, 0x180, v6
    v_lshlrev_b32 v5, 3, v5
    v_add_u32 v6, v6, v5
    v_lshrrev_b32 v4, 1, v4
    v_and_b32 v5, 1, v2
    v_lshlrev_b32 v5, 1, v5
    v_or_b32 v4, v4, v5
    v_xor_b32 v5, 0, v4
    v_lshlrev_b32 v5, 5, v5
    v_add_u32 v8, v5, v6
    v_xor_b32 v5, 1, v4
    v_lshlrev_b32 v5, 5, v5
    v_add_u32 v9, v5, v6
    v_xor_b32 v5, 2, v4
    v_lshlrev_b32 v5, 5, v5
    v_add_u32 v10, v5, v6
    v_xor_b32 v5, 3, v4
    v_lshlrev_b32 v5, 5, v5
    v_add_u32 v11, v5, v6
    v_lshrrev_b32 v4, 1, v2
    v_lshlrev_b32 v4, 10, v4
    v_and_b32 v5, 1, v2
    v_lshlrev_b32 v5, 9, v5
    v_lshlrev_b32 v6, 4, v3
    v_add3_u32 v12, v4, v5, v6
    s_waitcnt lgkmcnt(0)
    s_cmp_eq_u32 s90, 1
    s_cselect_b32 s4, s40, s42
    s_cselect_b32 s7, s41, s43
    s_mov_b32 s62, 5312512
    s_cselect_b32 s62, 667648, s62
    s_mov_b32 s31, 36864
    s_cselect_b32 s31, 9216, s31
    s_mov_b32 s32, 36864
    s_cselect_b32 s32, 73728, s32
    s_mov_b32 s46, 110592
    s_cselect_b32 s46, 73728, s46
    s_mov_b32 s47, 110592
    s_cselect_b32 s47, 73728, s47
    s_mov_b32 s52, 2048
    s_cselect_b32 s52, 2048, s52
    s_mov_b32 s53, 2048
    s_cselect_b32 s53, 2048, s53
    s_mov_b32 s54, 6144
    s_cselect_b32 s54, 2048, s54
    s_mov_b32 s55, 6144
    s_cselect_b32 s55, 2048, s55
    s_mov_b32 s60, 4293787648
    s_cselect_b32 s60, 0, s60
    s_mov_b32 s61, 4294901760
    s_cselect_b32 s61, 0, s61
    s_mov_b32 s36, 3
    s_cselect_b32 s37, 1, 99
    s_cselect_b32 s67, 99, 1
    s_cselect_b32 s66, 1, 99
    s_mul_i32 s63, s91, 36
    s_cselect_b32 s63, 144, s63
    s_mul_i32 s56, s63, 36864
    s_cselect_b32 s30, 0, s56
    s_mul_i32 s57, s6, 384
    s_add_u32 s24, s4, s57
    s_addc_u32 s25, s7, 0
    s_sub_u32 s24, s24, 4096
    s_subb_u32 s25, s25, 0
    s_sub_u32 s26, s62, s57
    s_mov_b32 s27, 0x20000
    s_mov_b32 s16, s70
    s_mov_b32 s17, s71
    s_mov_b32 s18, 21233664
    s_mov_b32 s19, 0x20000
    s_lshl_b32 s57, s5, 2
    s_add_u32 s57, s57, s93
    s_mul_i32 s48, s57, 162
    s_add_u32 s48, s48, s63
    s_lshl_b32 s33, s48, 11
    s_mul_i32 s29, s93, 3072
    s_add_u32 m0, s29, 0
    s_nop 0
    buffer_load_dwordx4 v17, s[24:27], s30 offen offset:0 lds
    buffer_load_dwordx4 v18, s[24:27], s30 offen offset:1024 lds
    buffer_load_dwordx4 v19, s[24:27], s30 offen offset:2048 lds
    s_add_u32 s30, s30, s31
    s_add_u32 m0, s29, 12288
    s_nop 0
    buffer_load_dwordx4 v17, s[24:27], s30 offen offset:0 lds
    buffer_load_dwordx4 v18, s[24:27], s30 offen offset:1024 lds
    buffer_load_dwordx4 v19, s[24:27], s30 offen offset:2048 lds
    s_add_u32 s30, s30, s32
    s_add_u32 m0, s29, 24576
    s_nop 0
    buffer_load_dwordx4 v17, s[24:27], s30 offen offset:0 lds
    buffer_load_dwordx4 v18, s[24:27], s30 offen offset:1024 lds
    buffer_load_dwordx4 v19, s[24:27], s30 offen offset:2048 lds
    s_add_u32 s30, s30, s31
    s_add_u32 m0, s29, 36864
    s_nop 0
    buffer_load_dwordx4 v17, s[24:27], s30 offen offset:0 lds
    buffer_load_dwordx4 v18, s[24:27], s30 offen offset:1024 lds
    buffer_load_dwordx4 v19, s[24:27], s30 offen offset:2048 lds
    s_add_u32 s30, s30, s46
    s_cmp_eq_u32 s93, 0
    s_cbranch_scc0 L_p2_poll1f_ok
    v_readfirstlane_b32 s38, v25
    s_nop 1
    s_cmp_ge_u32 s38, s97
    s_cbranch_scc1 L_p2_poll1f_ok
    s_lshl_b32 s38, s96, 7
    v_mov_b32 v2, s38
    s_mov_b32 s39, 0
L_p2_poll1f:
    global_load_dword v3, v2, s[64:65] sc1
    s_waitcnt vmcnt(0)
    v_readfirstlane_b32 s38, v3
    s_add_u32 s39, s39, 1
    s_cmp_ge_u32 s38, s97
    s_cbranch_scc1 L_p2_poll1f_ok
    s_cmp_gt_u32 s39, 200000
    s_cbranch_scc1 L_p2_poll1f_ok
    s_sleep 6
    s_branch L_p2_poll1f
L_p2_poll1f_ok:
    s_barrier
    s_lshl_b32 s38, s95, 7
    v_mov_b32 v7, s38
    buffer_load_dwordx4 a[0:3], v12, s[16:19], s33 offen sc1
    buffer_load_dwordx4 a[4:7], v12, s[16:19], s33 offen offset:256 sc1
    s_add_u32 s33, s33, s52
    buffer_load_dwordx4 a[8:11], v12, s[16:19], s33 offen sc1
    buffer_load_dwordx4 a[12:15], v12, s[16:19], s33 offen offset:256 sc1
    s_add_u32 s33, s33, s53
    buffer_load_dwordx4 a[16:19], v12, s[16:19], s33 offen sc1
    buffer_load_dwordx4 a[20:23], v12, s[16:19], s33 offen offset:256 sc1
    s_add_u32 s33, s33, s52
    buffer_load_dwordx4 a[24:27], v12, s[16:19], s33 offen sc1
    buffer_load_dwordx4 a[28:31], v12, s[16:19], s33 offen offset:256 sc1
    s_add_u32 s33, s33, s54
    v_mov_b32 v64, 0
    v_mov_b32 v65, 0
    v_mov_b32 v66, 0
    v_mov_b32 v67, 0
    v_mov_b32 v68, 0
    v_mov_b32 v69, 0
    v_mov_b32 v70, 0
    v_mov_b32 v71, 0
    v_mov_b32 v72, 0
    v_mov_b32 v73, 0
    v_mov_b32 v74, 0
    v_mov_b32 v75, 0
    v_mov_b32 v76, 0
    v_mov_b32 v77, 0
    v_mov_b32 v78, 0
    v_mov_b32 v79, 0
    v_mov_b32 v80, 0
    v_mov_b32 v81, 0
    v_mov_b32 v82, 0
    v_mov_b32 v83, 0
    v_mov_b32 v84, 0
    v_mov_b32 v85, 0
    v_mov_b32 v86, 0
    v_mov_b32 v87, 0
    v_mov_b32 v88, 0
    v_mov_b32 v89, 0
    v_mov_b32 v90, 0
    v_mov_b32 v91, 0
    v_mov_b32 v92, 0
    v_mov_b32 v93, 0
    v_mov_b32 v94, 0
    v_mov_b32 v95, 0
    v_mov_b32 v96, 0
    v_mov_b32 v97, 0
    v_mov_b32 v98, 0
    v_mov_b32 v99, 0
    v_mov_b32 v100, 0
    v_mov_b32 v101, 0
    v_mov_b32 v102, 0
    v_mov_b32 v103, 0
    v_mov_b32 v104, 0
    v_mov_b32 v105, 0
    v_mov_b32 v106, 0
    v_mov_b32 v107, 0
    v_mov_b32 v108, 0
    v_mov_b32 v109, 0
    v_mov_b32 v110, 0
    v_mov_b32 v111, 0
    v_mov_b32 v112, 0
    v_mov_b32 v113, 0
    v_mov_b32 v114, 0
    v_mov_b32 v115, 0
    v_mov_b32 v116, 0
    v_mov_b32 v117, 0
    v_mov_b32 v118, 0
    v_mov_b32 v119, 0
    v_mov_b32 v120, 0
    v_mov_b32 v121, 0
    v_mov_b32 v122, 0
    v_mov_b32 v123, 0
    v_mov_b32 v124, 0
    v_mov_b32 v125, 0
    v_mov_b32 v126, 0
    v_mov_b32 v127, 0
    v_mov_b32 v128, 0
    v_mov_b32 v129, 0
    v_mov_b32 v130, 0
    v_mov_b32 v131, 0
    v_mov_b32 v132, 0
    v_mov_b32 v133, 0
    v_mov_b32 v134, 0
    v_mov_b32 v135, 0
    v_mov_b32 v136, 0
    v_mov_b32 v137, 0
    v_mov_b32 v138, 0
    v_mov_b32 v139, 0
    v_mov_b32 v140, 0
    v_mov_b32 v141, 0
    v_mov_b32 v142, 0
    v_mov_b32 v143, 0
    v_mov_b32 v144, 0
    v_mov_b32 v145, 0
    v_mov_b32 v146, 0
    v_mov_b32 v147, 0
    v_mov_b32 v148, 0
    v_mov_b32 v149, 0
    v_mov_b32 v150, 0
    v_mov_b32 v151, 0
    v_mov_b32 v152, 0
    v_mov_b32 v153, 0
    v_mov_b32 v154, 0
    v_mov_b32 v155, 0
    v_mov_b32 v156, 0
    v_mov_b32 v157, 0
    v_mov_b32 v158, 0
    v_mov_b32 v159, 0
    v_mov_b32 v50, 0xbdd2d3e8
    v_mov_b32 v51, 0xbdd2d3e8
    v_mov_b32 v52, 0xc0135761
    v_mov_b32 v53, 0xc0135761
    v_mov_b32 v54, 1.0
    v_mov_b32 v55, 1.0
    s_nop 7
    v_pk_mul_f32 v[32:33], v[160:161], v[160:161]
    v_pk_mul_f32 v[36:37], v[162:163], v[162:163]
    v_pk_mul_f32 v[40:41], v[164:165], v[164:165]
    v_pk_mul_f32 v[44:45], v[166:167], v[166:167]
    v_pk_fma_f32 v[32:33], v[32:33], v[50:51], v[52:53]
    v_pk_fma_f32 v[36:37], v[36:37], v[50:51], v[52:53]
    v_pk_fma_f32 v[40:41], v[40:41], v[50:51], v[52:53]
    v_pk_fma_f32 v[44:45], v[44:45], v[50:51], v[52:53]
    v_pk_mul_f32 v[32:33], v[32:33], v[160:161]
    v_pk_mul_f32 v[36:37], v[36:37], v[162:163]
    v_pk_mul_f32 v[40:41], v[40:41], v[164:165]
    v_pk_mul_f32 v[44:45], v[44:45], v[166:167]
    v_exp_f32 v32, v32
    v_exp_f32 v36, v36
    v_exp_f32 v40, v40
    v_exp_f32 v44, v44
    v_exp_f32 v33, v33
    v_exp_f32 v37, v37
    v_exp_f32 v41, v41
    v_exp_f32 v45, v45
    v_pk_mul_f32 v[34:35], v[160:161], v[176:177]
    v_pk_mul_f32 v[38:39], v[162:163], v[178:179]
    v_pk_mul_f32 v[42:43], v[164:165], v[180:181]
    v_pk_mul_f32 v[46:47], v[166:167], v[182:183]
    v_pk_add_f32 v[32:33], v[32:33], v[54:55]
    v_pk_add_f32 v[36:37], v[36:37], v[54:55]
    v_pk_add_f32 v[40:41], v[40:41], v[54:55]
    v_pk_add_f32 v[44:45], v[44:45], v[54:55]
    v_rcp_f32 v32, v32
    v_rcp_f32 v36, v36
    v_rcp_f32 v40, v40
    v_rcp_f32 v44, v44
    v_rcp_f32 v33, v33
    v_rcp_f32 v37, v37
    v_rcp_f32 v41, v41
    v_rcp_f32 v45, v45
    v_pk_mul_f32 v[34:35], v[34:35], v[32:33]
    v_pk_mul_f32 v[38:39], v[38:39], v[36:37]
    v_pk_mul_f32 v[42:43], v[42:43], v[40:41]
    v_pk_mul_f32 v[46:47], v[46:47], v[44:45]
    v_cvt_pk_bf16_f32 v24, v34, v35
    v_cvt_pk_bf16_f32 v25, v38, v39
    v_cvt_pk_bf16_f32 v26, v42, v43
    v_cvt_pk_bf16_f32 v27, v46, v47
    buffer_store_dwordx4 v[24:27], v22, s[20:23], s28 offen offset:0 sc1
    v_pk_mul_f32 v[32:33], v[168:169], v[168:169]
    v_pk_mul_f32 v[36:37], v[170:171], v[170:171]
    v_pk_mul_f32 v[40:41], v[172:173], v[172:173]
    v_pk_mul_f32 v[44:45], v[174:175], v[174:175]
    v_pk_fma_f32 v[32:33], v[32:33], v[50:51], v[52:53]
    v_pk_fma_f32 v[36:37], v[36:37], v[50:51], v[52:53]
    v_pk_fma_f32 v[40:41], v[40:41], v[50:51], v[52:53]
    v_pk_fma_f32 v[44:45], v[44:45], v[50:51], v[52:53]
    v_pk_mul_f32 v[32:33], v[32:33], v[168:169]
    v_pk_mul_f32 v[36:37], v[36:37], v[170:171]
    v_pk_mul_f32 v[40:41], v[40:41], v[172:173]
    v_pk_mul_f32 v[44:45], v[44:45], v[174:175]
    v_exp_f32 v32, v32
    v_exp_f32 v36, v36
    v_exp_f32 v40, v40
    v_exp_f32 v44, v44
    v_exp_f32 v33, v33
    v_exp_f32 v37, v37
    v_exp_f32 v41, v41
    v_exp_f32 v45, v45
    v_pk_mul_f32 v[34:35], v[168:169], v[184:185]
    v_pk_mul_f32 v[38:39], v[170:171], v[186:187]
    v_pk_mul_f32 v[42:43], v[172:173], v[188:189]
    v_pk_mul_f32 v[46:47], v[174:175], v[190:191]
    v_pk_add_f32 v[32:33], v[32:33], v[54:55]
    v_pk_add_f32 v[36:37], v[36:37], v[54:55]
    v_pk_add_f32 v[40:41], v[40:41], v[54:55]
    v_pk_add_f32 v[44:45], v[44:45], v[54:55]
    v_rcp_f32 v32, v32
    v_rcp_f32 v36, v36
    v_rcp_f32 v40, v40
    v_rcp_f32 v44, v44
    v_rcp_f32 v33, v33
    v_rcp_f32 v37, v37
    v_rcp_f32 v41, v41
    v_rcp_f32 v45, v45
    v_pk_mul_f32 v[34:35], v[34:35], v[32:33]
    v_pk_mul_f32 v[38:39], v[38:39], v[36:37]
    v_pk_mul_f32 v[42:43], v[42:43], v[40:41]
    v_pk_mul_f32 v[46:47], v[46:47], v[44:45]
    v_cvt_pk_bf16_f32 v28, v34, v35
    v_cvt_pk_bf16_f32 v29, v38, v39
    v_cvt_pk_bf16_f32 v30, v42, v43
    v_cvt_pk_bf16_f32 v31, v46, v47
    buffer_store_dwordx4 v[28:31], v22, s[20:23], s28 offen offset:1024 sc1
    s_add_u32 s28, s28, 331776
    v_pk_mul_f32 v[32:33], v[192:193], v[192:193]
    v_pk_mul_f32 v[36:37], v[194:195], v[194:195]
    v_pk_mul_f32 v[40:41], v[196:197], v[196:197]
    v_pk_mul_f32 v[44:45], v[198:199], v[198:199]
    v_pk_fma_f32 v[32:33], v[32:33], v[50:51], v[52:53]
    v_pk_fma_f32 v[36:37], v[36:37], v[50:51], v[52:53]
    v_pk_fma_f32 v[40:41], v[40:41], v[50:51], v[52:53]
    v_pk_fma_f32 v[44:45], v[44:45], v[50:51], v[52:53]
    v_pk_mul_f32 v[32:33], v[32:33], v[192:193]
    v_pk_mul_f32 v[36:37], v[36:37], v[194:195]
    v_pk_mul_f32 v[40:41], v[40:41], v[196:197]
    v_pk_mul_f32 v[44:45], v[44:45], v[198:199]
    v_exp_f32 v32, v32
    v_exp_f32 v36, v36
    v_exp_f32 v40, v40
    v_exp_f32 v44, v44
    v_exp_f32 v33, v33
    v_exp_f32 v37, v37
    v_exp_f32 v41, v41
    v_exp_f32 v45, v45
    v_pk_mul_f32 v[34:35], v[192:193], v[208:209]
    v_pk_mul_f32 v[38:39], v[194:195], v[210:211]
    v_pk_mul_f32 v[42:43], v[196:197], v[212:213]
    v_pk_mul_f32 v[46:47], v[198:199], v[214:215]
    v_pk_add_f32 v[32:33], v[32:33], v[54:55]
    v_pk_add_f32 v[36:37], v[36:37], v[54:55]
    v_pk_add_f32 v[40:41], v[40:41], v[54:55]
    v_pk_add_f32 v[44:45], v[44:45], v[54:55]
    v_rcp_f32 v32, v32
    v_rcp_f32 v36, v36
    v_rcp_f32 v40, v40
    v_rcp_f32 v44, v44
    v_rcp_f32 v33, v33
    v_rcp_f32 v37, v37
    v_rcp_f32 v41, v41
    v_rcp_f32 v45, v45
    v_pk_mul_f32 v[34:35], v[34:35], v[32:33]
    v_pk_mul_f32 v[38:39], v[38:39], v[36:37]
    v_pk_mul_f32 v[42:43], v[42:43], v[40:41]
    v_pk_mul_f32 v[46:47], v[46:47], v[44:45]
    v_cvt_pk_bf16_f32 v24, v34, v35
    v_cvt_pk_bf16_f32 v25, v38, v39
    v_cvt_pk_bf16_f32 v26, v42, v43
    v_cvt_pk_bf16_f32 v27, v46, v47
    buffer_store_dwordx4 v[24:27], v22, s[20:23], s28 offen offset:0 sc1
    v_pk_mul_f32 v[32:33], v[200:201], v[200:201]
    v_pk_mul_f32 v[36:37], v[202:203], v[202:203]
    v_pk_mul_f32 v[40:41], v[204:205], v[204:205]
    v_pk_mul_f32 v[44:45], v[206:207], v[206:207]
    v_pk_fma_f32 v[32:33], v[32:33], v[50:51], v[52:53]
    v_pk_fma_f32 v[36:37], v[36:37], v[50:51], v[52:53]
    v_pk_fma_f32 v[40:41], v[40:41], v[50:51], v[52:53]
    v_pk_fma_f32 v[44:45], v[44:45], v[50:51], v[52:53]
    v_pk_mul_f32 v[32:33], v[32:33], v[200:201]
    v_pk_mul_f32 v[36:37], v[36:37], v[202:203]
    v_pk_mul_f32 v[40:41], v[40:41], v[204:205]
    v_pk_mul_f32 v[44:45], v[44:45], v[206:207]
    v_exp_f32 v32, v32
    v_exp_f32 v36, v36
    v_exp_f32 v40, v40
    v_exp_f32 v44, v44
    v_exp_f32 v33, v33
    v_exp_f32 v37, v37
    v_exp_f32 v41, v41
    v_exp_f32 v45, v45
    v_pk_mul_f32 v[34:35], v[200:201], v[216:217]
    v_pk_mul_f32 v[38:39], v[202:203], v[218:219]
    v_pk_mul_f32 v[42:43], v[204:205], v[220:221]
    v_pk_mul_f32 v[46:47], v[206:207], v[222:223]
    v_pk_add_f32 v[32:33], v[32:33], v[54:55]
    v_pk_add_f32 v[36:37], v[36:37], v[54:55]
    v_pk_add_f32 v[40:41], v[40:41], v[54:55]
    v_pk_add_f32 v[44:45], v[44:45], v[54:55]
    v_rcp_f32 v32, v32
    v_rcp_f32 v36, v36
    v_rcp_f32 v40, v40
    v_rcp_f32 v44, v44
    v_rcp_f32 v33, v33
    v_rcp_f32 v37, v37
    v_rcp_f32 v41, v41
    v_rcp_f32 v45, v45
    v_pk_mul_f32 v[34:35], v[34:35], v[32:33]
    v_pk_mul_f32 v[38:39], v[38:39], v[36:37]
    v_pk_mul_f32 v[42:43], v[42:43], v[40:41]
    v_pk_mul_f32 v[46:47], v[46:47], v[44:45]
    v_cvt_pk_bf16_f32 v28, v34, v35
    v_cvt_pk_bf16_f32 v29, v38, v39
    v_cvt_pk_bf16_f32 v30, v42, v43
    v_cvt_pk_bf16_f32 v31, v46, v47
    buffer_store_dwordx4 v[28:31], v22, s[20:23], s28 offen offset:1024 sc1
    s_sub_u32 s28, s28, 329728
    s_branch L_p2b
L_att:
    s_mov_b32 s33, s4
    s_mov_b32 s32, s5
    s_sub_u32 s12, s58, 4096
    s_subb_u32 s13, s59, 0
    s_mov_b32 s14, 1994752
    s_mov_b32 s15, 0x20000
    v_and_b32 v20, 63, v0
    s_mul_i32 s38, s24, 448
    v_add_u32 v30, s38, v20
    v_mul_u32_u24 v31, 7282, v30
    v_lshrrev_b32 v31, 16, v31
    v_mul_u32_u24 v32, 9, v31
    v_sub_u32 v32, v30, v32
    v_lshlrev_b32 v32, 4, v32
    v_mul_u32_u24 v31, 0x480, v31
    v_add3_u32 v1, v32, v31, 0
    v_add_u32 v1, 4096, v1
    v_add_u32 v30, s38, v20
    v_add_u32 v30, 64, v30
    v_mul_u32_u24 v31, 7282, v30
    v_lshrrev_b32 v31, 16, v31
    v_mul_u32_u24 v32, 9, v31
    v_sub_u32 v32, v30, v32
    v_lshlrev_b32 v32, 4, v32
    v_mul_u32_u24 v31, 0x480, v31
    v_add3_u32 v2, v32, v31, 0
    v_add_u32 v2, 3072, v2
    v_add_u32 v30, s38, v20
    v_add_u32 v30, 128, v30
    v_mul_u32_u24 v31, 7282, v30
    v_lshrrev_b32 v31, 16, v31
    v_mul_u32_u24 v32, 9, v31
    v_sub_u32 v32, v30, v32
    v_lshlrev_b32 v32, 4, v32
    v_mul_u32_u24 v31, 0x480, v31
    v_add3_u32 v3, v32, v31, 0
    v_add_u32 v3, 2048, v3
    v_add_u32 v30, s38, v20
    v_add_u32 v30, 192, v30
    v_mul_u32_u24 v31, 7282, v30
    v_lshrrev_b32 v31, 16, v31
    v_mul_u32_u24 v32, 9, v31
    v_sub_u32 v32, v30, v32
    v_lshlrev_b32 v32, 4, v32
    v_mul_u32_u24 v31, 0x480, v31
    v_add3_u32 v4, v32, v31, 0
    v_add_u32 v4, 1024, v4
    v_add_u32 v30, s38, v20
    v_add_u32 v30, 256, v30
    v_mul_u32_u24 v31, 7282, v30
    v_lshrrev_b32 v31, 16, v31
    v_mul_u32_u24 v32, 9, v31
    v_sub_u32 v32, v30, v32
    v_lshlrev_b32 v32, 4, v32
    v_mul_u32_u24 v31, 0x480, v31
    v_add3_u32 v5, v32, v31, 0
    v_add_u32 v5, 4096, v5
    v_add_u32 v30, s38, v20
    v_add_u32 v30, 320, v30
    v_mul_u32_u24 v31, 7282, v30
    v_lshrrev_b32 v31, 16, v31
    v_mul_u32_u24 v32, 9, v31
    v_sub_u32 v32, v30, v32
    v_lshlrev_b32 v32, 4, v32
    v_mul_u32_u24 v31, 0x480, v31
    v_add3_u32 v6, v32, v31, 0
    v_add_u32 v6, 3072, v6
    v_add_u32 v30, s38, v20
    v_add_u32 v30, 384, v30
    v_mul_u32_u24 v31, 7282, v30
    v_lshrrev_b32 v31, 16, v31
    v_mul_u32_u24 v32, 9, v31
    v_sub_u32 v32, v30, v32
    v_lshlrev_b32 v32, 4, v32
    v_mul_u32_u24 v31, 0x480, v31
    v_add3_u32 v7, v32, v31, 0
    v_add_u32 v7, 2048, v7
    s_mul_i32 s27, s33, 144
    s_add_u32 s41, s32, 0
    s_cmp_ge_u32 s41, 9
    s_cselect_b32 s38, 9, 0
    s_sub_u32 s41, s41, s38
    s_mov_b32 s34, s41
    s_mov_b32 s35, s41
    s_mul_i32 s38, s41, 221184
    s_add_u32 s27, s27, s38
    s_mul_i32 s74, s24, 7168
    s_mov_b32 s72, 0
    s_add_u32 s29, s74, s72
    s_mov_b32 m0, s29
    s_nop 0
    buffer_load_dwordx4 v1, s[12:15], s27 offen offset:0 lds
    buffer_load_dwordx4 v2, s[12:15], s27 offen offset:1024 lds
    buffer_load_dwordx4 v3, s[12:15], s27 offen offset:2048 lds
    buffer_load_dwordx4 v4, s[12:15], s27 offen offset:3072 lds
    s_add_u32 m0, s29, 4096
    s_nop 0
    buffer_load_dwordx4 v5, s[12:15], s27 offen offset:0 lds
    buffer_load_dwordx4 v6, s[12:15], s27 offen offset:1024 lds
    buffer_load_dwordx4 v7, s[12:15], s27 offen offset:2048 lds
    s_add_u32 s72, s72, 28672
    s_cmp_eq_u32 s72, 86016
    s_cselect_b32 s72, 0, s72
    s_add_u32 s27, s27, 221184
    s_add_u32 s34, s34, 1
    s_cmp_eq_u32 s34, 9
    s_cselect_b32 s38, 1990656, 0
    s_cselect_b32 s34, 0, s34
    s_sub_u32 s27, s27, s38
    s_mul_i32 s38, s32, 294912
    s_add_u32 s8, s56, s38
    s_addc_u32 s9, s57, 0
    s_sub_u32 s8, s8, 4096
    s_subb_u32 s9, s9, 0
    s_mov_b32 s10, 299008
    s_mov_b32 s11, 0x20000
    v_lshrrev_b32 v24, 4, v20
    v_and_b32 v25, 15, v20
    v_lshrrev_b32 v26, 3, v20
    v_and_b32 v27, 7, v20
    v_add_u32 v30, 0, v24
    v_and_b32 v30, 7, v30
    v_xor_b32 v30, v30, v27
    v_lshlrev_b32 v30, 4, v30
    v_add_u32 v31, 0, v26
    v_mul_u32_u24 v31, 0x480, v31
    v_add3_u32 v10, v30, v31, 0
    v_add_u32 v10, 4096, v10
    v_add_u32 v30, 4, v24
    v_and_b32 v30, 7, v30
    v_xor_b32 v30, v30, v27
    v_lshlrev_b32 v30, 4, v30
    v_add_u32 v31, 8, v26
    v_mul_u32_u24 v31, 0x480, v31
    v_add3_u32 v11, v30, v31, 0
    v_add_u32 v11, 3072, v11
    v_add_u32 v30, 0, v24
    v_and_b32 v30, 7, v30
    v_xor_b32 v30, v30, v27
    v_lshlrev_b32 v30, 4, v30
    v_add_u32 v31, 16, v26
    v_mul_u32_u24 v31, 0x480, v31
    v_add3_u32 v12, v30, v31, 0
    v_add_u32 v12, 2048, v12
    v_add_u32 v30, 4, v24
    v_and_b32 v30, 7, v30
    v_xor_b32 v30, v30, v27
    v_lshlrev_b32 v30, 4, v30
    v_add_u32 v31, 24, v26
    v_mul_u32_u24 v31, 0x480, v31
    v_add3_u32 v13, v30, v31, 0
    v_add_u32 v13, 1024, v13
    s_mul_i32 s25, s24, 73728
    s_lshl_b32 s38, s41, 7
    s_add_u32 s25, s25, s38
    s_add_u32 s26, s25, 36864
    s_lshl_b32 s30, s24, 13
    s_add_u32 s30, s30, 86016
    s_add_u32 s38, s30, 32768
    s_xor_b32 s37, s30, s38
    s_mov_b32 s40, s30
    s_mov_b32 m0, s30
    s_nop 0
    buffer_load_dwordx4 v10, s[8:11], s25 offen offset:0 lds
    buffer_load_dwordx4 v11, s[8:11], s25 offen offset:1024 lds
    buffer_load_dwordx4 v12, s[8:11], s25 offen offset:2048 lds
    buffer_load_dwordx4 v13, s[8:11], s25 offen offset:3072 lds
    s_add_u32 m0, s30, 4096
    s_nop 0
    buffer_load_dwordx4 v10, s[8:11], s26 offen offset:0 lds
    buffer_load_dwordx4 v11, s[8:11], s26 offen offset:1024 lds
    buffer_load_dwordx4 v12, s[8:11], s26 offen offset:2048 lds
    buffer_load_dwordx4 v13, s[8:11], s26 offen offset:3072 lds
    s_xor_b32 s30, s30, s37
    s_add_u32 s25, s25, 128
    s_add_u32 s35, s35, 1
    s_cmp_eq_u32 s35, 9
    s_cselect_b32 s39, 1152, 0
    s_cselect_b32 s35, 0, s35
    s_sub_u32 s25, s25, s39
    s_add_u32 s26, s25, 36864
    s_mov_b32 s31, 0x3fb8aa3b
    s_mov_b32 s16, s70
    s_mov_b32 s17, s71
    s_mov_b32 s18, 21233664
    s_mov_b32 s19, 0x20000
    s_add_u32 s20, s70, 22028288
    s_addc_u32 s21, s71, 0
    s_mov_b32 s22, 737280
    s_mov_b32 s23, 0x20000
    v_lshlrev_b32 v21, 4, v20
    v_lshrrev_b32 v28, 2, v25
    v_and_b32 v29, 3, v25
    v_lshrrev_b32 v30, 1, v25
    v_xor_b32 v30, v30, v24
    v_lshlrev_b32 v30, 4, v30
    v_lshlrev_b32 v31, 7, v25
    v_add_u32 v30, v30, v31
    v_add_u32 v16, s40, v30
    v_xor_b32 v17, 64, v16
    v_add_u32 v18, 32768, v16
    v_add_u32 v19, 32768, v17
    v_lshlrev_b32 v30, 3, v24
    v_add_u32 v30, v30, v28
    v_mul_u32_u24 v30, 432, v30
    v_mul_u32_u24 v31, 36, v29
    v_and_b32 v33, 1, v29
    v_lshlrev_b32 v33, 2, v33
    v_sub_u32 v31, v31, v33
    v_add_u32 v8, v30, v31
    v_mov_b32 v14, v8
    v_add_u32 v15, 28672, v8
    s_mov_b32 s73, 28672
    v_cmp_eq_u32 vcc, v29, v24
    v_mul_u32_u24 v30, 960, v24
    v_mul_u32_u24 v31, 40, v28
    v_add_u32 v30, v30, v31
    v_add_u32 v30, 151552, v30
    v_mov_b32 v32, 155392
    v_cndmask_b32 v22, v32, v30, vcc
    v_mul_u32_u24 v30, 1920, v24
    v_add_u32 v30, v30, v31
    v_add_u32 v30, 129024, v30
    v_cndmask_b32 v23, v32, v30, vcc
    s_mul_i32 s38, s33, 2592
    s_add_u32 s48, s60, s38
    s_addc_u32 s49, s61, 0
    s_mov_b32 s50, 2592
    s_mov_b32 s51, 0x20000
    v_lshlrev_b32 v30, 2, v0
    buffer_load_dword v44, v30, s[48:51], 0 offen offset:0
    buffer_load_dword v45, v30, s[48:51], 0 offen offset:1024
    buffer_load_dword v46, v30, s[48:51], 0 offen offset:2048
    v_mov_b32 v40, 0
    v_mov_b32 v41, 0
    v_mov_b32 v42, 0
    v_mov_b32 v43, 0
    v_lshlrev_b32 v30, 4, v0
    v_add_u32 v30, 151552, v30
    ds_write_b128 v30, v[40:43]
    v_cmp_gt_u32 vcc, 104, v0
    s_and_saveexec_b64 s[48:49], vcc
    s_cbranch_execz L_att_z1
    ds_write_b128 v30, v[40:43] offset:4096
L_att_z1:
    s_mov_b64 exec, s[48:49]
    v_add_u32 v30, 0, v0
    v_mul_u32_u24 v31, 405, v30
    v_lshrrev_b32 v31, 16, v31
    v_mul_u32_u24 v32, 162, v31
    v_sub_u32 v32, v30, v32
    v_mul_u32_u24 v33, 57, v32
    v_lshrrev_b32 v33, 9, v33
    v_mul_u32_u24 v34, 9, v33
    v_sub_u32 v34, v32, v34
    v_and_b32 v35, 1, v31
    v_lshl_add_u32 v33, v35, 1, v33
    v_mul_u32_u24 v31, 960, v31
    v_mul_u32_u24 v33, 40, v33
    v_lshlrev_b32 v34, 2, v34
    v_add3_u32 v47, v31, v33, v34
    v_add_u32 v47, 151552, v47
    v_add_u32 v30, 256, v0
    v_mul_u32_u24 v31, 405, v30
    v_lshrrev_b32 v31, 16, v31
    v_mul_u32_u24 v32, 162, v31
    v_sub_u32 v32, v30, v32
    v_mul_u32_u24 v33, 57, v32
    v_lshrrev_b32 v33, 9, v33
    v_mul_u32_u24 v34, 9, v33
    v_sub_u32 v34, v32, v34
    v_and_b32 v35, 1, v31
    v_lshl_add_u32 v33, v35, 1, v33
    v_mul_u32_u24 v31, 960, v31
    v_mul_u32_u24 v33, 40, v33
    v_lshlrev_b32 v34, 2, v34
    v_add3_u32 v48, v31, v33, v34
    v_add_u32 v48, 151552, v48
    v_add_u32 v30, 512, v0
    v_mul_u32_u24 v31, 405, v30
    v_lshrrev_b32 v31, 16, v31
    v_mul_u32_u24 v32, 162, v31
    v_sub_u32 v32, v30, v32
    v_mul_u32_u24 v33, 57, v32
    v_lshrrev_b32 v33, 9, v33
    v_mul_u32_u24 v34, 9, v33
    v_sub_u32 v34, v32, v34
    v_and_b32 v35, 1, v31
    v_lshl_add_u32 v33, v35, 1, v33
    v_mul_u32_u24 v31, 960, v31
    v_mul_u32_u24 v33, 40, v33
    v_lshlrev_b32 v34, 2, v34
    v_add3_u32 v49, v31, v33, v34
    v_add_u32 v49, 151552, v49
    v_accvgpr_write_b32 a0, 0
    v_accvgpr_write_b32 a1, 0
    v_accvgpr_write_b32 a2, 0
    v_accvgpr_write_b32 a3, 0
    v_accvgpr_write_b32 a4, 0
    v_accvgpr_write_b32 a5, 0
    v_accvgpr_write_b32 a6, 0
    v_accvgpr_write_b32 a7, 0
    v_accvgpr_write_b32 a8, 0
    v_accvgpr_write_b32 a9, 0
    v_accvgpr_write_b32 a10, 0
    v_accvgpr_write_b32 a11, 0
    v_accvgpr_write_b32 a12, 0
    v_accvgpr_write_b32 a13, 0
    v_accvgpr_write_b32 a14, 0
    v_accvgpr_write_b32 a15, 0
    v_accvgpr_write_b32 a16, 0
    v_accvgpr_write_b32 a17, 0
    v_accvgpr_write_b32 a18, 0
    v_accvgpr_write_b32 a19, 0
    v_accvgpr_write_b32 a20, 0
    v_accvgpr_write_b32 a21, 0
    v_accvgpr_write_b32 a22, 0
    v_accvgpr_write_b32 a23, 0
    v_accvgpr_write_b32 a24, 0
    v_accvgpr_write_b32 a25, 0
    v_accvgpr_write_b32 a26, 0
    v_accvgpr_write_b32 a27, 0
    v_accvgpr_write_b32 a28, 0
    v_accvgpr_write_b32 a29, 0
    v_accvgpr_write_b32 a30, 0
    v_accvgpr_write_b32 a31, 0
    v_accvgpr_write_b32 a32, 0
    v_accvgpr_write_b32 a33, 0
    v_accvgpr_write_b32 a34, 0
    v_accvgpr_write_b32 a35, 0
    v_accvgpr_write_b32 a36, 0
    v_accvgpr_write_b32 a37, 0
    v_accvgpr_write_b32 a38, 0
    v_accvgpr_write_b32 a39, 0
    v_accvgpr_write_b32 a40, 0
    v_accvgpr_write_b32 a41, 0
    v_accvgpr_write_b32 a42, 0
    v_accvgpr_write_b32 a43, 0
    v_accvgpr_write_b32 a44, 0
    v_accvgpr_write_b32 a45, 0
    v_accvgpr_write_b32 a46, 0
    v_accvgpr_write_b32 a47, 0
    v_accvgpr_write_b32 a48, 0
    v_accvgpr_write_b32 a49, 0
    v_accvgpr_write_b32 a50, 0
    v_accvgpr_write_b32 a51, 0
    v_accvgpr_write_b32 a52, 0
    v_accvgpr_write_b32 a53, 0
    v_accvgpr_write_b32 a54, 0
    v_accvgpr_write_b32 a55, 0
    v_accvgpr_write_b32 a56, 0
    v_accvgpr_write_b32 a57, 0
    v_accvgpr_write_b32 a58, 0
    v_accvgpr_write_b32 a59, 0
    v_accvgpr_write_b32 a60, 0
    v_accvgpr_write_b32 a61, 0
    v_accvgpr_write_b32 a62, 0
    v_accvgpr_write_b32 a63, 0
    v_accvgpr_write_b32 a64, 0
    v_accvgpr_write_b32 a65, 0
    v_accvgpr_write_b32 a66, 0
    v_accvgpr_write_b32 a67, 0
    v_accvgpr_write_b32 a68, 0
    v_accvgpr_write_b32 a69, 0
    v_accvgpr_write_b32 a70, 0
    v_accvgpr_write_b32 a71, 0
    v_accvgpr_write_b32 a72, 0
    v_accvgpr_write_b32 a73, 0
    v_accvgpr_write_b32 a74, 0
    v_accvgpr_write_b32 a75, 0
    v_accvgpr_write_b32 a76, 0
    v_accvgpr_write_b32 a77, 0
    v_accvgpr_write_b32 a78, 0
    v_accvgpr_write_b32 a79, 0
    v_mov_b32 v96, 0
    v_mov_b32 v97, 0
    v_mov_b32 v98, 0
    v_mov_b32 v99, 0
    v_mov_b32 v100, 0
    v_mov_b32 v101, 0
    v_mov_b32 v102, 0
    v_mov_b32 v103, 0
    v_mov_b32 v104, 0
    v_mov_b32 v105, 0
    v_mov_b32 v106, 0
    v_mov_b32 v107, 0
    v_mov_b32 v108, 0
    v_mov_b32 v109, 0
    v_mov_b32 v110, 0
    v_mov_b32 v111, 0
    v_mov_b32 v112, 0
    v_mov_b32 v113, 0
    v_mov_b32 v114, 0
    v_mov_b32 v115, 0
    v_mov_b32 v116, 0
    v_mov_b32 v117, 0
    v_mov_b32 v118, 0
    v_mov_b32 v119, 0
    v_mov_b32 v120, 0
    v_mov_b32 v121, 0
    v_mov_b32 v122, 0
    v_mov_b32 v123, 0
    v_mov_b32 v124, 0
    v_mov_b32 v125, 0
    v_mov_b32 v126, 0
    v_mov_b32 v127, 0
    v_mov_b32 v128, 0
    v_mov_b32 v129, 0
    v_mov_b32 v130, 0
    v_mov_b32 v131, 0
    v_mov_b32 v132, 0
    v_mov_b32 v133, 0
    v_mov_b32 v134, 0
    v_mov_b32 v135, 0
    v_mov_b32 v136, 0
    v_mov_b32 v137, 0
    v_mov_b32 v138, 0
    v_mov_b32 v139, 0
    v_mov_b32 v140, 0
    v_mov_b32 v141, 0
    v_mov_b32 v142, 0
    v_mov_b32 v143, 0
    v_mov_b32 v144, 0
    v_mov_b32 v145, 0
    v_mov_b32 v146, 0
    v_mov_b32 v147, 0
    v_mov_b32 v148, 0
    v_mov_b32 v149, 0
    v_mov_b32 v150, 0
    v_mov_b32 v151, 0
    v_mov_b32 v152, 0
    v_mov_b32 v153, 0
    v_mov_b32 v154, 0
    v_mov_b32 v155, 0
    v_mov_b32 v156, 0
    v_mov_b32 v157, 0
    v_mov_b32 v158, 0
    v_mov_b32 v159, 0
    v_mov_b32 v160, 0
    v_mov_b32 v161, 0
    v_mov_b32 v162, 0
    v_mov_b32 v163, 0
    v_mov_b32 v164, 0
    v_mov_b32 v165, 0
    v_mov_b32 v166, 0
    v_mov_b32 v167, 0
    v_mov_b32 v168, 0
    v_mov_b32 v169, 0
    v_mov_b32 v170, 0
    v_mov_b32 v171, 0
    v_mov_b32 v172, 0
    v_mov_b32 v173, 0
    v_mov_b32 v174, 0
    v_mov_b32 v175, 0
    v_mov_b32 v176, 0
    v_mov_b32 v177, 0
    v_mov_b32 v178, 0
    v_mov_b32 v179, 0
    v_mov_b32 v180, 0
    v_mov_b32 v181, 0
    v_mov_b32 v182, 0
    v_mov_b32 v183, 0
    v_mov_b32 v184, 0
    v_mov_b32 v185, 0
    v_mov_b32 v186, 0
    v_mov_b32 v187, 0
    v_mov_b32 v188, 0
    v_mov_b32 v189, 0
    v_mov_b32 v190, 0
    v_mov_b32 v191, 0
    v_mov_b32 v192, 0
    v_mov_b32 v193, 0
    v_mov_b32 v194, 0
    v_mov_b32 v195, 0
    v_mov_b32 v196, 0
    v_mov_b32 v197, 0
    v_mov_b32 v198, 0
    v_mov_b32 v199, 0
    v_mov_b32 v200, 0
    v_mov_b32 v201, 0
    v_mov_b32 v202, 0
    v_mov_b32 v203, 0
    v_mov_b32 v204, 0
    v_mov_b32 v205, 0
    v_mov_b32 v206, 0
    v_mov_b32 v207, 0
    v_mov_b32 v208, 0
    v_mov_b32 v209, 0
    v_mov_b32 v210, 0
    v_mov_b32 v211, 0
    v_mov_b32 v212, 0
    v_mov_b32 v213, 0
    v_mov_b32 v214, 0
    v_mov_b32 v215, 0
    v_mov_b32 v216, 0
    v_mov_b32 v217, 0
    v_mov_b32 v218, 0
    v_mov_b32 v219, 0
    v_mov_b32 v220, 0
    v_mov_b32 v221, 0
    v_mov_b32 v222, 0
    v_mov_b32 v223, 0
    v_mov_b32 v224, 0
    v_mov_b32 v225, 0
    v_mov_b32 v226, 0
    v_mov_b32 v227, 0
    v_mov_b32 v228, 0
    v_mov_b32 v229, 0
    v_mov_b32 v230, 0
    v_mov_b32 v231, 0
    v_mov_b32 v232, 0
    v_mov_b32 v233, 0
    v_mov_b32 v234, 0
    v_mov_b32 v235, 0
    v_mov_b32 v236, 0
    v_mov_b32 v237, 0
    v_mov_b32 v238, 0
    v_mov_b32 v239, 0
    v_mov_b32 v240, 0
    v_mov_b32 v241, 0
    v_mov_b32 v242, 0
    v_mov_b32 v243, 0
    v_mov_b32 v244, 0
    v_mov_b32 v245, 0
    v_mov_b32 v246, 0
    v_mov_b32 v247, 0
    v_mov_b32 v248, 0
    v_mov_b32 v249, 0
    v_mov_b32 v250, 0
    v_mov_b32 v251, 0
    v_mov_b32 v252, 0
    v_mov_b32 v253, 0
    v_mov_b32 v254, 0
    v_mov_b32 v255, 0
    s_add_u32 s29, s74, s72
    s_mov_b32 m0, s29
    s_nop 0
    buffer_load_dwordx4 v1, s[12:15], s27 offen offset:0 lds
    buffer_load_dwordx4 v2, s[12:15], s27 offen offset:1024 lds
    buffer_load_dwordx4 v3, s[12:15], s27 offen offset:2048 lds
    buffer_load_dwordx4 v4, s[12:15], s27 offen offset:3072 lds
    s_add_u32 m0, s29, 4096
    s_nop 0
    buffer_load_dwordx4 v5, s[12:15], s27 offen offset:0 lds
    buffer_load_dwordx4 v6, s[12:15], s27 offen offset:1024 lds
    buffer_load_dwordx4 v7, s[12:15], s27 offen offset:2048 lds
    s_add_u32 s72, s72, 28672
    s_cmp_eq_u32 s72, 86016
    s_cselect_b32 s72, 0, s72
    s_add_u32 s27, s27, 221184
    s_add_u32 s34, s34, 1
    s_cmp_eq_u32 s34, 9
    s_cselect_b32 s38, 1990656, 0
    s_cselect_b32 s34, 0, s34
    s_sub_u32 s27, s27, s38
    s_mov_b32 m0, s30
    s_nop 0
    buffer_load_dwordx4 v10, s[8:11], s25 offen offset:0 lds
    buffer_load_dwordx4 v11, s[8:11], s25 offen offset:1024 lds
    buffer_load_dwordx4 v12, s[8:11], s25 offen offset:2048 lds
    buffer_load_dwordx4 v13, s[8:11], s25 offen offset:3072 lds
    s_waitcnt vmcnt(11) lgkmcnt(0)
    s_barrier
    s_cmp_eq_u32 s24, 0
    s_cbranch_scc0 L_att_az
    s_cmp_lt_u32 s2, 17
    s_cselect_b32 s52, 2, 1
    v_mov_b32 v50, 0
    v_mov_b32 v51, s52
    v_cmp_eq_u32 vcc, 0, v0
    s_and_saveexec_b64 s[52:53], vcc
    global_atomic_add v50, v51, s[68:69] sc1
    s_mov_b64 exec, s[52:53]
L_att_az:
    ds_write_b32 v47, v44
    ds_write_b32 v48, v45
    v_cmp_gt_u32 vcc, 136, v0
    s_and_saveexec_b64 s[48:49], vcc
    s_cbranch_execz L_att_z2
    ds_write_b32 v49, v46
L_att_z2:
    s_mov_b64 exec, s[48:49]
    s_waitcnt lgkmcnt(0)
    v_mov_b32 v15, v8
    v_swap_b32 v16, v18
    v_swap_b32 v17, v19
    ds_read_b64_tr_b16 a[80:81], v15 offset:0
    ds_read_b64_tr_b16 a[82:83], v15 offset:1728
    ds_read_b128 a[104:107], v18 offset:0
    ds_read_b64_tr_b16 a[84:85], v15 offset:8
    ds_read_b64_tr_b16 a[86:87], v15 offset:1736
    ds_read_b128 a[108:111], v18 offset:2048
    ds_read_b64_tr_b16 a[88:89], v15 offset:16
    ds_read_b64_tr_b16 a[90:91], v15 offset:1744
    ds_read_b128 a[112:115], v18 offset:4096
    ds_read_b64_tr_b16 a[92:93], v15 offset:24
    ds_read_b64_tr_b16 a[94:95], v15 offset:1752
    ds_read_b128 a[116:119], v18 offset:6144
    v_add_u32 v15, 28672, v8
    v_swap_b32 v16, v18
    v_swap_b32 v17, v19
    s_mov_b32 s28, 0
L_att_loop:
    s_waitcnt lgkmcnt(7)
    v_mfma_f32_16x16x32_bf16 a[0:3], a[80:83], a[104:107], a[0:3]
    ds_read_b64_tr_b16 a[96:97], v14 offset:32
    s_waitcnt lgkmcnt(5)
    v_mfma_f32_16x16x32_bf16 a[4:7], a[80:83], a[108:111], a[4:7]
    ds_read_b64_tr_b16 a[98:99], v14 offset:1760
    s_waitcnt lgkmcnt(3)
    v_mfma_f32_16x16x32_bf16 a[8:11], a[80:83], a[112:115], a[8:11]
    s_waitcnt lgkmcnt(0)
    v_mfma_f32_16x16x32_bf16 a[12:15], a[80:83], a[116:119], a[12:15]
    v_mfma_f32_16x16x32_bf16 a[16:19], a[84:87], a[104:107], a[16:19]
    s_add_u32 m0, s30, 4096
    ds_read_b64_tr_b16 a[100:101], v14 offset:144
    v_mfma_f32_16x16x32_bf16 a[20:23], a[84:87], a[108:111], a[20:23]
    ds_read_b64_tr_b16 a[102:103], v14 offset:1872
    v_mfma_f32_16x16x32_bf16 a[24:27], a[84:87], a[112:115], a[24:27]
    ds_read_b128 a[120:123], v17 offset:0
    v_mfma_f32_16x16x32_bf16 a[28:31], a[84:87], a[116:119], a[28:31]
    v_mfma_f32_16x16x32_bf16 a[32:35], a[88:91], a[104:107], a[32:35]
    ds_read_b64_tr_b16 a[80:81], v14 offset:152
    v_mfma_f32_16x16x32_bf16 a[36:39], a[88:91], a[108:111], a[36:39]
    ds_read_b64_tr_b16 a[82:83], v14 offset:1880
    v_mfma_f32_16x16x32_bf16 a[40:43], a[88:91], a[112:115], a[40:43]
    buffer_load_dwordx4 v10, s[8:11], s26 offen offset:0 lds
    ds_read_b128 a[124:127], v17 offset:2048
    v_mfma_f32_16x16x32_bf16 a[44:47], a[88:91], a[116:119], a[44:47]
    v_mfma_f32_16x16x32_bf16 a[48:51], a[92:95], a[104:107], a[48:51]
    ds_read_b64_tr_b16 a[84:85], v14 offset:160
    v_mfma_f32_16x16x32_bf16 a[52:55], a[92:95], a[108:111], a[52:55]
    ds_read_b64_tr_b16 a[86:87], v14 offset:1888
    v_mfma_f32_16x16x32_bf16 a[56:59], a[92:95], a[112:115], a[56:59]
    ds_read_b128 a[128:131], v17 offset:4096
    v_mfma_f32_16x16x32_bf16 a[60:63], a[92:95], a[116:119], a[60:63]
    v_mfma_f32_16x16x32_bf16 a[64:67], a[96:99], a[104:107], a[64:67]
    ds_read_b64_tr_b16 a[88:89], v14 offset:168
    v_mfma_f32_16x16x32_bf16 a[68:71], a[96:99], a[108:111], a[68:71]
    buffer_load_dwordx4 v11, s[8:11], s26 offen offset:1024 lds
    ds_read_b64_tr_b16 a[90:91], v14 offset:1896
    v_mfma_f32_16x16x32_bf16 a[72:75], a[96:99], a[112:115], a[72:75]
    ds_read_b128 a[132:135], v17 offset:6144
    v_mfma_f32_16x16x32_bf16 a[76:79], a[96:99], a[116:119], a[76:79]
    s_waitcnt lgkmcnt(8)
    v_mfma_f32_16x16x32_bf16 v[96:99], a[100:103], a[104:107], v[96:99]
    ds_read_b64_tr_b16 a[92:93], v14 offset:176
    v_mfma_f32_16x16x32_bf16 v[100:103], a[100:103], a[108:111], v[100:103]
    ds_read_b64_tr_b16 a[94:95], v14 offset:1904
    v_mfma_f32_16x16x32_bf16 v[104:107], a[100:103], a[112:115], v[104:107]
    v_mfma_f32_16x16x32_bf16 v[108:111], a[100:103], a[116:119], v[108:111]
    buffer_load_dwordx4 v12, s[8:11], s26 offen offset:2048 lds
    s_waitcnt lgkmcnt(7)
    v_mfma_f32_16x16x32_bf16 v[112:115], a[80:83], a[104:107], v[112:115]
    ds_read_b64_tr_b16 a[96:97], v14 offset:288
    v_mfma_f32_16x16x32_bf16 v[116:119], a[80:83], a[108:111], v[116:119]
    ds_read_b64_tr_b16 a[98:99], v14 offset:2016
    v_mfma_f32_16x16x32_bf16 v[120:123], a[80:83], a[112:115], v[120:123]
    v_mfma_f32_16x16x32_bf16 v[124:127], a[80:83], a[116:119], v[124:127]
    s_waitcnt lgkmcnt(6)
    v_mfma_f32_16x16x32_bf16 v[128:131], a[84:87], a[104:107], v[128:131]
    ds_read_b64_tr_b16 a[100:101], v14 offset:296
    v_mfma_f32_16x16x32_bf16 v[132:135], a[84:87], a[108:111], v[132:135]
    ds_read_b64_tr_b16 a[102:103], v14 offset:2024
    v_mfma_f32_16x16x32_bf16 v[136:139], a[84:87], a[112:115], v[136:139]
    buffer_load_dwordx4 v13, s[8:11], s26 offen offset:3072 lds
    v_mfma_f32_16x16x32_bf16 v[140:143], a[84:87], a[116:119], v[140:143]
    s_waitcnt lgkmcnt(5)
    v_mfma_f32_16x16x32_bf16 v[144:147], a[88:91], a[104:107], v[144:147]
    ds_read_b64_tr_b16 a[80:81], v14 offset:304
    v_mfma_f32_16x16x32_bf16 v[148:151], a[88:91], a[108:111], v[148:151]
    ds_read_b64_tr_b16 a[82:83], v14 offset:2032
    v_mfma_f32_16x16x32_bf16 v[152:155], a[88:91], a[112:115], v[152:155]
    v_mfma_f32_16x16x32_bf16 v[156:159], a[88:91], a[116:119], v[156:159]
    s_waitcnt lgkmcnt(4)
    v_mfma_f32_16x16x32_bf16 v[160:163], a[92:95], a[104:107], v[160:163]
    ds_read_b64_tr_b16 a[84:85], v14 offset:312
    v_mfma_f32_16x16x32_bf16 v[164:167], a[92:95], a[108:111], v[164:167]
    s_xor_b32 s30, s30, s37
    s_add_u32 s25, s25, 128
    s_add_u32 s35, s35, 1
    s_cmp_eq_u32 s35, 9
    s_cselect_b32 s39, 1152, 0
    s_cselect_b32 s35, 0, s35
    s_sub_u32 s25, s25, s39
    s_add_u32 s26, s25, 36864
    s_add_u32 s29, s74, s72
    s_mov_b32 m0, s29
    ds_read_b64_tr_b16 a[86:87], v14 offset:2040
    v_mfma_f32_16x16x32_bf16 v[168:171], a[92:95], a[112:115], v[168:171]
    v_mfma_f32_16x16x32_bf16 v[172:175], a[92:95], a[116:119], v[172:175]
    v_mfma_f32_16x16x32_bf16 v[176:179], a[96:99], a[104:107], v[176:179]
    ds_read_b64_tr_b16 a[88:89], v14 offset:320
    v_mfma_f32_16x16x32_bf16 v[180:183], a[96:99], a[108:111], v[180:183]
    ds_read_b64_tr_b16 a[90:91], v14 offset:2048
    v_mfma_f32_16x16x32_bf16 v[184:187], a[96:99], a[112:115], v[184:187]
    v_mfma_f32_16x16x32_bf16 v[188:191], a[96:99], a[116:119], v[188:191]
    buffer_load_dwordx4 v1, s[12:15], s27 offen offset:0 lds
    s_waitcnt lgkmcnt(4)
    v_mfma_f32_16x16x32_bf16 v[192:195], a[100:103], a[104:107], v[192:195]
    ds_read_b64_tr_b16 a[92:93], v14 offset:13824
    v_mfma_f32_16x16x32_bf16 v[196:199], a[100:103], a[108:111], v[196:199]
    ds_read_b64_tr_b16 a[94:95], v14 offset:15552
    v_mfma_f32_16x16x32_bf16 v[200:203], a[100:103], a[112:115], v[200:203]
    v_mfma_f32_16x16x32_bf16 v[204:207], a[100:103], a[116:119], v[204:207]
    v_mfma_f32_16x16x32_bf16 v[208:211], a[80:83], a[104:107], v[208:211]
    ds_read_b64_tr_b16 a[96:97], v14 offset:13832
    v_mfma_f32_16x16x32_bf16 v[212:215], a[80:83], a[108:111], v[212:215]
    ds_read_b64_tr_b16 a[98:99], v14 offset:15560
    v_mfma_f32_16x16x32_bf16 v[216:219], a[80:83], a[112:115], v[216:219]
    buffer_load_dwordx4 v2, s[12:15], s27 offen offset:1024 lds
    v_mfma_f32_16x16x32_bf16 v[220:223], a[80:83], a[116:119], v[220:223]
    s_waitcnt lgkmcnt(4)
    v_mfma_f32_16x16x32_bf16 v[224:227], a[84:87], a[104:107], v[224:227]
    ds_read_b64_tr_b16 a[100:101], v14 offset:13840
    v_mfma_f32_16x16x32_bf16 v[228:231], a[84:87], a[108:111], v[228:231]
    ds_read_b64_tr_b16 a[102:103], v14 offset:15568
    v_mfma_f32_16x16x32_bf16 v[232:235], a[84:87], a[112:115], v[232:235]
    v_mfma_f32_16x16x32_bf16 v[236:239], a[84:87], a[116:119], v[236:239]
    v_mfma_f32_16x16x32_bf16 v[240:243], a[88:91], a[104:107], v[240:243]
    buffer_load_dwordx4 v3, s[12:15], s27 offen offset:2048 lds
    ds_read_b64_tr_b16 a[80:81], v14 offset:13848
    v_mfma_f32_16x16x32_bf16 v[244:247], a[88:91], a[108:111], v[244:247]
    ds_read_b64_tr_b16 a[82:83], v14 offset:15576
    v_mfma_f32_16x16x32_bf16 v[248:251], a[88:91], a[112:115], v[248:251]
    v_mfma_f32_16x16x32_bf16 v[252:255], a[88:91], a[116:119], v[252:255]
    s_waitcnt lgkmcnt(4)
    v_mfma_f32_16x16x32_bf16 a[0:3], a[92:95], a[120:123], a[0:3]
    ds_read_b64_tr_b16 a[84:85], v14 offset:13856
    v_mfma_f32_16x16x32_bf16 a[4:7], a[92:95], a[124:127], a[4:7]
    ds_read_b64_tr_b16 a[86:87], v14 offset:15584
    v_mfma_f32_16x16x32_bf16 a[8:11], a[92:95], a[128:131], a[8:11]
    v_mfma_f32_16x16x32_bf16 a[12:15], a[92:95], a[132:135], a[12:15]
    buffer_load_dwordx4 v4, s[12:15], s27 offen offset:3072 lds
    v_mfma_f32_16x16x32_bf16 a[16:19], a[96:99], a[120:123], a[16:19]
    ds_read_b64_tr_b16 a[88:89], v14 offset:13968
    v_mfma_f32_16x16x32_bf16 a[20:23], a[96:99], a[124:127], a[20:23]
    ds_read_b64_tr_b16 a[90:91], v14 offset:15696
    v_mfma_f32_16x16x32_bf16 a[24:27], a[96:99], a[128:131], a[24:27]
    v_mfma_f32_16x16x32_bf16 a[28:31], a[96:99], a[132:135], a[28:31]
    s_waitcnt lgkmcnt(4)
    v_mfma_f32_16x16x32_bf16 a[32:35], a[100:103], a[120:123], a[32:35]
    ds_read_b64_tr_b16 a[92:93], v14 offset:13976
    v_mfma_f32_16x16x32_bf16 a[36:39], a[100:103], a[124:127], a[36:39]
    ds_read_b64_tr_b16 a[94:95], v14 offset:15704
    v_mfma_f32_16x16x32_bf16 a[40:43], a[100:103], a[128:131], a[40:43]
    s_add_u32 m0, s29, 4096
    v_mfma_f32_16x16x32_bf16 a[44:47], a[100:103], a[132:135], a[44:47]
    v_mfma_f32_16x16x32_bf16 a[48:51], a[80:83], a[120:123], a[48:51]
    ds_read_b64_tr_b16 a[96:97], v14 offset:13984
    v_mfma_f32_16x16x32_bf16 a[52:55], a[80:83], a[124:127], a[52:55]
    ds_read_b64_tr_b16 a[98:99], v14 offset:15712
    v_mfma_f32_16x16x32_bf16 a[56:59], a[80:83], a[128:131], a[56:59]
    v_mfma_f32_16x16x32_bf16 a[60:63], a[80:83], a[132:135], a[60:63]
    s_waitcnt lgkmcnt(4)
    v_mfma_f32_16x16x32_bf16 a[64:67], a[84:87], a[120:123], a[64:67]
    buffer_load_dwordx4 v5, s[12:15], s27 offen offset:0 lds
    ds_read_b64_tr_b16 a[100:101], v14 offset:13992
    v_mfma_f32_16x16x32_bf16 a[68:71], a[84:87], a[124:127], a[68:71]
    ds_read_b64_tr_b16 a[102:103], v14 offset:15720
    v_mfma_f32_16x16x32_bf16 a[72:75], a[84:87], a[128:131], a[72:75]
    v_mfma_f32_16x16x32_bf16 a[76:79], a[84:87], a[132:135], a[76:79]
    v_mfma_f32_16x16x32_bf16 v[96:99], a[88:91], a[120:123], v[96:99]
    ds_read_b64_tr_b16 a[80:81], v14 offset:14000
    v_mfma_f32_16x16x32_bf16 v[100:103], a[88:91], a[124:127], v[100:103]
    ds_read_b64_tr_b16 a[82:83], v14 offset:15728
    v_mfma_f32_16x16x32_bf16 v[104:107], a[88:91], a[128:131], v[104:107]
    v_mfma_f32_16x16x32_bf16 v[108:111], a[88:91], a[132:135], v[108:111]
    buffer_load_dwordx4 v6, s[12:15], s27 offen offset:1024 lds
    s_waitcnt lgkmcnt(4)
    v_mfma_f32_16x16x32_bf16 v[112:115], a[92:95], a[120:123], v[112:115]
    ds_read_b64_tr_b16 a[84:85], v14 offset:14112
    v_mfma_f32_16x16x32_bf16 v[116:119], a[92:95], a[124:127], v[116:119]
    ds_read_b64_tr_b16 a[86:87], v14 offset:15840
    v_mfma_f32_16x16x32_bf16 v[120:123], a[92:95], a[128:131], v[120:123]
    v_mfma_f32_16x16x32_bf16 v[124:127], a[92:95], a[132:135], v[124:127]
    v_mfma_f32_16x16x32_bf16 v[128:131], a[96:99], a[120:123], v[128:131]
    ds_read_b64_tr_b16 a[88:89], v14 offset:14120
    v_mfma_f32_16x16x32_bf16 v[132:135], a[96:99], a[124:127], v[132:135]
    buffer_load_dwordx4 v7, s[12:15], s27 offen offset:2048 lds
    ds_read_b64_tr_b16 a[90:91], v14 offset:15848
    v_mfma_f32_16x16x32_bf16 v[136:139], a[96:99], a[128:131], v[136:139]
    v_mfma_f32_16x16x32_bf16 v[140:143], a[96:99], a[132:135], v[140:143]
    s_waitcnt lgkmcnt(4)
    v_mfma_f32_16x16x32_bf16 v[144:147], a[100:103], a[120:123], v[144:147]
    ds_read_b64_tr_b16 a[92:93], v14 offset:14128
    v_mfma_f32_16x16x32_bf16 v[148:151], a[100:103], a[124:127], v[148:151]
    ds_read_b64_tr_b16 a[94:95], v14 offset:15856
    v_mfma_f32_16x16x32_bf16 v[152:155], a[100:103], a[128:131], v[152:155]
    v_mfma_f32_16x16x32_bf16 v[156:159], a[100:103], a[132:135], v[156:159]
    v_mfma_f32_16x16x32_bf16 v[160:163], a[80:83], a[120:123], v[160:163]
    s_add_u32 s72, s72, 28672
    s_cmp_eq_u32 s72, 86016
    s_cselect_b32 s72, 0, s72
    s_add_u32 s27, s27, 221184
    s_add_u32 s34, s34, 1
    s_cmp_eq_u32 s34, 9
    s_cselect_b32 s38, 1990656, 0
    s_cselect_b32 s34, 0, s34
    s_sub_u32 s27, s27, s38
    ds_read_b64_tr_b16 a[96:97], v14 offset:14136
    v_mfma_f32_16x16x32_bf16 v[164:167], a[80:83], a[124:127], v[164:167]
    ds_read_b64_tr_b16 a[98:99], v14 offset:15864
    v_mfma_f32_16x16x32_bf16 v[168:171], a[80:83], a[128:131], v[168:171]
    v_mfma_f32_16x16x32_bf16 v[172:175], a[80:83], a[132:135], v[172:175]
    s_waitcnt lgkmcnt(4)
    v_mfma_f32_16x16x32_bf16 v[176:179], a[84:87], a[120:123], v[176:179]
    ds_read_b64_tr_b16 a[100:101], v14 offset:14144
    v_mfma_f32_16x16x32_bf16 v[180:183], a[84:87], a[124:127], v[180:183]
    ds_read_b64_tr_b16 a[102:103], v14 offset:15872
    v_mfma_f32_16x16x32_bf16 v[184:187], a[84:87], a[128:131], v[184:187]
    v_mfma_f32_16x16x32_bf16 v[188:191], a[84:87], a[132:135], v[188:191]
    s_waitcnt vmcnt(7) lgkmcnt(0)
    s_barrier
    v_mfma_f32_16x16x32_bf16 v[192:195], a[88:91], a[120:123], v[192:195]
    ds_read_b64_tr_b16 a[80:81], v15 offset:0
    v_mfma_f32_16x16x32_bf16 v[196:199], a[88:91], a[124:127], v[196:199]
    s_mov_b32 m0, s30
    ds_read_b64_tr_b16 a[82:83], v15 offset:1728
    v_mfma_f32_16x16x32_bf16 v[200:203], a[88:91], a[128:131], v[200:203]
    ds_read_b128 a[104:107], v18 offset:0
    v_mfma_f32_16x16x32_bf16 v[204:207], a[88:91], a[132:135], v[204:207]
    v_mfma_f32_16x16x32_bf16 v[208:211], a[92:95], a[120:123], v[208:211]
    buffer_load_dwordx4 v10, s[8:11], s25 offen offset:0 lds
    ds_read_b64_tr_b16 a[84:85], v15 offset:8
    v_mfma_f32_16x16x32_bf16 v[212:215], a[92:95], a[124:127], v[212:215]
    ds_read_b64_tr_b16 a[86:87], v15 offset:1736
    v_mfma_f32_16x16x32_bf16 v[216:219], a[92:95], a[128:131], v[216:219]
    ds_read_b128 a[108:111], v18 offset:2048
    v_mfma_f32_16x16x32_bf16 v[220:223], a[92:95], a[132:135], v[220:223]
    buffer_load_dwordx4 v11, s[8:11], s25 offen offset:1024 lds
    v_mfma_f32_16x16x32_bf16 v[224:227], a[96:99], a[120:123], v[224:227]
    ds_read_b64_tr_b16 a[88:89], v15 offset:16
    v_mfma_f32_16x16x32_bf16 v[228:231], a[96:99], a[124:127], v[228:231]
    ds_read_b64_tr_b16 a[90:91], v15 offset:1744
    v_mfma_f32_16x16x32_bf16 v[232:235], a[96:99], a[128:131], v[232:235]
    buffer_load_dwordx4 v12, s[8:11], s25 offen offset:2048 lds
    ds_read_b128 a[112:115], v18 offset:4096
    v_mfma_f32_16x16x32_bf16 v[236:239], a[96:99], a[132:135], v[236:239]
    v_mfma_f32_16x16x32_bf16 v[240:243], a[100:103], a[120:123], v[240:243]
    ds_read_b64_tr_b16 a[92:93], v15 offset:24
    v_mfma_f32_16x16x32_bf16 v[244:247], a[100:103], a[124:127], v[244:247]
    buffer_load_dwordx4 v13, s[8:11], s25 offen offset:3072 lds
    ds_read_b64_tr_b16 a[94:95], v15 offset:1752
    v_mfma_f32_16x16x32_bf16 v[248:251], a[100:103], a[128:131], v[248:251]
    ds_read_b128 a[116:119], v18 offset:6144
    v_mfma_f32_16x16x32_bf16 v[252:255], a[100:103], a[132:135], v[252:255]
    v_mov_b32 v14, v15
    s_add_u32 s73, s73, 28672
    s_cmp_eq_u32 s73, 86016
    s_cselect_b32 s73, 0, s73
    v_add_u32 v15, s73, v8
    v_swap_b32 v16, v18
    v_swap_b32 v17, v19
    s_add_u32 s28, s28, 1
    s_cmp_lt_u32 s28, 9
    s_cbranch_scc1 L_att_loop
    s_waitcnt vmcnt(0) lgkmcnt(0)
    s_barrier
    ds_read_b64_tr_b16 a[80:81], v22 offset:0
    ds_read_b64_tr_b16 a[82:83], v22 offset:160
    ds_read_b64_tr_b16 a[84:85], v22 offset:320
    ds_read_b64_tr_b16 a[86:87], v22 offset:480
    ds_read_b64_tr_b16 a[88:89], v22 offset:640
    ds_read_b64_tr_b16 a[90:91], v22 offset:800
    ds_read_b64_tr_b16 a[92:93], v22 offset:8
    ds_read_b64_tr_b16 a[94:95], v22 offset:168
    ds_read_b64_tr_b16 a[96:97], v22 offset:328
    ds_read_b64_tr_b16 a[98:99], v22 offset:488
    ds_read_b64_tr_b16 a[100:101], v22 offset:648
    ds_read_b64_tr_b16 a[102:103], v22 offset:808
    ds_read_b64_tr_b16 a[104:105], v22 offset:16
    ds_read_b64_tr_b16 a[106:107], v22 offset:176
    v_mov_b32 v40, 0
    v_mov_b32 v41, 0
    v_mov_b32 v42, 0
    v_mov_b32 v43, 0
    v_lshlrev_b32 v30, 4, v0
    v_add_u32 v30, 129024, v30
    v_mov_b32 v94, s31
    s_waitcnt lgkmcnt(0)
    ds_read_b64_tr_b16 a[108:109], v22 offset:336
    ds_read_b64_tr_b16 a[110:111], v22 offset:496
    ds_read_b64_tr_b16 a[112:113], v22 offset:656
    ds_read_b64_tr_b16 a[114:115], v22 offset:816
    ds_read_b64_tr_b16 a[116:117], v22 offset:24
    ds_read_b64_tr_b16 a[118:119], v22 offset:184
    ds_read_b64_tr_b16 a[120:121], v22 offset:344
    ds_read_b64_tr_b16 a[122:123], v22 offset:504
    ds_read_b64_tr_b16 a[124:125], v22 offset:664
    ds_read_b64_tr_b16 a[126:127], v22 offset:824
    ds_read_b64_tr_b16 a[128:129], v22 offset:32
    ds_read_b64_tr_b16 a[130:131], v22 offset:192
    ds_read_b64_tr_b16 a[132:133], v22 offset:352
    ds_read_b64_tr_b16 a[134:135], v22 offset:512
    s_waitcnt lgkmcnt(0)
    ds_read_b64_tr_b16 a[136:137], v22 offset:672
    ds_read_b64_tr_b16 a[138:139], v22 offset:832
    ds_write_b128 v30, v[40:43]
    v_cmp_gt_u32 vcc, 224, v0
    s_and_saveexec_b64 s[48:49], vcc
    s_cbranch_execz L_att_z3
    ds_write_b128 v30, v[40:43] offset:4096
L_att_z3:
    s_mov_b64 exec, s[48:49]
    v_cvt_pk_bf16_f32 v24, v96, v97
    v_cvt_pk_bf16_f32 v25, v98, v99
    v_cvt_pk_bf16_f32 v26, v112, v113
    v_cvt_pk_bf16_f32 v27, v114, v115
    v_cvt_pk_bf16_f32 v28, v128, v129
    v_cvt_pk_bf16_f32 v29, v130, v131
    v_cvt_pk_bf16_f32 v30, v144, v145
    v_cvt_pk_bf16_f32 v31, v146, v147
    v_cvt_pk_bf16_f32 v32, v160, v161
    v_cvt_pk_bf16_f32 v33, v162, v163
    v_mov_b32 v34, 0
    v_mov_b32 v35, 0
    v_cvt_pk_bf16_f32 v36, v100, v101
    v_cvt_pk_bf16_f32 v37, v102, v103
    v_cvt_pk_bf16_f32 v38, v116, v117
    v_cvt_pk_bf16_f32 v39, v118, v119
    v_cvt_pk_bf16_f32 v40, v132, v133
    v_cvt_pk_bf16_f32 v41, v134, v135
    v_cvt_pk_bf16_f32 v42, v148, v149
    v_cvt_pk_bf16_f32 v43, v150, v151
    v_cvt_pk_bf16_f32 v44, v164, v165
    v_cvt_pk_bf16_f32 v45, v166, v167
    v_mov_b32 v46, 0
    v_mov_b32 v47, 0
    v_cvt_pk_bf16_f32 v48, v104, v105
    v_cvt_pk_bf16_f32 v49, v106, v107
    v_cvt_pk_bf16_f32 v50, v120, v121
    v_cvt_pk_bf16_f32 v51, v122, v123
    v_cvt_pk_bf16_f32 v52, v136, v137
    v_cvt_pk_bf16_f32 v53, v138, v139
    v_cvt_pk_bf16_f32 v54, v152, v153
    v_cvt_pk_bf16_f32 v55, v154, v155
    v_cvt_pk_bf16_f32 v56, v168, v169
    v_cvt_pk_bf16_f32 v57, v170, v171
    v_mov_b32 v58, 0
    v_mov_b32 v59, 0
    v_cvt_pk_bf16_f32 v60, v108, v109
    v_cvt_pk_bf16_f32 v61, v110, v111
    v_cvt_pk_bf16_f32 v62, v124, v125
    v_cvt_pk_bf16_f32 v63, v126, v127
    v_cvt_pk_bf16_f32 v64, v140, v141
    v_cvt_pk_bf16_f32 v65, v142, v143
    v_cvt_pk_bf16_f32 v66, v156, v157
    v_cvt_pk_bf16_f32 v67, v158, v159
    v_cvt_pk_bf16_f32 v68, v172, v173
    v_cvt_pk_bf16_f32 v69, v174, v175
    v_mov_b32 v70, 0
    v_mov_b32 v71, 0
    s_waitcnt lgkmcnt(0)
    s_nop 1
    v_mfma_f32_16x16x32_bf16 v[96:99], a[80:83], v[24:27], 0
    v_mfma_f32_16x16x32_bf16 v[112:115], a[92:95], v[24:27], 0
    v_mfma_f32_16x16x32_bf16 v[128:131], a[104:107], v[24:27], 0
    v_mfma_f32_16x16x32_bf16 v[144:147], a[116:119], v[24:27], 0
    v_mfma_f32_16x16x32_bf16 v[160:163], a[128:131], v[24:27], 0
    v_mfma_f32_16x16x32_bf16 v[96:99], a[84:87], v[28:31], v[96:99]
    v_mfma_f32_16x16x32_bf16 v[112:115], a[96:99], v[28:31], v[112:115]
    v_mfma_f32_16x16x32_bf16 v[128:131], a[108:111], v[28:31], v[128:131]
    v_mfma_f32_16x16x32_bf16 v[144:147], a[120:123], v[28:31], v[144:147]
    v_mfma_f32_16x16x32_bf16 v[160:163], a[132:135], v[28:31], v[160:163]
    v_mfma_f32_16x16x32_bf16 v[96:99], a[88:91], v[32:35], v[96:99]
    v_mfma_f32_16x16x32_bf16 v[112:115], a[100:103], v[32:35], v[112:115]
    v_mfma_f32_16x16x32_bf16 v[128:131], a[112:115], v[32:35], v[128:131]
    v_mfma_f32_16x16x32_bf16 v[144:147], a[124:127], v[32:35], v[144:147]
    v_mfma_f32_16x16x32_bf16 v[160:163], a[136:139], v[32:35], v[160:163]
    v_mfma_f32_16x16x32_bf16 v[100:103], a[80:83], v[36:39], 0
    v_mfma_f32_16x16x32_bf16 v[116:119], a[92:95], v[36:39], 0
    v_mfma_f32_16x16x32_bf16 v[132:135], a[104:107], v[36:39], 0
    v_mfma_f32_16x16x32_bf16 v[148:151], a[116:119], v[36:39], 0
    v_mfma_f32_16x16x32_bf16 v[164:167], a[128:131], v[36:39], 0
    v_mfma_f32_16x16x32_bf16 v[100:103], a[84:87], v[40:43], v[100:103]
    v_mfma_f32_16x16x32_bf16 v[116:119], a[96:99], v[40:43], v[116:119]
    v_mfma_f32_16x16x32_bf16 v[132:135], a[108:111], v[40:43], v[132:135]
    v_mfma_f32_16x16x32_bf16 v[148:151], a[120:123], v[40:43], v[148:151]
    v_mfma_f32_16x16x32_bf16 v[164:167], a[132:135], v[40:43], v[164:167]
    v_mfma_f32_16x16x32_bf16 v[100:103], a[88:91], v[44:47], v[100:103]
    v_mfma_f32_16x16x32_bf16 v[116:119], a[100:103], v[44:47], v[116:119]
    v_mfma_f32_16x16x32_bf16 v[132:135], a[112:115], v[44:47], v[132:135]
    v_mfma_f32_16x16x32_bf16 v[148:151], a[124:127], v[44:47], v[148:151]
    v_mfma_f32_16x16x32_bf16 v[164:167], a[136:139], v[44:47], v[164:167]
    v_mfma_f32_16x16x32_bf16 v[104:107], a[80:83], v[48:51], 0
    v_mfma_f32_16x16x32_bf16 v[120:123], a[92:95], v[48:51], 0
    v_mfma_f32_16x16x32_bf16 v[136:139], a[104:107], v[48:51], 0
    v_mfma_f32_16x16x32_bf16 v[152:155], a[116:119], v[48:51], 0
    v_mfma_f32_16x16x32_bf16 v[168:171], a[128:131], v[48:51], 0
    v_mfma_f32_16x16x32_bf16 v[104:107], a[84:87], v[52:55], v[104:107]
    v_mfma_f32_16x16x32_bf16 v[120:123], a[96:99], v[52:55], v[120:123]
    v_mfma_f32_16x16x32_bf16 v[136:139], a[108:111], v[52:55], v[136:139]
    v_mfma_f32_16x16x32_bf16 v[152:155], a[120:123], v[52:55], v[152:155]
    v_mfma_f32_16x16x32_bf16 v[168:171], a[132:135], v[52:55], v[168:171]
    v_mfma_f32_16x16x32_bf16 v[104:107], a[88:91], v[56:59], v[104:107]
    v_mfma_f32_16x16x32_bf16 v[120:123], a[100:103], v[56:59], v[120:123]
    v_mfma_f32_16x16x32_bf16 v[136:139], a[112:115], v[56:59], v[136:139]
    v_mfma_f32_16x16x32_bf16 v[152:155], a[124:127], v[56:59], v[152:155]
    v_mfma_f32_16x16x32_bf16 v[168:171], a[136:139], v[56:59], v[168:171]
    v_mfma_f32_16x16x32_bf16 v[108:111], a[80:83], v[60:63], 0
    v_mfma_f32_16x16x32_bf16 v[124:127], a[92:95], v[60:63], 0
    v_mfma_f32_16x16x32_bf16 v[140:143], a[104:107], v[60:63], 0
    v_mfma_f32_16x16x32_bf16 v[156:159], a[116:119], v[60:63], 0
    v_mfma_f32_16x16x32_bf16 v[172:175], a[128:131], v[60:63], 0
    v_mfma_f32_16x16x32_bf16 v[108:111], a[84:87], v[64:67], v[108:111]
    v_mfma_f32_16x16x32_bf16 v[124:127], a[96:99], v[64:67], v[124:127]
    v_mfma_f32_16x16x32_bf16 v[140:143], a[108:111], v[64:67], v[140:143]
    v_mfma_f32_16x16x32_bf16 v[156:159], a[120:123], v[64:67], v[156:159]
    v_mfma_f32_16x16x32_bf16 v[172:175], a[132:135], v[64:67], v[172:175]
    v_mfma_f32_16x16x32_bf16 v[108:111], a[88:91], v[68:71], v[108:111]
    v_mfma_f32_16x16x32_bf16 v[124:127], a[100:103], v[68:71], v[124:127]
    v_mfma_f32_16x16x32_bf16 v[140:143], a[112:115], v[68:71], v[140:143]
    v_mfma_f32_16x16x32_bf16 v[156:159], a[124:127], v[68:71], v[156:159]
    v_mfma_f32_16x16x32_bf16 v[172:175], a[136:139], v[68:71], v[172:175]
    s_nop 7
    v_and_b32 v72, 15, v20
    v_lshrrev_b32 v73, 4, v20
    s_lshl_b32 s38, s24, 6
    v_add_u32 v72, s38, v72
    v_mul_u32_u24 v74, 336, v72
    v_mul_u32_u24 v75, 80, v73
    v_add_u32 v74, v74, v75
    v_mul_u32_u24 v75, 168, v72
    v_mul_u32_u24 v76, 40, v73
    v_add_u32 v75, v75, v76
    v_add_u32 v75, 86016, v75
    v_and_b32 v76, 1, v73
    v_cmp_eq_u32 s[58:59], 1, v76
    v_mov_b32 v70, 1.0
    v_mov_b32 v71, 0
    v_max3_f32 v60, v96, v97, v98
    v_min3_f32 v62, v96, v97, v98
    v_max3_f32 v60, v60, v99, v112
    v_min3_f32 v62, v62, v99, v112
    v_max3_f32 v60, v60, v113, v114
    v_min3_f32 v62, v62, v113, v114
    v_max3_f32 v60, v60, v115, v128
    v_min3_f32 v62, v62, v115, v128
    v_max3_f32 v60, v60, v129, v130
    v_min3_f32 v62, v62, v129, v130
    v_max3_f32 v60, v60, v131, v144
    v_min3_f32 v62, v62, v131, v144
    v_max3_f32 v60, v60, v145, v146
    v_min3_f32 v62, v62, v145, v146
    v_max3_f32 v60, v60, v147, v160
    v_min3_f32 v62, v62, v147, v160
    v_max_f32 v60, v60, v161
    v_min_f32 v62, v62, v161
    v_mul_f32_e64 v60, -s31, v60
    v_mul_f32 v62, s31, v62
    v_pk_fma_f32 v[24:25], v[96:97], v[94:95], v[60:61] op_sel_hi:[1,0,0]
    v_pk_fma_f32 v[42:43], v[96:97], v[94:95], v[62:63] op_sel_hi:[1,0,0] neg_lo:[0,1,0] neg_hi:[0,1,0]
    v_pk_fma_f32 v[26:27], v[98:99], v[94:95], v[60:61] op_sel_hi:[1,0,0]
    v_pk_fma_f32 v[44:45], v[98:99], v[94:95], v[62:63] op_sel_hi:[1,0,0] neg_lo:[0,1,0] neg_hi:[0,1,0]
    v_pk_fma_f32 v[28:29], v[112:113], v[94:95], v[60:61] op_sel_hi:[1,0,0]
    v_pk_fma_f32 v[46:47], v[112:113], v[94:95], v[62:63] op_sel_hi:[1,0,0] neg_lo:[0,1,0] neg_hi:[0,1,0]
    v_pk_fma_f32 v[30:31], v[114:115], v[94:95], v[60:61] op_sel_hi:[1,0,0]
    v_pk_fma_f32 v[48:49], v[114:115], v[94:95], v[62:63] op_sel_hi:[1,0,0] neg_lo:[0,1,0] neg_hi:[0,1,0]
    v_pk_fma_f32 v[32:33], v[128:129], v[94:95], v[60:61] op_sel_hi:[1,0,0]
    v_pk_fma_f32 v[50:51], v[128:129], v[94:95], v[62:63] op_sel_hi:[1,0,0] neg_lo:[0,1,0] neg_hi:[0,1,0]
    v_pk_fma_f32 v[34:35], v[130:131], v[94:95], v[60:61] op_sel_hi:[1,0,0]
    v_pk_fma_f32 v[52:53], v[130:131], v[94:95], v[62:63] op_sel_hi:[1,0,0] neg_lo:[0,1,0] neg_hi:[0,1,0]
    v_pk_fma_f32 v[36:37], v[144:145], v[94:95], v[60:61] op_sel_hi:[1,0,0]
    v_pk_fma_f32 v[54:55], v[144:145], v[94:95], v[62:63] op_sel_hi:[1,0,0] neg_lo:[0,1,0] neg_hi:[0,1,0]
    v_pk_fma_f32 v[38:39], v[146:147], v[94:95], v[60:61] op_sel_hi:[1,0,0]
    v_pk_fma_f32 v[56:57], v[146:147], v[94:95], v[62:63] op_sel_hi:[1,0,0] neg_lo:[0,1,0] neg_hi:[0,1,0]
    v_pk_fma_f32 v[40:41], v[160:161], v[94:95], v[60:61] op_sel_hi:[1,0,0]
    v_pk_fma_f32 v[58:59], v[160:161], v[94:95], v[62:63] op_sel_hi:[1,0,0] neg_lo:[0,1,0] neg_hi:[0,1,0]
    v_exp_f32 v24, v24
    v_exp_f32 v42, v42
    v_exp_f32 v25, v25
    v_exp_f32 v43, v43
    v_exp_f32 v26, v26
    v_exp_f32 v44, v44
    v_exp_f32 v27, v27
    v_exp_f32 v45, v45
    v_exp_f32 v28, v28
    v_exp_f32 v46, v46
    v_exp_f32 v29, v29
    v_exp_f32 v47, v47
    v_exp_f32 v30, v30
    v_exp_f32 v48, v48
    v_exp_f32 v31, v31
    v_exp_f32 v49, v49
    v_exp_f32 v32, v32
    v_exp_f32 v50, v50
    v_exp_f32 v33, v33
    v_exp_f32 v51, v51
    v_exp_f32 v34, v34
    v_exp_f32 v52, v52
    v_exp_f32 v35, v35
    v_exp_f32 v53, v53
    v_exp_f32 v36, v36
    v_exp_f32 v54, v54
    v_exp_f32 v37, v37
    v_exp_f32 v55, v55
    v_exp_f32 v38, v38
    v_exp_f32 v56, v56
    v_exp_f32 v39, v39
    v_exp_f32 v57, v57
    v_exp_f32 v40, v40
    v_exp_f32 v58, v58
    v_exp_f32 v41, v41
    v_exp_f32 v59, v59
    v_pk_add_f32 v[64:65], v[24:25], v[26:27]
    s_nop 0
    v_pk_add_f32 v[66:67], v[42:43], v[44:45]
    v_pk_add_f32 v[64:65], v[64:65], v[28:29]
    v_pk_add_f32 v[66:67], v[66:67], v[46:47]
    v_pk_add_f32 v[64:65], v[64:65], v[30:31]
    v_pk_add_f32 v[66:67], v[66:67], v[48:49]
    v_pk_add_f32 v[64:65], v[64:65], v[32:33]
    v_pk_add_f32 v[66:67], v[66:67], v[50:51]
    v_pk_add_f32 v[64:65], v[64:65], v[34:35]
    v_pk_add_f32 v[66:67], v[66:67], v[52:53]
    v_pk_add_f32 v[64:65], v[64:65], v[36:37]
    v_pk_add_f32 v[66:67], v[66:67], v[54:55]
    v_pk_add_f32 v[64:65], v[64:65], v[38:39]
    v_pk_add_f32 v[66:67], v[66:67], v[56:57]
    v_pk_add_f32 v[64:65], v[64:65], v[40:41]
    v_pk_add_f32 v[66:67], v[66:67], v[58:59]
    v_add_f32 v64, v64, v65
    v_add_f32 v66, v66, v67
    v_rcp_f32 v64, v64
    v_rcp_f32 v66, v66
    s_nop 0
    v_pk_mul_f32 v[24:25], v[24:25], v[64:65] op_sel_hi:[1,0]
    v_pk_mul_f32 v[42:43], v[42:43], v[66:67] op_sel_hi:[1,0]
    v_pk_mul_f32 v[26:27], v[26:27], v[64:65] op_sel_hi:[1,0]
    v_pk_mul_f32 v[44:45], v[44:45], v[66:67] op_sel_hi:[1,0]
    v_pk_mul_f32 v[28:29], v[28:29], v[64:65] op_sel_hi:[1,0]
    v_pk_mul_f32 v[46:47], v[46:47], v[66:67] op_sel_hi:[1,0]
    v_pk_mul_f32 v[30:31], v[30:31], v[64:65] op_sel_hi:[1,0]
    v_pk_mul_f32 v[48:49], v[48:49], v[66:67] op_sel_hi:[1,0]
    v_pk_mul_f32 v[32:33], v[32:33], v[64:65] op_sel_hi:[1,0]
    v_pk_mul_f32 v[50:51], v[50:51], v[66:67] op_sel_hi:[1,0]
    v_pk_mul_f32 v[34:35], v[34:35], v[64:65] op_sel_hi:[1,0]
    v_pk_mul_f32 v[52:53], v[52:53], v[66:67] op_sel_hi:[1,0]
    v_pk_mul_f32 v[36:37], v[36:37], v[64:65] op_sel_hi:[1,0]
    v_pk_mul_f32 v[54:55], v[54:55], v[66:67] op_sel_hi:[1,0]
    v_pk_mul_f32 v[38:39], v[38:39], v[64:65] op_sel_hi:[1,0]
    v_pk_mul_f32 v[56:57], v[56:57], v[66:67] op_sel_hi:[1,0]
    v_pk_mul_f32 v[40:41], v[40:41], v[64:65] op_sel_hi:[1,0]
    v_pk_mul_f32 v[58:59], v[58:59], v[66:67] op_sel_hi:[1,0]
    s_waitcnt lgkmcnt(0)
    v_cvt_pk_bf16_f32 v76, v24, v25
    v_cvt_pk_bf16_f32 v77, v26, v27
    v_cvt_pk_bf16_f32 v78, v28, v29
    v_cvt_pk_bf16_f32 v79, v30, v31
    v_cvt_pk_bf16_f32 v80, v32, v33
    v_cvt_pk_bf16_f32 v81, v34, v35
    v_cvt_pk_bf16_f32 v82, v36, v37
    v_cvt_pk_bf16_f32 v83, v38, v39
    v_cvt_pk_bf16_f32 v84, v40, v41
    v_cvt_pk_bf16_f32 v85, v42, v43
    v_cvt_pk_bf16_f32 v86, v44, v45
    v_cvt_pk_bf16_f32 v87, v46, v47
    v_cvt_pk_bf16_f32 v88, v48, v49
    v_cvt_pk_bf16_f32 v89, v50, v51
    v_cvt_pk_bf16_f32 v90, v52, v53
    v_cvt_pk_bf16_f32 v91, v54, v55
    v_cvt_pk_bf16_f32 v92, v56, v57
    v_cvt_pk_bf16_f32 v93, v58, v59
    v_cndmask_b32 v176, v176, v70, s[58:59]
    v_cndmask_b32 v177, v177, v71, s[58:59]
    v_cndmask_b32 v242, v70, v242, s[58:59]
    v_cndmask_b32 v243, v71, v243, s[58:59]
    v_cvt_pk_bf16_f32 v176, v176, v177
    v_cvt_pk_bf16_f32 v177, v178, v179
    v_cvt_pk_bf16_f32 v192, v192, v193
    v_cvt_pk_bf16_f32 v193, v194, v195
    v_cvt_pk_bf16_f32 v208, v208, v209
    v_cvt_pk_bf16_f32 v209, v210, v211
    v_cvt_pk_bf16_f32 v224, v224, v225
    v_cvt_pk_bf16_f32 v225, v226, v227
    v_cvt_pk_bf16_f32 v240, v240, v241
    v_cvt_pk_bf16_f32 v241, v242, v243
    v_max3_f32 v60, v100, v101, v102
    v_min3_f32 v62, v100, v101, v102
    v_max3_f32 v60, v60, v103, v116
    v_min3_f32 v62, v62, v103, v116
    v_max3_f32 v60, v60, v117, v118
    v_min3_f32 v62, v62, v117, v118
    v_max3_f32 v60, v60, v119, v132
    v_min3_f32 v62, v62, v119, v132
    v_max3_f32 v60, v60, v133, v134
    v_min3_f32 v62, v62, v133, v134
    ds_write_b128 v74, v[76:79] offset:0
    v_max3_f32 v60, v60, v135, v148
    v_min3_f32 v62, v62, v135, v148
    v_max3_f32 v60, v60, v149, v150
    v_min3_f32 v62, v62, v149, v150
    v_max3_f32 v60, v60, v151, v164
    v_min3_f32 v62, v62, v151, v164
    v_max_f32 v60, v60, v165
    v_min_f32 v62, v62, v165
    v_mul_f32_e64 v60, -s31, v60
    v_mul_f32 v62, s31, v62
    ds_write_b128 v74, v[80:83] offset:16
    v_pk_fma_f32 v[24:25], v[100:101], v[94:95], v[60:61] op_sel_hi:[1,0,0]
    v_pk_fma_f32 v[42:43], v[100:101], v[94:95], v[62:63] op_sel_hi:[1,0,0] neg_lo:[0,1,0] neg_hi:[0,1,0]
    v_pk_fma_f32 v[26:27], v[102:103], v[94:95], v[60:61] op_sel_hi:[1,0,0]
    v_pk_fma_f32 v[44:45], v[102:103], v[94:95], v[62:63] op_sel_hi:[1,0,0] neg_lo:[0,1,0] neg_hi:[0,1,0]
    v_pk_fma_f32 v[28:29], v[116:117], v[94:95], v[60:61] op_sel_hi:[1,0,0]
    v_pk_fma_f32 v[46:47], v[116:117], v[94:95], v[62:63] op_sel_hi:[1,0,0] neg_lo:[0,1,0] neg_hi:[0,1,0]
    v_pk_fma_f32 v[30:31], v[118:119], v[94:95], v[60:61] op_sel_hi:[1,0,0]
    v_pk_fma_f32 v[48:49], v[118:119], v[94:95], v[62:63] op_sel_hi:[1,0,0] neg_lo:[0,1,0] neg_hi:[0,1,0]
    v_pk_fma_f32 v[32:33], v[132:133], v[94:95], v[60:61] op_sel_hi:[1,0,0]
    v_pk_fma_f32 v[50:51], v[132:133], v[94:95], v[62:63] op_sel_hi:[1,0,0] neg_lo:[0,1,0] neg_hi:[0,1,0]
    ds_write_b128 v74, v[84:87] offset:32
    v_pk_fma_f32 v[34:35], v[134:135], v[94:95], v[60:61] op_sel_hi:[1,0,0]
    v_pk_fma_f32 v[52:53], v[134:135], v[94:95], v[62:63] op_sel_hi:[1,0,0] neg_lo:[0,1,0] neg_hi:[0,1,0]
    v_pk_fma_f32 v[36:37], v[148:149], v[94:95], v[60:61] op_sel_hi:[1,0,0]
    v_pk_fma_f32 v[54:55], v[148:149], v[94:95], v[62:63] op_sel_hi:[1,0,0] neg_lo:[0,1,0] neg_hi:[0,1,0]
    v_pk_fma_f32 v[38:39], v[150:151], v[94:95], v[60:61] op_sel_hi:[1,0,0]
    v_pk_fma_f32 v[56:57], v[150:151], v[94:95], v[62:63] op_sel_hi:[1,0,0] neg_lo:[0,1,0] neg_hi:[0,1,0]
    v_pk_fma_f32 v[40:41], v[164:165], v[94:95], v[60:61] op_sel_hi:[1,0,0]
    v_pk_fma_f32 v[58:59], v[164:165], v[94:95], v[62:63] op_sel_hi:[1,0,0] neg_lo:[0,1,0] neg_hi:[0,1,0]
    v_exp_f32 v24, v24
    v_exp_f32 v42, v42
    ds_write_b128 v74, v[88:91] offset:48
    v_exp_f32 v25, v25
    v_exp_f32 v43, v43
    v_exp_f32 v26, v26
    v_exp_f32 v44, v44
    v_exp_f32 v27, v27
    v_exp_f32 v45, v45
    v_exp_f32 v28, v28
    v_exp_f32 v46, v46
    v_exp_f32 v29, v29
    v_exp_f32 v47, v47
    ds_write_b64 v74, v[92:93] offset:64
    v_exp_f32 v30, v30
    v_exp_f32 v48, v48
    v_exp_f32 v31, v31
    v_exp_f32 v49, v49
    v_exp_f32 v32, v32
    v_exp_f32 v50, v50
    v_exp_f32 v33, v33
    v_exp_f32 v51, v51
    v_exp_f32 v34, v34
    v_exp_f32 v52, v52
    ds_write_b64 v75, v[176:177] offset:0
    v_exp_f32 v35, v35
    v_exp_f32 v53, v53
    v_exp_f32 v36, v36
    v_exp_f32 v54, v54
    v_exp_f32 v37, v37
    v_exp_f32 v55, v55
    v_exp_f32 v38, v38
    v_exp_f32 v56, v56
    v_exp_f32 v39, v39
    v_exp_f32 v57, v57
    ds_write_b64 v75, v[192:193] offset:8
    v_exp_f32 v40, v40
    v_exp_f32 v58, v58
    v_exp_f32 v41, v41
    v_exp_f32 v59, v59
    v_pk_add_f32 v[64:65], v[24:25], v[26:27]
    s_nop 0
    v_pk_add_f32 v[66:67], v[42:43], v[44:45]
    v_pk_add_f32 v[64:65], v[64:65], v[28:29]
    v_pk_add_f32 v[66:67], v[66:67], v[46:47]
    v_pk_add_f32 v[64:65], v[64:65], v[30:31]
    ds_write_b64 v75, v[208:209] offset:16
    v_pk_add_f32 v[66:67], v[66:67], v[48:49]
    v_pk_add_f32 v[64:65], v[64:65], v[32:33]
    v_pk_add_f32 v[66:67], v[66:67], v[50:51]
    v_pk_add_f32 v[64:65], v[64:65], v[34:35]
    v_pk_add_f32 v[66:67], v[66:67], v[52:53]
    v_pk_add_f32 v[64:65], v[64:65], v[36:37]
    v_pk_add_f32 v[66:67], v[66:67], v[54:55]
    v_pk_add_f32 v[64:65], v[64:65], v[38:39]
    v_pk_add_f32 v[66:67], v[66:67], v[56:57]
    v_pk_add_f32 v[64:65], v[64:65], v[40:41]
    ds_write_b64 v75, v[224:225] offset:24
    v_pk_add_f32 v[66:67], v[66:67], v[58:59]
    v_add_f32 v64, v64, v65
    v_add_f32 v66, v66, v67
    v_rcp_f32 v64, v64
    v_rcp_f32 v66, v66
    s_nop 0
    v_pk_mul_f32 v[24:25], v[24:25], v[64:65] op_sel_hi:[1,0]
    v_pk_mul_f32 v[42:43], v[42:43], v[66:67] op_sel_hi:[1,0]
    v_pk_mul_f32 v[26:27], v[26:27], v[64:65] op_sel_hi:[1,0]
    v_pk_mul_f32 v[44:45], v[44:45], v[66:67] op_sel_hi:[1,0]
    ds_write_b64 v75, v[240:241] offset:32
    v_pk_mul_f32 v[28:29], v[28:29], v[64:65] op_sel_hi:[1,0]
    v_pk_mul_f32 v[46:47], v[46:47], v[66:67] op_sel_hi:[1,0]
    v_pk_mul_f32 v[30:31], v[30:31], v[64:65] op_sel_hi:[1,0]
    v_pk_mul_f32 v[48:49], v[48:49], v[66:67] op_sel_hi:[1,0]
    v_pk_mul_f32 v[32:33], v[32:33], v[64:65] op_sel_hi:[1,0]
    v_pk_mul_f32 v[50:51], v[50:51], v[66:67] op_sel_hi:[1,0]
    v_pk_mul_f32 v[34:35], v[34:35], v[64:65] op_sel_hi:[1,0]
    v_pk_mul_f32 v[52:53], v[52:53], v[66:67] op_sel_hi:[1,0]
    v_pk_mul_f32 v[36:37], v[36:37], v[64:65] op_sel_hi:[1,0]
    v_pk_mul_f32 v[54:55], v[54:55], v[66:67] op_sel_hi:[1,0]
    v_pk_mul_f32 v[38:39], v[38:39], v[64:65] op_sel_hi:[1,0]
    v_pk_mul_f32 v[56:57], v[56:57], v[66:67] op_sel_hi:[1,0]
    v_pk_mul_f32 v[40:41], v[40:41], v[64:65] op_sel_hi:[1,0]
    v_pk_mul_f32 v[58:59], v[58:59], v[66:67] op_sel_hi:[1,0]
    s_waitcnt lgkmcnt(0)
    v_cvt_pk_bf16_f32 v96, v24, v25
    v_cvt_pk_bf16_f32 v97, v26, v27
    v_cvt_pk_bf16_f32 v98, v28, v29
    v_cvt_pk_bf16_f32 v99, v30, v31
    v_cvt_pk_bf16_f32 v112, v32, v33
    v_cvt_pk_bf16_f32 v113, v34, v35
    v_cvt_pk_bf16_f32 v114, v36, v37
    v_cvt_pk_bf16_f32 v115, v38, v39
    v_cvt_pk_bf16_f32 v128, v40, v41
    v_cvt_pk_bf16_f32 v129, v42, v43
    v_cvt_pk_bf16_f32 v130, v44, v45
    v_cvt_pk_bf16_f32 v131, v46, v47
    v_cvt_pk_bf16_f32 v144, v48, v49
    v_cvt_pk_bf16_f32 v145, v50, v51
    v_cvt_pk_bf16_f32 v146, v52, v53
    v_cvt_pk_bf16_f32 v147, v54, v55
    v_cvt_pk_bf16_f32 v160, v56, v57
    v_cvt_pk_bf16_f32 v161, v58, v59
    v_cndmask_b32 v180, v180, v70, s[58:59]
    v_cndmask_b32 v181, v181, v71, s[58:59]
    v_cndmask_b32 v246, v70, v246, s[58:59]
    v_cndmask_b32 v247, v71, v247, s[58:59]
    v_cvt_pk_bf16_f32 v180, v180, v181
    v_cvt_pk_bf16_f32 v181, v182, v183
    v_cvt_pk_bf16_f32 v196, v196, v197
    v_cvt_pk_bf16_f32 v197, v198, v199
    v_cvt_pk_bf16_f32 v212, v212, v213
    v_cvt_pk_bf16_f32 v213, v214, v215
    v_cvt_pk_bf16_f32 v228, v228, v229
    v_cvt_pk_bf16_f32 v229, v230, v231
    v_cvt_pk_bf16_f32 v244, v244, v245
    v_cvt_pk_bf16_f32 v245, v246, v247
    v_max3_f32 v60, v104, v105, v106
    v_min3_f32 v62, v104, v105, v106
    v_max3_f32 v60, v60, v107, v120
    v_min3_f32 v62, v62, v107, v120
    v_max3_f32 v60, v60, v121, v122
    v_min3_f32 v62, v62, v121, v122
    v_max3_f32 v60, v60, v123, v136
    v_min3_f32 v62, v62, v123, v136
    v_max3_f32 v60, v60, v137, v138
    v_min3_f32 v62, v62, v137, v138
    ds_write_b128 v74, v[96:99] offset:5376
    v_max3_f32 v60, v60, v139, v152
    v_min3_f32 v62, v62, v139, v152
    v_max3_f32 v60, v60, v153, v154
    v_min3_f32 v62, v62, v153, v154
    v_max3_f32 v60, v60, v155, v168
    v_min3_f32 v62, v62, v155, v168
    v_max_f32 v60, v60, v169
    v_min_f32 v62, v62, v169
    v_mul_f32_e64 v60, -s31, v60
    v_mul_f32 v62, s31, v62
    ds_write_b128 v74, v[112:115] offset:5392
    v_pk_fma_f32 v[24:25], v[104:105], v[94:95], v[60:61] op_sel_hi:[1,0,0]
    v_pk_fma_f32 v[42:43], v[104:105], v[94:95], v[62:63] op_sel_hi:[1,0,0] neg_lo:[0,1,0] neg_hi:[0,1,0]
    v_pk_fma_f32 v[26:27], v[106:107], v[94:95], v[60:61] op_sel_hi:[1,0,0]
    v_pk_fma_f32 v[44:45], v[106:107], v[94:95], v[62:63] op_sel_hi:[1,0,0] neg_lo:[0,1,0] neg_hi:[0,1,0]
    v_pk_fma_f32 v[28:29], v[120:121], v[94:95], v[60:61] op_sel_hi:[1,0,0]
    v_pk_fma_f32 v[46:47], v[120:121], v[94:95], v[62:63] op_sel_hi:[1,0,0] neg_lo:[0,1,0] neg_hi:[0,1,0]
    v_pk_fma_f32 v[30:31], v[122:123], v[94:95], v[60:61] op_sel_hi:[1,0,0]
    v_pk_fma_f32 v[48:49], v[122:123], v[94:95], v[62:63] op_sel_hi:[1,0,0] neg_lo:[0,1,0] neg_hi:[0,1,0]
    v_pk_fma_f32 v[32:33], v[136:137], v[94:95], v[60:61] op_sel_hi:[1,0,0]
    v_pk_fma_f32 v[50:51], v[136:137], v[94:95], v[62:63] op_sel_hi:[1,0,0] neg_lo:[0,1,0] neg_hi:[0,1,0]
    ds_write_b128 v74, v[128:131] offset:5408
    v_pk_fma_f32 v[34:35], v[138:139], v[94:95], v[60:61] op_sel_hi:[1,0,0]
    v_pk_fma_f32 v[52:53], v[138:139], v[94:95], v[62:63] op_sel_hi:[1,0,0] neg_lo:[0,1,0] neg_hi:[0,1,0]
    v_pk_fma_f32 v[36:37], v[152:153], v[94:95], v[60:61] op_sel_hi:[1,0,0]
    v_pk_fma_f32 v[54:55], v[152:153], v[94:95], v[62:63] op_sel_hi:[1,0,0] neg_lo:[0,1,0] neg_hi:[0,1,0]
    v_pk_fma_f32 v[38:39], v[154:155], v[94:95], v[60:61] op_sel_hi:[1,0,0]
    v_pk_fma_f32 v[56:57], v[154:155], v[94:95], v[62:63] op_sel_hi:[1,0,0] neg_lo:[0,1,0] neg_hi:[0,1,0]
    v_pk_fma_f32 v[40:41], v[168:169], v[94:95], v[60:61] op_sel_hi:[1,0,0]
    v_pk_fma_f32 v[58:59], v[168:169], v[94:95], v[62:63] op_sel_hi:[1,0,0] neg_lo:[0,1,0] neg_hi:[0,1,0]
    v_exp_f32 v24, v24
    v_exp_f32 v42, v42
    ds_write_b128 v74, v[144:147] offset:5424
    v_exp_f32 v25, v25
    v_exp_f32 v43, v43
    v_exp_f32 v26, v26
    v_exp_f32 v44, v44
    v_exp_f32 v27, v27
    v_exp_f32 v45, v45
    v_exp_f32 v28, v28
    v_exp_f32 v46, v46
    v_exp_f32 v29, v29
    v_exp_f32 v47, v47
    ds_write_b64 v74, v[160:161] offset:5440
    v_exp_f32 v30, v30
    v_exp_f32 v48, v48
    v_exp_f32 v31, v31
    v_exp_f32 v49, v49
    v_exp_f32 v32, v32
    v_exp_f32 v50, v50
    v_exp_f32 v33, v33
    v_exp_f32 v51, v51
    v_exp_f32 v34, v34
    v_exp_f32 v52, v52
    ds_write_b64 v75, v[180:181] offset:2688
    v_exp_f32 v35, v35
    v_exp_f32 v53, v53
    v_exp_f32 v36, v36
    v_exp_f32 v54, v54
    v_exp_f32 v37, v37
    v_exp_f32 v55, v55
    v_exp_f32 v38, v38
    v_exp_f32 v56, v56
    v_exp_f32 v39, v39
    v_exp_f32 v57, v57
    ds_write_b64 v75, v[196:197] offset:2696
    v_exp_f32 v40, v40
    v_exp_f32 v58, v58
    v_exp_f32 v41, v41
    v_exp_f32 v59, v59
    v_pk_add_f32 v[64:65], v[24:25], v[26:27]
    s_nop 0
    v_pk_add_f32 v[66:67], v[42:43], v[44:45]
    v_pk_add_f32 v[64:65], v[64:65], v[28:29]
    v_pk_add_f32 v[66:67], v[66:67], v[46:47]
    v_pk_add_f32 v[64:65], v[64:65], v[30:31]
    ds_write_b64 v75, v[212:213] offset:2704
    v_pk_add_f32 v[66:67], v[66:67], v[48:49]
    v_pk_add_f32 v[64:65], v[64:65], v[32:33]
    v_pk_add_f32 v[66:67], v[66:67], v[50:51]
    v_pk_add_f32 v[64:65], v[64:65], v[34:35]
    v_pk_add_f32 v[66:67], v[66:67], v[52:53]
    v_pk_add_f32 v[64:65], v[64:65], v[36:37]
    v_pk_add_f32 v[66:67], v[66:67], v[54:55]
    v_pk_add_f32 v[64:65], v[64:65], v[38:39]
    v_pk_add_f32 v[66:67], v[66:67], v[56:57]
    v_pk_add_f32 v[64:65], v[64:65], v[40:41]
    ds_write_b64 v75, v[228:229] offset:2712
    v_pk_add_f32 v[66:67], v[66:67], v[58:59]
    v_add_f32 v64, v64, v65
    v_add_f32 v66, v66, v67
    v_rcp_f32 v64, v64
    v_rcp_f32 v66, v66
    s_nop 0
    v_pk_mul_f32 v[24:25], v[24:25], v[64:65] op_sel_hi:[1,0]
    v_pk_mul_f32 v[42:43], v[42:43], v[66:67] op_sel_hi:[1,0]
    v_pk_mul_f32 v[26:27], v[26:27], v[64:65] op_sel_hi:[1,0]
    v_pk_mul_f32 v[44:45], v[44:45], v[66:67] op_sel_hi:[1,0]
    ds_write_b64 v75, v[244:245] offset:2720
    v_pk_mul_f32 v[28:29], v[28:29], v[64:65] op_sel_hi:[1,0]
    v_pk_mul_f32 v[46:47], v[46:47], v[66:67] op_sel_hi:[1,0]
    v_pk_mul_f32 v[30:31], v[30:31], v[64:65] op_sel_hi:[1,0]
    v_pk_mul_f32 v[48:49], v[48:49], v[66:67] op_sel_hi:[1,0]
    v_pk_mul_f32 v[32:33], v[32:33], v[64:65] op_sel_hi:[1,0]
    v_pk_mul_f32 v[50:51], v[50:51], v[66:67] op_sel_hi:[1,0]
    v_pk_mul_f32 v[34:35], v[34:35], v[64:65] op_sel_hi:[1,0]
    v_pk_mul_f32 v[52:53], v[52:53], v[66:67] op_sel_hi:[1,0]
    v_pk_mul_f32 v[36:37], v[36:37], v[64:65] op_sel_hi:[1,0]
    v_pk_mul_f32 v[54:55], v[54:55], v[66:67] op_sel_hi:[1,0]
    v_pk_mul_f32 v[38:39], v[38:39], v[64:65] op_sel_hi:[1,0]
    v_pk_mul_f32 v[56:57], v[56:57], v[66:67] op_sel_hi:[1,0]
    v_pk_mul_f32 v[40:41], v[40:41], v[64:65] op_sel_hi:[1,0]
    v_pk_mul_f32 v[58:59], v[58:59], v[66:67] op_sel_hi:[1,0]
    s_waitcnt lgkmcnt(0)
    v_cvt_pk_bf16_f32 v76, v24, v25
    v_cvt_pk_bf16_f32 v77, v26, v27
    v_cvt_pk_bf16_f32 v78, v28, v29
    v_cvt_pk_bf16_f32 v79, v30, v31
    v_cvt_pk_bf16_f32 v80, v32, v33
    v_cvt_pk_bf16_f32 v81, v34, v35
    v_cvt_pk_bf16_f32 v82, v36, v37
    v_cvt_pk_bf16_f32 v83, v38, v39
    v_cvt_pk_bf16_f32 v84, v40, v41
    v_cvt_pk_bf16_f32 v85, v42, v43
    v_cvt_pk_bf16_f32 v86, v44, v45
    v_cvt_pk_bf16_f32 v87, v46, v47
    v_cvt_pk_bf16_f32 v88, v48, v49
    v_cvt_pk_bf16_f32 v89, v50, v51
    v_cvt_pk_bf16_f32 v90, v52, v53
    v_cvt_pk_bf16_f32 v91, v54, v55
    v_cvt_pk_bf16_f32 v92, v56, v57
    v_cvt_pk_bf16_f32 v93, v58, v59
    v_cndmask_b32 v184, v184, v70, s[58:59]
    v_cndmask_b32 v185, v185, v71, s[58:59]
    v_cndmask_b32 v250, v70, v250, s[58:59]
    v_cndmask_b32 v251, v71, v251, s[58:59]
    v_cvt_pk_bf16_f32 v184, v184, v185
    v_cvt_pk_bf16_f32 v185, v186, v187
    v_cvt_pk_bf16_f32 v200, v200, v201
    v_cvt_pk_bf16_f32 v201, v202, v203
    v_cvt_pk_bf16_f32 v216, v216, v217
    v_cvt_pk_bf16_f32 v217, v218, v219
    v_cvt_pk_bf16_f32 v232, v232, v233
    v_cvt_pk_bf16_f32 v233, v234, v235
    v_cvt_pk_bf16_f32 v248, v248, v249
    v_cvt_pk_bf16_f32 v249, v250, v251
    v_max3_f32 v60, v108, v109, v110
    v_min3_f32 v62, v108, v109, v110
    v_max3_f32 v60, v60, v111, v124
    v_min3_f32 v62, v62, v111, v124
    v_max3_f32 v60, v60, v125, v126
    v_min3_f32 v62, v62, v125, v126
    v_max3_f32 v60, v60, v127, v140
    v_min3_f32 v62, v62, v127, v140
    v_max3_f32 v60, v60, v141, v142
    v_min3_f32 v62, v62, v141, v142
    ds_write_b128 v74, v[76:79] offset:10752
    v_max3_f32 v60, v60, v143, v156
    v_min3_f32 v62, v62, v143, v156
    v_max3_f32 v60, v60, v157, v158
    v_min3_f32 v62, v62, v157, v158
    v_max3_f32 v60, v60, v159, v172
    v_min3_f32 v62, v62, v159, v172
    v_max_f32 v60, v60, v173
    v_min_f32 v62, v62, v173
    v_mul_f32_e64 v60, -s31, v60
    v_mul_f32 v62, s31, v62
    ds_write_b128 v74, v[80:83] offset:10768
    v_pk_fma_f32 v[24:25], v[108:109], v[94:95], v[60:61] op_sel_hi:[1,0,0]
    v_pk_fma_f32 v[42:43], v[108:109], v[94:95], v[62:63] op_sel_hi:[1,0,0] neg_lo:[0,1,0] neg_hi:[0,1,0]
    v_pk_fma_f32 v[26:27], v[110:111], v[94:95], v[60:61] op_sel_hi:[1,0,0]
    v_pk_fma_f32 v[44:45], v[110:111], v[94:95], v[62:63] op_sel_hi:[1,0,0] neg_lo:[0,1,0] neg_hi:[0,1,0]
    v_pk_fma_f32 v[28:29], v[124:125], v[94:95], v[60:61] op_sel_hi:[1,0,0]
    v_pk_fma_f32 v[46:47], v[124:125], v[94:95], v[62:63] op_sel_hi:[1,0,0] neg_lo:[0,1,0] neg_hi:[0,1,0]
    v_pk_fma_f32 v[30:31], v[126:127], v[94:95], v[60:61] op_sel_hi:[1,0,0]
    v_pk_fma_f32 v[48:49], v[126:127], v[94:95], v[62:63] op_sel_hi:[1,0,0] neg_lo:[0,1,0] neg_hi:[0,1,0]
    v_pk_fma_f32 v[32:33], v[140:141], v[94:95], v[60:61] op_sel_hi:[1,0,0]
    v_pk_fma_f32 v[50:51], v[140:141], v[94:95], v[62:63] op_sel_hi:[1,0,0] neg_lo:[0,1,0] neg_hi:[0,1,0]
    ds_write_b128 v74, v[84:87] offset:10784
    v_pk_fma_f32 v[34:35], v[142:143], v[94:95], v[60:61] op_sel_hi:[1,0,0]
    v_pk_fma_f32 v[52:53], v[142:143], v[94:95], v[62:63] op_sel_hi:[1,0,0] neg_lo:[0,1,0] neg_hi:[0,1,0]
    v_pk_fma_f32 v[36:37], v[156:157], v[94:95], v[60:61] op_sel_hi:[1,0,0]
    v_pk_fma_f32 v[54:55], v[156:157], v[94:95], v[62:63] op_sel_hi:[1,0,0] neg_lo:[0,1,0] neg_hi:[0,1,0]
    v_pk_fma_f32 v[38:39], v[158:159], v[94:95], v[60:61] op_sel_hi:[1,0,0]
    v_pk_fma_f32 v[56:57], v[158:159], v[94:95], v[62:63] op_sel_hi:[1,0,0] neg_lo:[0,1,0] neg_hi:[0,1,0]
    v_pk_fma_f32 v[40:41], v[172:173], v[94:95], v[60:61] op_sel_hi:[1,0,0]
    v_pk_fma_f32 v[58:59], v[172:173], v[94:95], v[62:63] op_sel_hi:[1,0,0] neg_lo:[0,1,0] neg_hi:[0,1,0]
    v_exp_f32 v24, v24
    v_exp_f32 v42, v42
    ds_write_b128 v74, v[88:91] offset:10800
    v_exp_f32 v25, v25
    v_exp_f32 v43, v43
    v_exp_f32 v26, v26
    v_exp_f32 v44, v44
    v_exp_f32 v27, v27
    v_exp_f32 v45, v45
    v_exp_f32 v28, v28
    v_exp_f32 v46, v46
    v_exp_f32 v29, v29
    v_exp_f32 v47, v47
    ds_write_b64 v74, v[92:93] offset:10816
    v_exp_f32 v30, v30
    v_exp_f32 v48, v48
    v_exp_f32 v31, v31
    v_exp_f32 v49, v49
    v_exp_f32 v32, v32
    v_exp_f32 v50, v50
    v_exp_f32 v33, v33
    v_exp_f32 v51, v51
    v_exp_f32 v34, v34
    v_exp_f32 v52, v52
    ds_write_b64 v75, v[184:185] offset:5376
    v_exp_f32 v35, v35
    v_exp_f32 v53, v53
    v_exp_f32 v36, v36
    v_exp_f32 v54, v54
    v_exp_f32 v37, v37
    v_exp_f32 v55, v55
    v_exp_f32 v38, v38
    v_exp_f32 v56, v56
    v_exp_f32 v39, v39
    v_exp_f32 v57, v57
    ds_write_b64 v75, v[200:201] offset:5384
    v_exp_f32 v40, v40
    v_exp_f32 v58, v58
    v_exp_f32 v41, v41
    v_exp_f32 v59, v59
    v_pk_add_f32 v[64:65], v[24:25], v[26:27]
    s_nop 0
    v_pk_add_f32 v[66:67], v[42:43], v[44:45]
    v_pk_add_f32 v[64:65], v[64:65], v[28:29]
    v_pk_add_f32 v[66:67], v[66:67], v[46:47]
    v_pk_add_f32 v[64:65], v[64:65], v[30:31]
    ds_write_b64 v75, v[216:217] offset:5392
    v_pk_add_f32 v[66:67], v[66:67], v[48:49]
    v_pk_add_f32 v[64:65], v[64:65], v[32:33]
    v_pk_add_f32 v[66:67], v[66:67], v[50:51]
    v_pk_add_f32 v[64:65], v[64:65], v[34:35]
    v_pk_add_f32 v[66:67], v[66:67], v[52:53]
    v_pk_add_f32 v[64:65], v[64:65], v[36:37]
    v_pk_add_f32 v[66:67], v[66:67], v[54:55]
    v_pk_add_f32 v[64:65], v[64:65], v[38:39]
    v_pk_add_f32 v[66:67], v[66:67], v[56:57]
    v_pk_add_f32 v[64:65], v[64:65], v[40:41]
    ds_write_b64 v75, v[232:233] offset:5400
    v_pk_add_f32 v[66:67], v[66:67], v[58:59]
    v_add_f32 v64, v64, v65
    v_add_f32 v66, v66, v67
    v_rcp_f32 v64, v64
    v_rcp_f32 v66, v66
    s_nop 0
    v_pk_mul_f32 v[24:25], v[24:25], v[64:65] op_sel_hi:[1,0]
    v_pk_mul_f32 v[42:43], v[42:43], v[66:67] op_sel_hi:[1,0]
    v_pk_mul_f32 v[26:27], v[26:27], v[64:65] op_sel_hi:[1,0]
    v_pk_mul_f32 v[44:45], v[44:45], v[66:67] op_sel_hi:[1,0]
    ds_write_b64 v75, v[248:249] offset:5408
    v_pk_mul_f32 v[28:29], v[28:29], v[64:65] op_sel_hi:[1,0]
    v_pk_mul_f32 v[46:47], v[46:47], v[66:67] op_sel_hi:[1,0]
    v_pk_mul_f32 v[30:31], v[30:31], v[64:65] op_sel_hi:[1,0]
    v_pk_mul_f32 v[48:49], v[48:49], v[66:67] op_sel_hi:[1,0]
    v_pk_mul_f32 v[32:33], v[32:33], v[64:65] op_sel_hi:[1,0]
    v_pk_mul_f32 v[50:51], v[50:51], v[66:67] op_sel_hi:[1,0]
    v_pk_mul_f32 v[34:35], v[34:35], v[64:65] op_sel_hi:[1,0]
    v_pk_mul_f32 v[52:53], v[52:53], v[66:67] op_sel_hi:[1,0]
    v_pk_mul_f32 v[36:37], v[36:37], v[64:65] op_sel_hi:[1,0]
    v_pk_mul_f32 v[54:55], v[54:55], v[66:67] op_sel_hi:[1,0]
    v_pk_mul_f32 v[38:39], v[38:39], v[64:65] op_sel_hi:[1,0]
    v_pk_mul_f32 v[56:57], v[56:57], v[66:67] op_sel_hi:[1,0]
    v_pk_mul_f32 v[40:41], v[40:41], v[64:65] op_sel_hi:[1,0]
    v_pk_mul_f32 v[58:59], v[58:59], v[66:67] op_sel_hi:[1,0]
    s_waitcnt lgkmcnt(0)
    v_cvt_pk_bf16_f32 v104, v24, v25
    v_cvt_pk_bf16_f32 v105, v26, v27
    v_cvt_pk_bf16_f32 v106, v28, v29
    v_cvt_pk_bf16_f32 v107, v30, v31
    v_cvt_pk_bf16_f32 v120, v32, v33
    v_cvt_pk_bf16_f32 v121, v34, v35
    v_cvt_pk_bf16_f32 v122, v36, v37
    v_cvt_pk_bf16_f32 v123, v38, v39
    v_cvt_pk_bf16_f32 v136, v40, v41
    v_cvt_pk_bf16_f32 v137, v42, v43
    v_cvt_pk_bf16_f32 v138, v44, v45
    v_cvt_pk_bf16_f32 v139, v46, v47
    v_cvt_pk_bf16_f32 v152, v48, v49
    v_cvt_pk_bf16_f32 v153, v50, v51
    v_cvt_pk_bf16_f32 v154, v52, v53
    v_cvt_pk_bf16_f32 v155, v54, v55
    v_cvt_pk_bf16_f32 v168, v56, v57
    v_cvt_pk_bf16_f32 v169, v58, v59
    v_cndmask_b32 v188, v188, v70, s[58:59]
    v_cndmask_b32 v189, v189, v71, s[58:59]
    v_cndmask_b32 v254, v70, v254, s[58:59]
    v_cndmask_b32 v255, v71, v255, s[58:59]
    v_cvt_pk_bf16_f32 v188, v188, v189
    v_cvt_pk_bf16_f32 v189, v190, v191
    v_cvt_pk_bf16_f32 v204, v204, v205
    v_cvt_pk_bf16_f32 v205, v206, v207
    v_cvt_pk_bf16_f32 v220, v220, v221
    v_cvt_pk_bf16_f32 v221, v222, v223
    v_cvt_pk_bf16_f32 v236, v236, v237
    v_cvt_pk_bf16_f32 v237, v238, v239
    v_cvt_pk_bf16_f32 v252, v252, v253
    v_cvt_pk_bf16_f32 v253, v254, v255
    ds_write_b128 v74, v[104:107] offset:16128
    ds_write_b128 v74, v[120:123] offset:16144
    ds_write_b128 v74, v[136:139] offset:16160
    ds_write_b128 v74, v[152:155] offset:16176
    ds_write_b64 v74, v[168:169] offset:16192
    ds_write_b64 v75, v[188:189] offset:8064
    ds_write_b64 v75, v[204:205] offset:8072
    ds_write_b64 v75, v[220:221] offset:8080
    ds_write_b64 v75, v[236:237] offset:8088
    ds_write_b64 v75, v[252:253] offset:8096
    s_waitcnt lgkmcnt(0)
    s_barrier
    v_and_b32 v24, 15, v20
    v_lshrrev_b32 v25, 4, v20
    v_lshrrev_b32 v26, 2, v24
    v_and_b32 v27, 3, v24
    v_lshlrev_b32 v28, 3, v25
    v_add_u32 v28, v28, v26
    v_mul_u32_u24 v29, 168, v28
    v_lshlrev_b32 v30, 3, v27
    v_add_u32 v29, v29, v30
    s_mul_i32 s38, s24, 40
    s_add_u32 s38, s38, 86016
    v_add_u32 v29, s38, v29
    v_mul_u32_u24 v31, 336, v28
    v_add_u32 v31, v31, v30
    s_mul_i32 s38, s24, 80
    v_add_u32 v31, s38, v31
    v_add_u32 v32, 43008, v31
    ds_read_b64_tr_b16 v[36:37], v29 offset:0
    ds_read_b64_tr_b16 v[38:39], v29 offset:672
    ds_read_b64_tr_b16 v[40:41], v29 offset:32
    ds_read_b64_tr_b16 v[42:43], v29 offset:704
    ds_read_b64_tr_b16 v[44:45], v31 offset:0
    ds_read_b64_tr_b16 v[46:47], v31 offset:1344
    ds_read_b64_tr_b16 v[48:49], v31 offset:32
    ds_read_b64_tr_b16 v[50:51], v31 offset:1376
    ds_read_b64_tr_b16 v[52:53], v31 offset:64
    ds_read_b64_tr_b16 v[54:55], v31 offset:1408
    s_waitcnt lgkmcnt(0)
    ds_read_b64_tr_b16 v[56:57], v29 offset:5376
    ds_read_b64_tr_b16 v[58:59], v29 offset:6048
    ds_read_b64_tr_b16 v[60:61], v29 offset:5408
    ds_read_b64_tr_b16 v[62:63], v29 offset:6080
    ds_read_b64_tr_b16 v[64:65], v31 offset:10752
    v_mfma_f32_16x16x32_bf16 v[96:99], v[36:39], v[44:47], 0
    v_mfma_f32_16x16x32_bf16 v[100:103], v[36:39], v[48:51], 0
    ds_read_b64_tr_b16 v[66:67], v31 offset:12096
    ds_read_b64_tr_b16 v[68:69], v31 offset:10784
    ds_read_b64_tr_b16 v[70:71], v31 offset:12128
    ds_read_b64_tr_b16 v[72:73], v31 offset:10816
    ds_read_b64_tr_b16 v[74:75], v31 offset:12160
    v_mfma_f32_16x16x32_bf16 v[104:107], v[36:39], v[52:55], 0
    v_mfma_f32_16x16x32_bf16 v[108:111], v[40:43], v[44:47], 0
    v_mfma_f32_16x16x32_bf16 v[112:115], v[40:43], v[48:51], 0
    v_mfma_f32_16x16x32_bf16 v[116:119], v[40:43], v[52:55], 0
    s_waitcnt lgkmcnt(0)
    ds_read_b64_tr_b16 v[36:37], v29 offset:10752
    ds_read_b64_tr_b16 v[38:39], v29 offset:11424
    ds_read_b64_tr_b16 v[40:41], v29 offset:10784
    ds_read_b64_tr_b16 v[42:43], v29 offset:11456
    ds_read_b64_tr_b16 v[44:45], v31 offset:21504
    v_mfma_f32_16x16x32_bf16 v[96:99], v[56:59], v[64:67], v[96:99]
    v_mfma_f32_16x16x32_bf16 v[100:103], v[56:59], v[68:71], v[100:103]
    ds_read_b64_tr_b16 v[46:47], v31 offset:22848
    ds_read_b64_tr_b16 v[48:49], v31 offset:21536
    ds_read_b64_tr_b16 v[50:51], v31 offset:22880
    ds_read_b64_tr_b16 v[52:53], v31 offset:21568
    ds_read_b64_tr_b16 v[54:55], v31 offset:22912
    v_mfma_f32_16x16x32_bf16 v[104:107], v[56:59], v[72:75], v[104:107]
    v_mfma_f32_16x16x32_bf16 v[108:111], v[60:63], v[64:67], v[108:111]
    v_mfma_f32_16x16x32_bf16 v[112:115], v[60:63], v[68:71], v[112:115]
    v_mfma_f32_16x16x32_bf16 v[116:119], v[60:63], v[72:75], v[116:119]
    s_waitcnt lgkmcnt(0)
    ds_read_b64_tr_b16 v[56:57], v29 offset:16128
    ds_read_b64_tr_b16 v[58:59], v29 offset:16800
    ds_read_b64_tr_b16 v[60:61], v29 offset:16160
    ds_read_b64_tr_b16 v[62:63], v29 offset:16832
    ds_read_b64_tr_b16 v[64:65], v31 offset:32256
    v_mfma_f32_16x16x32_bf16 v[96:99], v[36:39], v[44:47], v[96:99]
    v_mfma_f32_16x16x32_bf16 v[100:103], v[36:39], v[48:51], v[100:103]
    ds_read_b64_tr_b16 v[66:67], v31 offset:33600
    ds_read_b64_tr_b16 v[68:69], v31 offset:32288
    ds_read_b64_tr_b16 v[70:71], v31 offset:33632
    ds_read_b64_tr_b16 v[72:73], v31 offset:32320
    ds_read_b64_tr_b16 v[74:75], v31 offset:33664
    v_mfma_f32_16x16x32_bf16 v[104:107], v[36:39], v[52:55], v[104:107]
    v_mfma_f32_16x16x32_bf16 v[108:111], v[40:43], v[44:47], v[108:111]
    v_mfma_f32_16x16x32_bf16 v[112:115], v[40:43], v[48:51], v[112:115]
    v_mfma_f32_16x16x32_bf16 v[116:119], v[40:43], v[52:55], v[116:119]
    s_waitcnt lgkmcnt(0)
    ds_read_b64_tr_b16 v[36:37], v29 offset:21504
    ds_read_b64_tr_b16 v[38:39], v29 offset:22176
    ds_read_b64_tr_b16 v[40:41], v29 offset:21536
    ds_read_b64_tr_b16 v[42:43], v29 offset:22208
    ds_read_b64_tr_b16 v[44:45], v32 offset:0
    v_mfma_f32_16x16x32_bf16 v[96:99], v[56:59], v[64:67], v[96:99]
    v_mfma_f32_16x16x32_bf16 v[100:103], v[56:59], v[68:71], v[100:103]
    ds_read_b64_tr_b16 v[46:47], v32 offset:1344
    ds_read_b64_tr_b16 v[48:49], v32 offset:32
    ds_read_b64_tr_b16 v[50:51], v32 offset:1376
    ds_read_b64_tr_b16 v[52:53], v32 offset:64
    ds_read_b64_tr_b16 v[54:55], v32 offset:1408
    v_mfma_f32_16x16x32_bf16 v[104:107], v[56:59], v[72:75], v[104:107]
    v_mfma_f32_16x16x32_bf16 v[108:111], v[60:63], v[64:67], v[108:111]
    v_mfma_f32_16x16x32_bf16 v[112:115], v[60:63], v[68:71], v[112:115]
    v_mfma_f32_16x16x32_bf16 v[116:119], v[60:63], v[72:75], v[116:119]
    s_waitcnt lgkmcnt(0)
    ds_read_b64_tr_b16 v[56:57], v29 offset:26880
    ds_read_b64_tr_b16 v[58:59], v29 offset:27552
    ds_read_b64_tr_b16 v[60:61], v29 offset:26912
    ds_read_b64_tr_b16 v[62:63], v29 offset:27584
    ds_read_b64_tr_b16 v[64:65], v32 offset:10752
    v_mfma_f32_16x16x32_bf16 v[96:99], v[36:39], v[44:47], v[96:99]
    v_mfma_f32_16x16x32_bf16 v[100:103], v[36:39], v[48:51], v[100:103]
    ds_read_b64_tr_b16 v[66:67], v32 offset:12096
    ds_read_b64_tr_b16 v[68:69], v32 offset:10784
    ds_read_b64_tr_b16 v[70:71], v32 offset:12128
    ds_read_b64_tr_b16 v[72:73], v32 offset:10816
    ds_read_b64_tr_b16 v[74:75], v32 offset:12160
    v_mfma_f32_16x16x32_bf16 v[104:107], v[36:39], v[52:55], v[104:107]
    v_mfma_f32_16x16x32_bf16 v[108:111], v[40:43], v[44:47], v[108:111]
    v_mfma_f32_16x16x32_bf16 v[112:115], v[40:43], v[48:51], v[112:115]
    v_mfma_f32_16x16x32_bf16 v[116:119], v[40:43], v[52:55], v[116:119]
    s_waitcnt lgkmcnt(0)
    ds_read_b64_tr_b16 v[36:37], v29 offset:32256
    ds_read_b64_tr_b16 v[38:39], v29 offset:32928
    ds_read_b64_tr_b16 v[40:41], v29 offset:32288
    ds_read_b64_tr_b16 v[42:43], v29 offset:32960
    ds_read_b64_tr_b16 v[44:45], v32 offset:21504
    v_mfma_f32_16x16x32_bf16 v[96:99], v[56:59], v[64:67], v[96:99]
    v_mfma_f32_16x16x32_bf16 v[100:103], v[56:59], v[68:71], v[100:103]
    ds_read_b64_tr_b16 v[46:47], v32 offset:22848
    ds_read_b64_tr_b16 v[48:49], v32 offset:21536
    ds_read_b64_tr_b16 v[50:51], v32 offset:22880
    ds_read_b64_tr_b16 v[52:53], v32 offset:21568
    ds_read_b64_tr_b16 v[54:55], v32 offset:22912
    v_mfma_f32_16x16x32_bf16 v[104:107], v[56:59], v[72:75], v[104:107]
    v_mfma_f32_16x16x32_bf16 v[108:111], v[60:63], v[64:67], v[108:111]
    v_mfma_f32_16x16x32_bf16 v[112:115], v[60:63], v[68:71], v[112:115]
    v_mfma_f32_16x16x32_bf16 v[116:119], v[60:63], v[72:75], v[116:119]
    s_waitcnt lgkmcnt(0)
    ds_read_b64_tr_b16 v[56:57], v29 offset:37632
    ds_read_b64_tr_b16 v[58:59], v29 offset:38304
    ds_read_b64_tr_b16 v[60:61], v29 offset:37664
    ds_read_b64_tr_b16 v[62:63], v29 offset:38336
    ds_read_b64_tr_b16 v[64:65], v32 offset:32256
    v_mfma_f32_16x16x32_bf16 v[96:99], v[36:39], v[44:47], v[96:99]
    v_mfma_f32_16x16x32_bf16 v[100:103], v[36:39], v[48:51], v[100:103]
    ds_read_b64_tr_b16 v[66:67], v32 offset:33600
    ds_read_b64_tr_b16 v[68:69], v32 offset:32288
    ds_read_b64_tr_b16 v[70:71], v32 offset:33632
    ds_read_b64_tr_b16 v[72:73], v32 offset:32320
    ds_read_b64_tr_b16 v[74:75], v32 offset:33664
    v_mfma_f32_16x16x32_bf16 v[104:107], v[36:39], v[52:55], v[104:107]
    v_mfma_f32_16x16x32_bf16 v[108:111], v[40:43], v[44:47], v[108:111]
    v_mfma_f32_16x16x32_bf16 v[112:115], v[40:43], v[48:51], v[112:115]
    v_mfma_f32_16x16x32_bf16 v[116:119], v[40:43], v[52:55], v[116:119]
    s_waitcnt lgkmcnt(0)
    v_mfma_f32_16x16x32_bf16 v[96:99], v[56:59], v[64:67], v[96:99]
    v_mfma_f32_16x16x32_bf16 v[100:103], v[56:59], v[68:71], v[100:103]
    v_mfma_f32_16x16x32_bf16 v[104:107], v[56:59], v[72:75], v[104:107]
    v_mfma_f32_16x16x32_bf16 v[108:111], v[60:63], v[64:67], v[108:111]
    v_mfma_f32_16x16x32_bf16 v[112:115], v[60:63], v[68:71], v[112:115]
    v_mfma_f32_16x16x32_bf16 v[116:119], v[60:63], v[72:75], v[116:119]
    s_lshl_b32 s38, s32, 5
    s_lshl_b32 s39, s33, 2
    s_add_u32 s38, s38, s39
    s_add_u32 s38, s38, s24
    s_mul_i32 s38, s38, 2880
    v_mul_u32_u24 v33, 80, v24
    v_lshlrev_b32 v34, 4, v25
    v_add_u32 v33, v33, v34
    v_cmp_eq_u32 s[50:51], 0, v25
    v_cmp_gt_u32 s[52:53], 4, v24
    s_nop 1
    s_and_b64 s[54:55], s[50:51], s[52:53]
    buffer_store_dwordx4 v[96:99], v33, s[20:23], s38 offen offset:0 sc1
    s_mov_b64 exec, s[50:51]
    buffer_store_dwordx4 v[108:111], v33, s[20:23], s38 offen offset:64 sc1
    s_mov_b64 exec, -1
    buffer_store_dwordx4 v[100:103], v33, s[20:23], s38 offen offset:1280 sc1
    s_mov_b64 exec, s[50:51]
    buffer_store_dwordx4 v[112:115], v33, s[20:23], s38 offen offset:1344 sc1
    s_mov_b64 exec, -1
    s_mov_b64 exec, s[52:53]
    buffer_store_dwordx4 v[104:107], v33, s[20:23], s38 offen offset:2560 sc1
    s_mov_b64 exec, -1
    s_mov_b64 exec, s[54:55]
    buffer_store_dwordx4 v[116:119], v33, s[20:23], s38 offen offset:2624 sc1
    s_mov_b64 exec, -1
    v_mov_b32 v93, 0
    global_load_dword v95, v93, s[68:69] sc1
    v_accvgpr_read_b32 v120, a24
    v_accvgpr_read_b32 v121, a25
    v_accvgpr_read_b32 v122, a26
    v_accvgpr_read_b32 v123, a27
    v_accvgpr_read_b32 v124, a28
    v_accvgpr_read_b32 v125, a29
    v_accvgpr_read_b32 v126, a30
    v_accvgpr_read_b32 v127, a31
    v_accvgpr_read_b32 v128, a32
    v_accvgpr_read_b32 v129, a33
    v_accvgpr_read_b32 v130, a34
    v_accvgpr_read_b32 v131, a35
    v_accvgpr_read_b32 v132, a36
    v_accvgpr_read_b32 v133, a37
    v_accvgpr_read_b32 v134, a38
    v_accvgpr_read_b32 v135, a39
    v_accvgpr_read_b32 v136, a40
    v_accvgpr_read_b32 v137, a41
    v_accvgpr_read_b32 v138, a42
    v_accvgpr_read_b32 v139, a43
    v_accvgpr_read_b32 v140, a44
    v_accvgpr_read_b32 v141, a45
    v_accvgpr_read_b32 v142, a46
    v_accvgpr_read_b32 v143, a47
    v_accvgpr_read_b32 v144, a48
    v_accvgpr_read_b32 v145, a49
    v_accvgpr_read_b32 v146, a50
    v_accvgpr_read_b32 v147, a51
    v_accvgpr_read_b32 v148, a52
    v_accvgpr_read_b32 v149, a53
    v_accvgpr_read_b32 v150, a54
    v_accvgpr_read_b32 v151, a55
    v_accvgpr_read_b32 v152, a56
    v_accvgpr_read_b32 v153, a57
    v_accvgpr_read_b32 v154, a58
    v_accvgpr_read_b32 v155, a59
    v_accvgpr_read_b32 v156, a60
    v_accvgpr_read_b32 v157, a61
    v_accvgpr_read_b32 v158, a62
    v_accvgpr_read_b32 v159, a63
    v_accvgpr_read_b32 v160, a64
    v_accvgpr_read_b32 v161, a65
    v_accvgpr_read_b32 v162, a66
    v_accvgpr_read_b32 v163, a67
    v_accvgpr_read_b32 v164, a68
    v_accvgpr_read_b32 v165, a69
    v_accvgpr_read_b32 v166, a70
    v_accvgpr_read_b32 v167, a71
    v_accvgpr_read_b32 v168, a72
    v_accvgpr_read_b32 v169, a73
    v_accvgpr_read_b32 v170, a74
    v_accvgpr_read_b32 v171, a75
    v_accvgpr_read_b32 v172, a76
    v_accvgpr_read_b32 v173, a77
    v_accvgpr_read_b32 v174, a78
    v_accvgpr_read_b32 v175, a79
    v_accvgpr_read_b32 v96, a0
    v_accvgpr_read_b32 v97, a1
    v_accvgpr_read_b32 v98, a2
    v_accvgpr_read_b32 v99, a3
    v_accvgpr_read_b32 v100, a4
    v_accvgpr_read_b32 v101, a5
    v_accvgpr_read_b32 v102, a6
    v_accvgpr_read_b32 v103, a7
    v_accvgpr_read_b32 v104, a8
    v_accvgpr_read_b32 v105, a9
    v_accvgpr_read_b32 v106, a10
    v_accvgpr_read_b32 v107, a11
    v_accvgpr_read_b32 v108, a12
    v_accvgpr_read_b32 v109, a13
    v_accvgpr_read_b32 v110, a14
    v_accvgpr_read_b32 v111, a15
    v_accvgpr_read_b32 v112, a16
    v_accvgpr_read_b32 v113, a17
    v_accvgpr_read_b32 v114, a18
    v_accvgpr_read_b32 v115, a19
    v_accvgpr_read_b32 v116, a20
    v_accvgpr_read_b32 v117, a21
    v_accvgpr_read_b32 v118, a22
    v_accvgpr_read_b32 v119, a23
    v_cvt_pk_bf16_f32 v24, v96, v97
    v_cvt_pk_bf16_f32 v25, v98, v99
    v_cvt_pk_bf16_f32 v26, v112, v113
    v_cvt_pk_bf16_f32 v27, v114, v115
    v_cvt_pk_bf16_f32 v28, v128, v129
    v_cvt_pk_bf16_f32 v29, v130, v131
    v_cvt_pk_bf16_f32 v30, v144, v145
    v_cvt_pk_bf16_f32 v31, v146, v147
    v_cvt_pk_bf16_f32 v32, v160, v161
    v_cvt_pk_bf16_f32 v33, v162, v163
    v_mov_b32 v34, 0
    v_mov_b32 v35, 0
    v_cvt_pk_bf16_f32 v36, v100, v101
    v_cvt_pk_bf16_f32 v37, v102, v103
    v_cvt_pk_bf16_f32 v38, v116, v117
    v_cvt_pk_bf16_f32 v39, v118, v119
    v_cvt_pk_bf16_f32 v40, v132, v133
    v_cvt_pk_bf16_f32 v41, v134, v135
    v_cvt_pk_bf16_f32 v42, v148, v149
    v_cvt_pk_bf16_f32 v43, v150, v151
    v_cvt_pk_bf16_f32 v44, v164, v165
    v_cvt_pk_bf16_f32 v45, v166, v167
    v_mov_b32 v46, 0
    v_mov_b32 v47, 0
    v_cvt_pk_bf16_f32 v48, v104, v105
    v_cvt_pk_bf16_f32 v49, v106, v107
    v_cvt_pk_bf16_f32 v50, v120, v121
    v_cvt_pk_bf16_f32 v51, v122, v123
    v_cvt_pk_bf16_f32 v52, v136, v137
    v_cvt_pk_bf16_f32 v53, v138, v139
    v_cvt_pk_bf16_f32 v54, v152, v153
    v_cvt_pk_bf16_f32 v55, v154, v155
    v_cvt_pk_bf16_f32 v56, v168, v169
    v_cvt_pk_bf16_f32 v57, v170, v171
    v_mov_b32 v58, 0
    v_mov_b32 v59, 0
    v_cvt_pk_bf16_f32 v60, v108, v109
    v_cvt_pk_bf16_f32 v61, v110, v111
    v_cvt_pk_bf16_f32 v62, v124, v125
    v_cvt_pk_bf16_f32 v63, v126, v127
    v_cvt_pk_bf16_f32 v64, v140, v141
    v_cvt_pk_bf16_f32 v65, v142, v143
    v_cvt_pk_bf16_f32 v66, v156, v157
    v_cvt_pk_bf16_f32 v67, v158, v159
    v_cvt_pk_bf16_f32 v68, v172, v173
    v_cvt_pk_bf16_f32 v69, v174, v175
    v_mov_b32 v70, 0
    v_mov_b32 v71, 0
    s_nop 1
    v_mfma_f32_16x16x32_bf16 v[176:179], a[80:83], v[24:27], 0
    v_mfma_f32_16x16x32_bf16 v[192:195], a[92:95], v[24:27], 0
    v_mfma_f32_16x16x32_bf16 v[208:211], a[104:107], v[24:27], 0
    v_mfma_f32_16x16x32_bf16 v[224:227], a[116:119], v[24:27], 0
    v_mfma_f32_16x16x32_bf16 v[240:243], a[128:131], v[24:27], 0
    v_mfma_f32_16x16x32_bf16 v[176:179], a[84:87], v[28:31], v[176:179]
    v_mfma_f32_16x16x32_bf16 v[192:195], a[96:99], v[28:31], v[192:195]
    v_mfma_f32_16x16x32_bf16 v[208:211], a[108:111], v[28:31], v[208:211]
    v_mfma_f32_16x16x32_bf16 v[224:227], a[120:123], v[28:31], v[224:227]
    v_mfma_f32_16x16x32_bf16 v[240:243], a[132:135], v[28:31], v[240:243]
    v_mfma_f32_16x16x32_bf16 v[176:179], a[88:91], v[32:35], v[176:179]
    v_mfma_f32_16x16x32_bf16 v[192:195], a[100:103], v[32:35], v[192:195]
    v_mfma_f32_16x16x32_bf16 v[208:211], a[112:115], v[32:35], v[208:211]
    v_mfma_f32_16x16x32_bf16 v[224:227], a[124:127], v[32:35], v[224:227]
    v_mfma_f32_16x16x32_bf16 v[240:243], a[136:139], v[32:35], v[240:243]
    v_mfma_f32_16x16x32_bf16 v[180:183], a[80:83], v[36:39], 0
    v_mfma_f32_16x16x32_bf16 v[196:199], a[92:95], v[36:39], 0
    v_mfma_f32_16x16x32_bf16 v[212:215], a[104:107], v[36:39], 0
    v_mfma_f32_16x16x32_bf16 v[228:231], a[116:119], v[36:39], 0
    v_mfma_f32_16x16x32_bf16 v[244:247], a[128:131], v[36:39], 0
    v_mfma_f32_16x16x32_bf16 v[180:183], a[84:87], v[40:43], v[180:183]
    v_mfma_f32_16x16x32_bf16 v[196:199], a[96:99], v[40:43], v[196:199]
    v_mfma_f32_16x16x32_bf16 v[212:215], a[108:111], v[40:43], v[212:215]
    v_mfma_f32_16x16x32_bf16 v[228:231], a[120:123], v[40:43], v[228:231]
    v_mfma_f32_16x16x32_bf16 v[244:247], a[132:135], v[40:43], v[244:247]
    v_mfma_f32_16x16x32_bf16 v[180:183], a[88:91], v[44:47], v[180:183]
    v_mfma_f32_16x16x32_bf16 v[196:199], a[100:103], v[44:47], v[196:199]
    v_mfma_f32_16x16x32_bf16 v[212:215], a[112:115], v[44:47], v[212:215]
    v_mfma_f32_16x16x32_bf16 v[228:231], a[124:127], v[44:47], v[228:231]
    v_mfma_f32_16x16x32_bf16 v[244:247], a[136:139], v[44:47], v[244:247]
    v_mfma_f32_16x16x32_bf16 v[184:187], a[80:83], v[48:51], 0
    v_mfma_f32_16x16x32_bf16 v[200:203], a[92:95], v[48:51], 0
    v_mfma_f32_16x16x32_bf16 v[216:219], a[104:107], v[48:51], 0
    v_mfma_f32_16x16x32_bf16 v[232:235], a[116:119], v[48:51], 0
    v_mfma_f32_16x16x32_bf16 v[248:251], a[128:131], v[48:51], 0
    v_mfma_f32_16x16x32_bf16 v[184:187], a[84:87], v[52:55], v[184:187]
    v_mfma_f32_16x16x32_bf16 v[200:203], a[96:99], v[52:55], v[200:203]
    v_mfma_f32_16x16x32_bf16 v[216:219], a[108:111], v[52:55], v[216:219]
    v_mfma_f32_16x16x32_bf16 v[232:235], a[120:123], v[52:55], v[232:235]
    v_mfma_f32_16x16x32_bf16 v[248:251], a[132:135], v[52:55], v[248:251]
    v_mfma_f32_16x16x32_bf16 v[184:187], a[88:91], v[56:59], v[184:187]
    v_mfma_f32_16x16x32_bf16 v[200:203], a[100:103], v[56:59], v[200:203]
    v_mfma_f32_16x16x32_bf16 v[216:219], a[112:115], v[56:59], v[216:219]
    v_mfma_f32_16x16x32_bf16 v[232:235], a[124:127], v[56:59], v[232:235]
    v_mfma_f32_16x16x32_bf16 v[248:251], a[136:139], v[56:59], v[248:251]
    v_mfma_f32_16x16x32_bf16 v[188:191], a[80:83], v[60:63], 0
    v_mfma_f32_16x16x32_bf16 v[204:207], a[92:95], v[60:63], 0
    v_mfma_f32_16x16x32_bf16 v[220:223], a[104:107], v[60:63], 0
    v_mfma_f32_16x16x32_bf16 v[236:239], a[116:119], v[60:63], 0
    v_mfma_f32_16x16x32_bf16 v[252:255], a[128:131], v[60:63], 0
    v_mfma_f32_16x16x32_bf16 v[188:191], a[84:87], v[64:67], v[188:191]
    v_mfma_f32_16x16x32_bf16 v[204:207], a[96:99], v[64:67], v[204:207]
    v_mfma_f32_16x16x32_bf16 v[220:223], a[108:111], v[64:67], v[220:223]
    v_mfma_f32_16x16x32_bf16 v[236:239], a[120:123], v[64:67], v[236:239]
    v_mfma_f32_16x16x32_bf16 v[252:255], a[132:135], v[64:67], v[252:255]
    v_mfma_f32_16x16x32_bf16 v[188:191], a[88:91], v[68:71], v[188:191]
    v_mfma_f32_16x16x32_bf16 v[204:207], a[100:103], v[68:71], v[204:207]
    v_mfma_f32_16x16x32_bf16 v[220:223], a[112:115], v[68:71], v[220:223]
    v_mfma_f32_16x16x32_bf16 v[236:239], a[124:127], v[68:71], v[236:239]
    v_mfma_f32_16x16x32_bf16 v[252:255], a[136:139], v[68:71], v[252:255]
    s_nop 7
    s_waitcnt vmcnt(0)
    s_barrier
    s_add_u32 s66, s70, 22806528
    s_addc_u32 s67, s71, 0
    s_cmp_eq_u32 s24, 0
    s_cbranch_scc0 L_att_zr_ok
    v_readfirstlane_b32 s38, v95
    s_nop 1
    s_cmp_ge_u32 s38, 273
    s_cbranch_scc1 L_att_zr_ok
    v_mov_b32 v33, 0
    s_mov_b32 s39, 0
L_att_zr:
    global_load_dword v34, v33, s[68:69] sc1
    s_waitcnt vmcnt(0)
    v_readfirstlane_b32 s38, v34
    s_add_u32 s39, s39, 1
    s_cmp_ge_u32 s38, 273
    s_cbranch_scc1 L_att_zr_ok
    s_cmp_gt_u32 s39, 200000
    s_cbranch_scc1 L_att_zr_ok
    s_sleep 6
    s_branch L_att_zr
L_att_zr_ok:
    s_cmp_eq_u32 s24, 0
    s_cbranch_scc0 L_att_nosig
    s_lshl_b32 s38, s33, 7
    v_mov_b32 v33, s38
    v_mov_b32 v34, 1
    v_cmp_eq_u32 vcc, 0, v20
    s_and_saveexec_b64 s[48:49], vcc
    global_atomic_add v33, v34, s[66:67] sc1
    s_mov_b64 exec, s[48:49]
L_att_nosig:
    s_mov_b32 s40, s62
    s_mov_b32 s41, s63
    s_mov_b32 s42, 663552
    s_mov_b32 s43, 0x20000
    s_lshl_b32 s48, s32, 3
    s_add_u32 s48, s48, s33
    s_lshl_b32 s48, s48, 2
    s_add_u32 s48, s48, s24
    s_mul_i32 s48, s48, 3072
    buffer_load_dwordx4 a[0:3], v21, s[40:43], s48 offen offset:0
    buffer_load_dwordx4 a[4:7], v21, s[40:43], s48 offen offset:1024
    buffer_load_dwordx4 a[8:11], v21, s[40:43], s48 offen offset:2048
    v_max3_f32 v60, v176, v177, v178
    v_min3_f32 v62, v176, v177, v178
    v_max3_f32 v60, v60, v179, v192
    v_min3_f32 v62, v62, v179, v192
    v_max3_f32 v60, v60, v193, v194
    v_min3_f32 v62, v62, v193, v194
    v_max3_f32 v60, v60, v195, v208
    v_min3_f32 v62, v62, v195, v208
    v_max3_f32 v60, v60, v209, v210
    v_min3_f32 v62, v62, v209, v210
    v_max3_f32 v60, v60, v211, v224
    v_min3_f32 v62, v62, v211, v224
    v_max3_f32 v60, v60, v225, v226
    v_min3_f32 v62, v62, v225, v226
    v_max3_f32 v60, v60, v227, v240
    v_min3_f32 v62, v62, v227, v240
    v_max_f32 v60, v60, v241
    v_min_f32 v62, v62, v241
    v_mul_f32_e64 v60, -s31, v60
    v_mul_f32 v62, s31, v62
    v_pk_fma_f32 v[24:25], v[176:177], v[94:95], v[60:61] op_sel_hi:[1,0,0]
    v_pk_fma_f32 v[42:43], v[176:177], v[94:95], v[62:63] op_sel_hi:[1,0,0] neg_lo:[0,1,0] neg_hi:[0,1,0]
    v_pk_fma_f32 v[26:27], v[178:179], v[94:95], v[60:61] op_sel_hi:[1,0,0]
    v_pk_fma_f32 v[44:45], v[178:179], v[94:95], v[62:63] op_sel_hi:[1,0,0] neg_lo:[0,1,0] neg_hi:[0,1,0]
    v_pk_fma_f32 v[28:29], v[192:193], v[94:95], v[60:61] op_sel_hi:[1,0,0]
    v_pk_fma_f32 v[46:47], v[192:193], v[94:95], v[62:63] op_sel_hi:[1,0,0] neg_lo:[0,1,0] neg_hi:[0,1,0]
    v_pk_fma_f32 v[30:31], v[194:195], v[94:95], v[60:61] op_sel_hi:[1,0,0]
    v_pk_fma_f32 v[48:49], v[194:195], v[94:95], v[62:63] op_sel_hi:[1,0,0] neg_lo:[0,1,0] neg_hi:[0,1,0]
    v_pk_fma_f32 v[32:33], v[208:209], v[94:95], v[60:61] op_sel_hi:[1,0,0]
    v_pk_fma_f32 v[50:51], v[208:209], v[94:95], v[62:63] op_sel_hi:[1,0,0] neg_lo:[0,1,0] neg_hi:[0,1,0]
    v_pk_fma_f32 v[34:35], v[210:211], v[94:95], v[60:61] op_sel_hi:[1,0,0]
    v_pk_fma_f32 v[52:53], v[210:211], v[94:95], v[62:63] op_sel_hi:[1,0,0] neg_lo:[0,1,0] neg_hi:[0,1,0]
    v_pk_fma_f32 v[36:37], v[224:225], v[94:95], v[60:61] op_sel_hi:[1,0,0]
    v_pk_fma_f32 v[54:55], v[224:225], v[94:95], v[62:63] op_sel_hi:[1,0,0] neg_lo:[0,1,0] neg_hi:[0,1,0]
    v_pk_fma_f32 v[38:39], v[226:227], v[94:95], v[60:61] op_sel_hi:[1,0,0]
    v_pk_fma_f32 v[56:57], v[226:227], v[94:95], v[62:63] op_sel_hi:[1,0,0] neg_lo:[0,1,0] neg_hi:[0,1,0]
    v_pk_fma_f32 v[40:41], v[240:241], v[94:95], v[60:61] op_sel_hi:[1,0,0]
    v_pk_fma_f32 v[58:59], v[240:241], v[94:95], v[62:63] op_sel_hi:[1,0,0] neg_lo:[0,1,0] neg_hi:[0,1,0]
    v_exp_f32 v24, v24
    v_exp_f32 v42, v42
    v_exp_f32 v25, v25
    v_exp_f32 v43, v43
    v_exp_f32 v26, v26
    v_exp_f32 v44, v44
    v_exp_f32 v27, v27
    v_exp_f32 v45, v45
    v_exp_f32 v28, v28
    v_exp_f32 v46, v46
    v_exp_f32 v29, v29
    v_exp_f32 v47, v47
    v_exp_f32 v30, v30
    v_exp_f32 v48, v48
    v_exp_f32 v31, v31
    v_exp_f32 v49, v49
    v_exp_f32 v32, v32
    v_exp_f32 v50, v50
    v_exp_f32 v33, v33
    v_exp_f32 v51, v51
    v_exp_f32 v34, v34
    v_exp_f32 v52, v52
    v_exp_f32 v35, v35
    v_exp_f32 v53, v53
    v_exp_f32 v36, v36
    v_exp_f32 v54, v54
    v_exp_f32 v37, v37
    v_exp_f32 v55, v55
    v_exp_f32 v38, v38
    v_exp_f32 v56, v56
    v_exp_f32 v39, v39
    v_exp_f32 v57, v57
    v_exp_f32 v40, v40
    v_exp_f32 v58, v58
    v_exp_f32 v41, v41
    v_exp_f32 v59, v59
    s_nop 0
    v_cvt_pk_bf16_f32 v76, v24, v25
    v_cvt_pk_bf16_f32 v77, v26, v27
    v_cvt_pk_bf16_f32 v78, v28, v29
    v_cvt_pk_bf16_f32 v79, v30, v31
    v_cvt_pk_bf16_f32 v80, v32, v33
    v_cvt_pk_bf16_f32 v81, v34, v35
    v_cvt_pk_bf16_f32 v82, v36, v37
    v_cvt_pk_bf16_f32 v83, v38, v39
    v_cvt_pk_bf16_f32 v84, v40, v41
    v_accvgpr_write_b32 a140, v76
    v_accvgpr_write_b32 a141, v77
    v_accvgpr_write_b32 a142, v78
    v_accvgpr_write_b32 a143, v79
    v_accvgpr_write_b32 a144, v80
    v_accvgpr_write_b32 a145, v81
    v_accvgpr_write_b32 a146, v82
    v_accvgpr_write_b32 a147, v83
    v_accvgpr_write_b32 a148, v84
    v_accvgpr_write_b32 a149, 0
    v_accvgpr_write_b32 a150, 0
    v_accvgpr_write_b32 a151, 0
    v_cvt_pk_bf16_f32 v76, v42, v43
    v_cvt_pk_bf16_f32 v77, v44, v45
    v_cvt_pk_bf16_f32 v78, v46, v47
    v_cvt_pk_bf16_f32 v79, v48, v49
    v_cvt_pk_bf16_f32 v80, v50, v51
    v_cvt_pk_bf16_f32 v81, v52, v53
    v_cvt_pk_bf16_f32 v82, v54, v55
    v_cvt_pk_bf16_f32 v83, v56, v57
    v_cvt_pk_bf16_f32 v84, v58, v59
    v_accvgpr_write_b32 a152, v76
    v_accvgpr_write_b32 a153, v77
    v_accvgpr_write_b32 a154, v78
    v_accvgpr_write_b32 a155, v79
    v_accvgpr_write_b32 a156, v80
    v_accvgpr_write_b32 a157, v81
    v_accvgpr_write_b32 a158, v82
    v_accvgpr_write_b32 a159, v83
    v_accvgpr_write_b32 a160, v84
    v_accvgpr_write_b32 a161, 0
    v_accvgpr_write_b32 a162, 0
    v_accvgpr_write_b32 a163, 0
    v_max3_f32 v60, v180, v181, v182
    v_min3_f32 v62, v180, v181, v182
    v_max3_f32 v60, v60, v183, v196
    v_min3_f32 v62, v62, v183, v196
    v_max3_f32 v60, v60, v197, v198
    v_min3_f32 v62, v62, v197, v198
    v_max3_f32 v60, v60, v199, v212
    v_min3_f32 v62, v62, v199, v212
    v_max3_f32 v60, v60, v213, v214
    v_min3_f32 v62, v62, v213, v214
    v_max3_f32 v60, v60, v215, v228
    v_min3_f32 v62, v62, v215, v228
    v_max3_f32 v60, v60, v229, v230
    v_min3_f32 v62, v62, v229, v230
    v_max3_f32 v60, v60, v231, v244
    v_min3_f32 v62, v62, v231, v244
    v_max_f32 v60, v60, v245
    v_min_f32 v62, v62, v245
    v_mul_f32_e64 v60, -s31, v60
    v_mul_f32 v62, s31, v62
    v_pk_fma_f32 v[24:25], v[180:181], v[94:95], v[60:61] op_sel_hi:[1,0,0]
    v_pk_fma_f32 v[42:43], v[180:181], v[94:95], v[62:63] op_sel_hi:[1,0,0] neg_lo:[0,1,0] neg_hi:[0,1,0]
    v_pk_fma_f32 v[26:27], v[182:183], v[94:95], v[60:61] op_sel_hi:[1,0,0]
    v_pk_fma_f32 v[44:45], v[182:183], v[94:95], v[62:63] op_sel_hi:[1,0,0] neg_lo:[0,1,0] neg_hi:[0,1,0]
    v_pk_fma_f32 v[28:29], v[196:197], v[94:95], v[60:61] op_sel_hi:[1,0,0]
    v_pk_fma_f32 v[46:47], v[196:197], v[94:95], v[62:63] op_sel_hi:[1,0,0] neg_lo:[0,1,0] neg_hi:[0,1,0]
    v_pk_fma_f32 v[30:31], v[198:199], v[94:95], v[60:61] op_sel_hi:[1,0,0]
    v_pk_fma_f32 v[48:49], v[198:199], v[94:95], v[62:63] op_sel_hi:[1,0,0] neg_lo:[0,1,0] neg_hi:[0,1,0]
    v_pk_fma_f32 v[32:33], v[212:213], v[94:95], v[60:61] op_sel_hi:[1,0,0]
    v_pk_fma_f32 v[50:51], v[212:213], v[94:95], v[62:63] op_sel_hi:[1,0,0] neg_lo:[0,1,0] neg_hi:[0,1,0]
    v_pk_fma_f32 v[34:35], v[214:215], v[94:95], v[60:61] op_sel_hi:[1,0,0]
    v_pk_fma_f32 v[52:53], v[214:215], v[94:95], v[62:63] op_sel_hi:[1,0,0] neg_lo:[0,1,0] neg_hi:[0,1,0]
    v_pk_fma_f32 v[36:37], v[228:229], v[94:95], v[60:61] op_sel_hi:[1,0,0]
    v_pk_fma_f32 v[54:55], v[228:229], v[94:95], v[62:63] op_sel_hi:[1,0,0] neg_lo:[0,1,0] neg_hi:[0,1,0]
    v_pk_fma_f32 v[38:39], v[230:231], v[94:95], v[60:61] op_sel_hi:[1,0,0]
    v_pk_fma_f32 v[56:57], v[230:231], v[94:95], v[62:63] op_sel_hi:[1,0,0] neg_lo:[0,1,0] neg_hi:[0,1,0]
    v_pk_fma_f32 v[40:41], v[244:245], v[94:95], v[60:61] op_sel_hi:[1,0,0]
    v_pk_fma_f32 v[58:59], v[244:245], v[94:95], v[62:63] op_sel_hi:[1,0,0] neg_lo:[0,1,0] neg_hi:[0,1,0]
    v_exp_f32 v24, v24
    v_exp_f32 v42, v42
    v_exp_f32 v25, v25
    v_exp_f32 v43, v43
    v_exp_f32 v26, v26
    v_exp_f32 v44, v44
    v_exp_f32 v27, v27
    v_exp_f32 v45, v45
    v_exp_f32 v28, v28
    v_exp_f32 v46, v46
    v_exp_f32 v29, v29
    v_exp_f32 v47, v47
    v_exp_f32 v30, v30
    v_exp_f32 v48, v48
    v_exp_f32 v31, v31
    v_exp_f32 v49, v49
    v_exp_f32 v32, v32
    v_exp_f32 v50, v50
    v_exp_f32 v33, v33
    v_exp_f32 v51, v51
    v_exp_f32 v34, v34
    v_exp_f32 v52, v52
    v_exp_f32 v35, v35
    v_exp_f32 v53, v53
    v_exp_f32 v36, v36
    v_exp_f32 v54, v54
    v_exp_f32 v37, v37
    v_exp_f32 v55, v55
    v_exp_f32 v38, v38
    v_exp_f32 v56, v56
    v_exp_f32 v39, v39
    v_exp_f32 v57, v57
    v_exp_f32 v40, v40
    v_exp_f32 v58, v58
    v_exp_f32 v41, v41
    v_exp_f32 v59, v59
    s_nop 0
    v_cvt_pk_bf16_f32 v76, v24, v25
    v_cvt_pk_bf16_f32 v77, v26, v27
    v_cvt_pk_bf16_f32 v78, v28, v29
    v_cvt_pk_bf16_f32 v79, v30, v31
    v_cvt_pk_bf16_f32 v80, v32, v33
    v_cvt_pk_bf16_f32 v81, v34, v35
    v_cvt_pk_bf16_f32 v82, v36, v37
    v_cvt_pk_bf16_f32 v83, v38, v39
    v_cvt_pk_bf16_f32 v84, v40, v41
    v_accvgpr_write_b32 a164, v76
    v_accvgpr_write_b32 a165, v77
    v_accvgpr_write_b32 a166, v78
    v_accvgpr_write_b32 a167, v79
    v_accvgpr_write_b32 a168, v80
    v_accvgpr_write_b32 a169, v81
    v_accvgpr_write_b32 a170, v82
    v_accvgpr_write_b32 a171, v83
    v_accvgpr_write_b32 a172, v84
    v_accvgpr_write_b32 a173, 0
    v_accvgpr_write_b32 a174, 0
    v_accvgpr_write_b32 a175, 0
    v_cvt_pk_bf16_f32 v76, v42, v43
    v_cvt_pk_bf16_f32 v77, v44, v45
    v_cvt_pk_bf16_f32 v78, v46, v47
    v_cvt_pk_bf16_f32 v79, v48, v49
    v_cvt_pk_bf16_f32 v80, v50, v51
    v_cvt_pk_bf16_f32 v81, v52, v53
    v_cvt_pk_bf16_f32 v82, v54, v55
    v_cvt_pk_bf16_f32 v83, v56, v57
    v_cvt_pk_bf16_f32 v84, v58, v59
    v_accvgpr_write_b32 a176, v76
    v_accvgpr_write_b32 a177, v77
    v_accvgpr_write_b32 a178, v78
    v_accvgpr_write_b32 a179, v79
    v_accvgpr_write_b32 a180, v80
    v_accvgpr_write_b32 a181, v81
    v_accvgpr_write_b32 a182, v82
    v_accvgpr_write_b32 a183, v83
    v_accvgpr_write_b32 a184, v84
    v_accvgpr_write_b32 a185, 0
    v_accvgpr_write_b32 a186, 0
    v_accvgpr_write_b32 a187, 0
    v_max3_f32 v60, v184, v185, v186
    v_min3_f32 v62, v184, v185, v186
    v_max3_f32 v60, v60, v187, v200
    v_min3_f32 v62, v62, v187, v200
    v_max3_f32 v60, v60, v201, v202
    v_min3_f32 v62, v62, v201, v202
    v_max3_f32 v60, v60, v203, v216
    v_min3_f32 v62, v62, v203, v216
    v_max3_f32 v60, v60, v217, v218
    v_min3_f32 v62, v62, v217, v218
    v_max3_f32 v60, v60, v219, v232
    v_min3_f32 v62, v62, v219, v232
    v_max3_f32 v60, v60, v233, v234
    v_min3_f32 v62, v62, v233, v234
    v_max3_f32 v60, v60, v235, v248
    v_min3_f32 v62, v62, v235, v248
    v_max_f32 v60, v60, v249
    v_min_f32 v62, v62, v249
    v_mul_f32_e64 v60, -s31, v60
    v_mul_f32 v62, s31, v62
    v_pk_fma_f32 v[24:25], v[184:185], v[94:95], v[60:61] op_sel_hi:[1,0,0]
    v_pk_fma_f32 v[42:43], v[184:185], v[94:95], v[62:63] op_sel_hi:[1,0,0] neg_lo:[0,1,0] neg_hi:[0,1,0]
    v_pk_fma_f32 v[26:27], v[186:187], v[94:95], v[60:61] op_sel_hi:[1,0,0]
    v_pk_fma_f32 v[44:45], v[186:187], v[94:95], v[62:63] op_sel_hi:[1,0,0] neg_lo:[0,1,0] neg_hi:[0,1,0]
    v_pk_fma_f32 v[28:29], v[200:201], v[94:95], v[60:61] op_sel_hi:[1,0,0]
    v_pk_fma_f32 v[46:47], v[200:201], v[94:95], v[62:63] op_sel_hi:[1,0,0] neg_lo:[0,1,0] neg_hi:[0,1,0]
    v_pk_fma_f32 v[30:31], v[202:203], v[94:95], v[60:61] op_sel_hi:[1,0,0]
    v_pk_fma_f32 v[48:49], v[202:203], v[94:95], v[62:63] op_sel_hi:[1,0,0] neg_lo:[0,1,0] neg_hi:[0,1,0]
    v_pk_fma_f32 v[32:33], v[216:217], v[94:95], v[60:61] op_sel_hi:[1,0,0]
    v_pk_fma_f32 v[50:51], v[216:217], v[94:95], v[62:63] op_sel_hi:[1,0,0] neg_lo:[0,1,0] neg_hi:[0,1,0]
    v_pk_fma_f32 v[34:35], v[218:219], v[94:95], v[60:61] op_sel_hi:[1,0,0]
    v_pk_fma_f32 v[52:53], v[218:219], v[94:95], v[62:63] op_sel_hi:[1,0,0] neg_lo:[0,1,0] neg_hi:[0,1,0]
    v_pk_fma_f32 v[36:37], v[232:233], v[94:95], v[60:61] op_sel_hi:[1,0,0]
    v_pk_fma_f32 v[54:55], v[232:233], v[94:95], v[62:63] op_sel_hi:[1,0,0] neg_lo:[0,1,0] neg_hi:[0,1,0]
    v_pk_fma_f32 v[38:39], v[234:235], v[94:95], v[60:61] op_sel_hi:[1,0,0]
    v_pk_fma_f32 v[56:57], v[234:235], v[94:95], v[62:63] op_sel_hi:[1,0,0] neg_lo:[0,1,0] neg_hi:[0,1,0]
    v_pk_fma_f32 v[40:41], v[248:249], v[94:95], v[60:61] op_sel_hi:[1,0,0]
    v_pk_fma_f32 v[58:59], v[248:249], v[94:95], v[62:63] op_sel_hi:[1,0,0] neg_lo:[0,1,0] neg_hi:[0,1,0]
    v_exp_f32 v24, v24
    v_exp_f32 v42, v42
    v_exp_f32 v25, v25
    v_exp_f32 v43, v43
    v_exp_f32 v26, v26
    v_exp_f32 v44, v44
    v_exp_f32 v27, v27
    v_exp_f32 v45, v45
    v_exp_f32 v28, v28
    v_exp_f32 v46, v46
    v_exp_f32 v29, v29
    v_exp_f32 v47, v47
    v_exp_f32 v30, v30
    v_exp_f32 v48, v48
    v_exp_f32 v31, v31
    v_exp_f32 v49, v49
    v_exp_f32 v32, v32
    v_exp_f32 v50, v50
    v_exp_f32 v33, v33
    v_exp_f32 v51, v51
    v_exp_f32 v34, v34
    v_exp_f32 v52, v52
    v_exp_f32 v35, v35
    v_exp_f32 v53, v53
    v_exp_f32 v36, v36
    v_exp_f32 v54, v54
    v_exp_f32 v37, v37
    v_exp_f32 v55, v55
    v_exp_f32 v38, v38
    v_exp_f32 v56, v56
    v_exp_f32 v39, v39
    v_exp_f32 v57, v57
    v_exp_f32 v40, v40
    v_exp_f32 v58, v58
    v_exp_f32 v41, v41
    v_exp_f32 v59, v59
    s_nop 0
    v_cvt_pk_bf16_f32 v76, v24, v25
    v_cvt_pk_bf16_f32 v77, v26, v27
    v_cvt_pk_bf16_f32 v78, v28, v29
    v_cvt_pk_bf16_f32 v79, v30, v31
    v_cvt_pk_bf16_f32 v80, v32, v33
    v_cvt_pk_bf16_f32 v81, v34, v35
    v_cvt_pk_bf16_f32 v82, v36, v37
    v_cvt_pk_bf16_f32 v83, v38, v39
    v_cvt_pk_bf16_f32 v84, v40, v41
    v_accvgpr_write_b32 a188, v76
    v_accvgpr_write_b32 a189, v77
    v_accvgpr_write_b32 a190, v78
    v_accvgpr_write_b32 a191, v79
    v_accvgpr_write_b32 a192, v80
    v_accvgpr_write_b32 a193, v81
    v_accvgpr_write_b32 a194, v82
    v_accvgpr_write_b32 a195, v83
    v_accvgpr_write_b32 a196, v84
    v_accvgpr_write_b32 a197, 0
    v_accvgpr_write_b32 a198, 0
    v_accvgpr_write_b32 a199, 0
    v_cvt_pk_bf16_f32 v76, v42, v43
    v_cvt_pk_bf16_f32 v77, v44, v45
    v_cvt_pk_bf16_f32 v78, v46, v47
    v_cvt_pk_bf16_f32 v79, v48, v49
    v_cvt_pk_bf16_f32 v80, v50, v51
    v_cvt_pk_bf16_f32 v81, v52, v53
    v_cvt_pk_bf16_f32 v82, v54, v55
    v_cvt_pk_bf16_f32 v83, v56, v57
    v_cvt_pk_bf16_f32 v84, v58, v59
    v_accvgpr_write_b32 a200, v76
    v_accvgpr_write_b32 a201, v77
    v_accvgpr_write_b32 a202, v78
    v_accvgpr_write_b32 a203, v79
    v_accvgpr_write_b32 a204, v80
    v_accvgpr_write_b32 a205, v81
    v_accvgpr_write_b32 a206, v82
    v_accvgpr_write_b32 a207, v83
    v_accvgpr_write_b32 a208, v84
    v_accvgpr_write_b32 a209, 0
    v_accvgpr_write_b32 a210, 0
    v_accvgpr_write_b32 a211, 0
    s_lshl_b32 s38, s33, 7
    v_mov_b32 v174, s38
    global_load_dword v175, v174, s[66:67] sc1
    v_max3_f32 v60, v188, v189, v190
    v_min3_f32 v62, v188, v189, v190
    v_max3_f32 v60, v60, v191, v204
    v_min3_f32 v62, v62, v191, v204
    v_max3_f32 v60, v60, v205, v206
    v_min3_f32 v62, v62, v205, v206
    v_max3_f32 v60, v60, v207, v220
    v_min3_f32 v62, v62, v207, v220
    v_max3_f32 v60, v60, v221, v222
    v_min3_f32 v62, v62, v221, v222
    v_max3_f32 v60, v60, v223, v236
    v_min3_f32 v62, v62, v223, v236
    v_max3_f32 v60, v60, v237, v238
    v_min3_f32 v62, v62, v237, v238
    v_max3_f32 v60, v60, v239, v252
    v_min3_f32 v62, v62, v239, v252
    v_max_f32 v60, v60, v253
    v_min_f32 v62, v62, v253
    v_mul_f32_e64 v60, -s31, v60
    v_mul_f32 v62, s31, v62
    v_pk_fma_f32 v[24:25], v[188:189], v[94:95], v[60:61] op_sel_hi:[1,0,0]
    v_pk_fma_f32 v[42:43], v[188:189], v[94:95], v[62:63] op_sel_hi:[1,0,0] neg_lo:[0,1,0] neg_hi:[0,1,0]
    v_pk_fma_f32 v[26:27], v[190:191], v[94:95], v[60:61] op_sel_hi:[1,0,0]
    v_pk_fma_f32 v[44:45], v[190:191], v[94:95], v[62:63] op_sel_hi:[1,0,0] neg_lo:[0,1,0] neg_hi:[0,1,0]
    v_pk_fma_f32 v[28:29], v[204:205], v[94:95], v[60:61] op_sel_hi:[1,0,0]
    v_pk_fma_f32 v[46:47], v[204:205], v[94:95], v[62:63] op_sel_hi:[1,0,0] neg_lo:[0,1,0] neg_hi:[0,1,0]
    v_pk_fma_f32 v[30:31], v[206:207], v[94:95], v[60:61] op_sel_hi:[1,0,0]
    v_pk_fma_f32 v[48:49], v[206:207], v[94:95], v[62:63] op_sel_hi:[1,0,0] neg_lo:[0,1,0] neg_hi:[0,1,0]
    v_pk_fma_f32 v[32:33], v[220:221], v[94:95], v[60:61] op_sel_hi:[1,0,0]
    v_pk_fma_f32 v[50:51], v[220:221], v[94:95], v[62:63] op_sel_hi:[1,0,0] neg_lo:[0,1,0] neg_hi:[0,1,0]
    v_pk_fma_f32 v[34:35], v[222:223], v[94:95], v[60:61] op_sel_hi:[1,0,0]
    v_pk_fma_f32 v[52:53], v[222:223], v[94:95], v[62:63] op_sel_hi:[1,0,0] neg_lo:[0,1,0] neg_hi:[0,1,0]
    v_pk_fma_f32 v[36:37], v[236:237], v[94:95], v[60:61] op_sel_hi:[1,0,0]
    v_pk_fma_f32 v[54:55], v[236:237], v[94:95], v[62:63] op_sel_hi:[1,0,0] neg_lo:[0,1,0] neg_hi:[0,1,0]
    v_pk_fma_f32 v[38:39], v[238:239], v[94:95], v[60:61] op_sel_hi:[1,0,0]
    v_pk_fma_f32 v[56:57], v[238:239], v[94:95], v[62:63] op_sel_hi:[1,0,0] neg_lo:[0,1,0] neg_hi:[0,1,0]
    v_pk_fma_f32 v[40:41], v[252:253], v[94:95], v[60:61] op_sel_hi:[1,0,0]
    v_pk_fma_f32 v[58:59], v[252:253], v[94:95], v[62:63] op_sel_hi:[1,0,0] neg_lo:[0,1,0] neg_hi:[0,1,0]
    v_exp_f32 v24, v24
    v_exp_f32 v42, v42
    v_exp_f32 v25, v25
    v_exp_f32 v43, v43
    v_exp_f32 v26, v26
    v_exp_f32 v44, v44
    v_exp_f32 v27, v27
    v_exp_f32 v45, v45
    v_exp_f32 v28, v28
    v_exp_f32 v46, v46
    v_exp_f32 v29, v29
    v_exp_f32 v47, v47
    v_exp_f32 v30, v30
    v_exp_f32 v48, v48
    v_exp_f32 v31, v31
    v_exp_f32 v49, v49
    v_exp_f32 v32, v32
    v_exp_f32 v50, v50
    v_exp_f32 v33, v33
    v_exp_f32 v51, v51
    v_exp_f32 v34, v34
    v_exp_f32 v52, v52
    v_exp_f32 v35, v35
    v_exp_f32 v53, v53
    v_exp_f32 v36, v36
    v_exp_f32 v54, v54
    v_exp_f32 v37, v37
    v_exp_f32 v55, v55
    v_exp_f32 v38, v38
    v_exp_f32 v56, v56
    v_exp_f32 v39, v39
    v_exp_f32 v57, v57
    v_exp_f32 v40, v40
    v_exp_f32 v58, v58
    v_exp_f32 v41, v41
    v_exp_f32 v59, v59
    s_nop 0
    v_cvt_pk_bf16_f32 v76, v24, v25
    v_cvt_pk_bf16_f32 v77, v26, v27
    v_cvt_pk_bf16_f32 v78, v28, v29
    v_cvt_pk_bf16_f32 v79, v30, v31
    v_cvt_pk_bf16_f32 v80, v32, v33
    v_cvt_pk_bf16_f32 v81, v34, v35
    v_cvt_pk_bf16_f32 v82, v36, v37
    v_cvt_pk_bf16_f32 v83, v38, v39
    v_cvt_pk_bf16_f32 v84, v40, v41
    v_accvgpr_write_b32 a212, v76
    v_accvgpr_write_b32 a213, v77
    v_accvgpr_write_b32 a214, v78
    v_accvgpr_write_b32 a215, v79
    v_accvgpr_write_b32 a216, v80
    v_accvgpr_write_b32 a217, v81
    v_accvgpr_write_b32 a218, v82
    v_accvgpr_write_b32 a219, v83
    v_accvgpr_write_b32 a220, v84
    v_accvgpr_write_b32 a221, 0
    v_accvgpr_write_b32 a222, 0
    v_accvgpr_write_b32 a223, 0
    v_cvt_pk_bf16_f32 v76, v42, v43
    v_cvt_pk_bf16_f32 v77, v44, v45
    v_cvt_pk_bf16_f32 v78, v46, v47
    v_cvt_pk_bf16_f32 v79, v48, v49
    v_cvt_pk_bf16_f32 v80, v50, v51
    v_cvt_pk_bf16_f32 v81, v52, v53
    v_cvt_pk_bf16_f32 v82, v54, v55
    v_cvt_pk_bf16_f32 v83, v56, v57
    v_cvt_pk_bf16_f32 v84, v58, v59
    v_accvgpr_write_b32 a224, v76
    v_accvgpr_write_b32 a225, v77
    v_accvgpr_write_b32 a226, v78
    v_accvgpr_write_b32 a227, v79
    v_accvgpr_write_b32 a228, v80
    v_accvgpr_write_b32 a229, v81
    v_accvgpr_write_b32 a230, v82
    v_accvgpr_write_b32 a231, v83
    v_accvgpr_write_b32 a232, v84
    v_accvgpr_write_b32 a233, 0
    v_accvgpr_write_b32 a234, 0
    v_accvgpr_write_b32 a235, 0
    s_waitcnt vmcnt(0)
    s_cmp_eq_u32 s24, 0
    s_cbranch_scc0 L_att_wdone
    v_readfirstlane_b32 s38, v175
    s_nop 1
    s_cmp_ge_u32 s38, 8
    s_cbranch_scc1 L_att_wdone
    s_lshl_b32 s38, s33, 7
    v_mov_b32 v33, s38
    s_mov_b32 s39, 0
L_att_poll:
    s_add_u32 s39, s39, 1
    s_cmp_gt_u32 s39, 200000
    s_cbranch_scc1 L_att_wdone
    global_load_dword v34, v33, s[66:67] sc1
    s_waitcnt vmcnt(0)
    v_readfirstlane_b32 s38, v34
    s_nop 1
    s_cmp_ge_u32 s38, 8
    s_cbranch_scc1 L_att_wdone
    s_sleep 6
    s_branch L_att_poll
L_att_wdone:
    s_barrier
    s_lshl_b32 s39, s33, 2
    s_add_u32 s39, s39, s24
    s_mul_i32 s39, s39, 2880
    v_cmp_gt_u32 vcc, 52, v20
    s_add_u32 s38, s39, 0
    buffer_load_dwordx4 v[96:99], v21, s[20:23], s38 offen offset:0 sc1
    buffer_load_dwordx4 v[100:103], v21, s[20:23], s38 offen offset:1024 sc1
    s_add_u32 s38, s39, 92160
    buffer_load_dwordx4 v[108:111], v21, s[20:23], s38 offen offset:0 sc1
    buffer_load_dwordx4 v[112:115], v21, s[20:23], s38 offen offset:1024 sc1
    s_add_u32 s38, s39, 184320
    buffer_load_dwordx4 v[120:123], v21, s[20:23], s38 offen offset:0 sc1
    buffer_load_dwordx4 v[124:127], v21, s[20:23], s38 offen offset:1024 sc1
    s_add_u32 s38, s39, 276480
    buffer_load_dwordx4 v[132:135], v21, s[20:23], s38 offen offset:0 sc1
    buffer_load_dwordx4 v[136:139], v21, s[20:23], s38 offen offset:1024 sc1
    s_add_u32 s38, s39, 368640
    buffer_load_dwordx4 v[144:147], v21, s[20:23], s38 offen offset:0 sc1
    buffer_load_dwordx4 v[148:151], v21, s[20:23], s38 offen offset:1024 sc1
    s_add_u32 s38, s39, 460800
    buffer_load_dwordx4 v[156:159], v21, s[20:23], s38 offen offset:0 sc1
    buffer_load_dwordx4 v[160:163], v21, s[20:23], s38 offen offset:1024 sc1
    s_add_u32 s38, s39, 552960
    buffer_load_dwordx4 v[168:171], v21, s[20:23], s38 offen offset:0 sc1
    buffer_load_dwordx4 v[172:175], v21, s[20:23], s38 offen offset:1024 sc1
    s_add_u32 s38, s39, 645120
    buffer_load_dwordx4 v[180:183], v21, s[20:23], s38 offen offset:0 sc1
    buffer_load_dwordx4 v[184:187], v21, s[20:23], s38 offen offset:1024 sc1
    s_mov_b64 exec, vcc
    s_add_u32 s38, s39, 0
    buffer_load_dwordx4 v[104:107], v21, s[20:23], s38 offen offset:2048 sc1
    s_add_u32 s38, s39, 92160
    buffer_load_dwordx4 v[116:119], v21, s[20:23], s38 offen offset:2048 sc1
    s_add_u32 s38, s39, 184320
    buffer_load_dwordx4 v[128:131], v21, s[20:23], s38 offen offset:2048 sc1
    s_add_u32 s38, s39, 276480
    buffer_load_dwordx4 v[140:143], v21, s[20:23], s38 offen offset:2048 sc1
    s_add_u32 s38, s39, 368640
    buffer_load_dwordx4 v[152:155], v21, s[20:23], s38 offen offset:2048 sc1
    s_add_u32 s38, s39, 460800
    buffer_load_dwordx4 v[164:167], v21, s[20:23], s38 offen offset:2048 sc1
    s_add_u32 s38, s39, 552960
    buffer_load_dwordx4 v[176:179], v21, s[20:23], s38 offen offset:2048 sc1
    s_add_u32 s38, s39, 645120
    buffer_load_dwordx4 v[188:191], v21, s[20:23], s38 offen offset:2048 sc1
    s_mov_b64 exec, -1
    s_and_b32 s48, s24, 1
    v_add_u32 v30, 0, v20
    v_mul_u32_u24 v31, 205, v30
    v_lshrrev_b32 v31, 10, v31
    v_mul_u32_u24 v32, 5, v31
    v_sub_u32 v32, v30, v32
    s_cmp_eq_u32 s48, 0
    s_cselect_b32 s49, 4, 0
    v_cmp_eq_u32 s[50:51], s49, v32
    v_cmp_le_u32 vcc, 18, v31
    v_mov_b32 v36, 0
    v_mov_b32 v37, 240
    v_cndmask_b32 v36, v36, v37, vcc
    v_mul_u32_u24 v31, 40, v31
    v_add_u32 v31, v31, v36
    s_mul_i32 s38, s24, 1920
    s_add_u32 s38, s38, 129024
    v_add_u32 v31, s38, v31
    v_lshlrev_b32 v32, 1, v32
    v_subrev_u32 v33, s48, v32
    v_add_u32 v34, 1, v33
    v_cmp_gt_i32 vcc, 0, v33
    v_add_u32 v36, 10, v33
    s_nop 0
    v_cndmask_b32 v33, v33, v36, vcc
    v_lshl_add_u32 v40, v33, 2, v31
    v_lshl_add_u32 v41, v34, 2, v31
    v_add_u32 v30, 64, v20
    v_mul_u32_u24 v31, 205, v30
    v_lshrrev_b32 v31, 10, v31
    v_mul_u32_u24 v32, 5, v31
    v_sub_u32 v32, v30, v32
    s_cmp_eq_u32 s48, 0
    s_cselect_b32 s49, 4, 0
    v_cmp_eq_u32 s[52:53], s49, v32
    v_cmp_le_u32 vcc, 18, v31
    v_mov_b32 v36, 0
    v_mov_b32 v37, 240
    v_cndmask_b32 v36, v36, v37, vcc
    v_mul_u32_u24 v31, 40, v31
    v_add_u32 v31, v31, v36
    s_mul_i32 s38, s24, 1920
    s_add_u32 s38, s38, 129024
    v_add_u32 v31, s38, v31
    v_lshlrev_b32 v32, 1, v32
    v_subrev_u32 v33, s48, v32
    v_add_u32 v34, 1, v33
    v_cmp_gt_i32 vcc, 0, v33
    v_add_u32 v36, 10, v33
    s_nop 0
    v_cndmask_b32 v33, v33, v36, vcc
    v_lshl_add_u32 v42, v33, 2, v31
    v_lshl_add_u32 v43, v34, 2, v31
    v_add_u32 v30, 128, v20
    v_mul_u32_u24 v31, 205, v30
    v_lshrrev_b32 v31, 10, v31
    v_mul_u32_u24 v32, 5, v31
    v_sub_u32 v32, v30, v32
    s_cmp_eq_u32 s48, 0
    s_cselect_b32 s49, 4, 0
    v_cmp_eq_u32 s[54:55], s49, v32
    v_cmp_le_u32 vcc, 18, v31
    v_mov_b32 v36, 0
    v_mov_b32 v37, 240
    v_cndmask_b32 v36, v36, v37, vcc
    v_mul_u32_u24 v31, 40, v31
    v_add_u32 v31, v31, v36
    s_mul_i32 s38, s24, 1920
    s_add_u32 s38, s38, 129024
    v_add_u32 v31, s38, v31
    v_lshlrev_b32 v32, 1, v32
    v_subrev_u32 v33, s48, v32
    v_add_u32 v34, 1, v33
    v_cmp_gt_i32 vcc, 0, v33
    v_add_u32 v36, 10, v33
    s_nop 0
    v_cndmask_b32 v33, v33, v36, vcc
    v_lshl_add_u32 v44, v33, 2, v31
    v_lshl_add_u32 v45, v34, 2, v31
    v_mov_b32 v35, 1.0
    s_waitcnt vmcnt(0)
    v_pk_add_f32 v[96:97], v[96:97], v[108:109]
    v_pk_add_f32 v[96:97], v[96:97], v[120:121]
    v_pk_add_f32 v[96:97], v[96:97], v[132:133]
    v_pk_add_f32 v[96:97], v[96:97], v[144:145]
    v_pk_add_f32 v[96:97], v[96:97], v[156:157]
    v_pk_add_f32 v[96:97], v[96:97], v[168:169]
    v_pk_add_f32 v[96:97], v[96:97], v[180:181]
    v_pk_add_f32 v[98:99], v[98:99], v[110:111]
    v_pk_add_f32 v[98:99], v[98:99], v[122:123]
    v_pk_add_f32 v[98:99], v[98:99], v[134:135]
    v_pk_add_f32 v[98:99], v[98:99], v[146:147]
    v_pk_add_f32 v[98:99], v[98:99], v[158:159]
    v_pk_add_f32 v[98:99], v[98:99], v[170:171]
    v_pk_add_f32 v[98:99], v[98:99], v[182:183]
    v_pk_add_f32 v[100:101], v[100:101], v[112:113]
    v_pk_add_f32 v[100:101], v[100:101], v[124:125]
    v_pk_add_f32 v[100:101], v[100:101], v[136:137]
    v_pk_add_f32 v[100:101], v[100:101], v[148:149]
    v_pk_add_f32 v[100:101], v[100:101], v[160:161]
    v_pk_add_f32 v[100:101], v[100:101], v[172:173]
    v_pk_add_f32 v[100:101], v[100:101], v[184:185]
    v_pk_add_f32 v[102:103], v[102:103], v[114:115]
    v_pk_add_f32 v[102:103], v[102:103], v[126:127]
    v_pk_add_f32 v[102:103], v[102:103], v[138:139]
    v_pk_add_f32 v[102:103], v[102:103], v[150:151]
    v_pk_add_f32 v[102:103], v[102:103], v[162:163]
    v_pk_add_f32 v[102:103], v[102:103], v[174:175]
    v_pk_add_f32 v[102:103], v[102:103], v[186:187]
    v_pk_add_f32 v[104:105], v[104:105], v[116:117]
    v_pk_add_f32 v[104:105], v[104:105], v[128:129]
    v_pk_add_f32 v[104:105], v[104:105], v[140:141]
    v_pk_add_f32 v[104:105], v[104:105], v[152:153]
    v_pk_add_f32 v[104:105], v[104:105], v[164:165]
    v_pk_add_f32 v[104:105], v[104:105], v[176:177]
    v_pk_add_f32 v[104:105], v[104:105], v[188:189]
    v_pk_add_f32 v[106:107], v[106:107], v[118:119]
    v_pk_add_f32 v[106:107], v[106:107], v[130:131]
    v_pk_add_f32 v[106:107], v[106:107], v[142:143]
    v_pk_add_f32 v[106:107], v[106:107], v[154:155]
    v_pk_add_f32 v[106:107], v[106:107], v[166:167]
    v_pk_add_f32 v[106:107], v[106:107], v[178:179]
    v_pk_add_f32 v[106:107], v[106:107], v[190:191]
    v_cmp_gt_u32 vcc, 52, v20
    s_cmp_eq_u32 s48, 0
    s_cbranch_scc1 L_att_even
    v_cndmask_b32 v97, v97, v35, s[50:51]
    v_cndmask_b32 v101, v101, v35, s[52:53]
    v_cndmask_b32 v105, v105, v35, s[54:55]
    s_branch L_att_par
L_att_even:
    v_cndmask_b32 v99, v99, v35, s[50:51]
    v_cndmask_b32 v103, v103, v35, s[52:53]
    v_cndmask_b32 v107, v107, v35, s[54:55]
L_att_par:
    v_cvt_pk_bf16_f32 v38, v96, v97
    v_cvt_pk_bf16_f32 v39, v98, v99
    ds_write_b32 v40, v38
    ds_write_b32 v41, v39
    v_cvt_pk_bf16_f32 v38, v100, v101
    v_cvt_pk_bf16_f32 v39, v102, v103
    ds_write_b32 v42, v38
    ds_write_b32 v43, v39
    v_cvt_pk_bf16_f32 v38, v104, v105
    v_cvt_pk_bf16_f32 v39, v106, v107
    s_mov_b64 exec, vcc
    ds_write_b32 v44, v38
    ds_write_b32 v45, v39
    s_mov_b64 exec, -1
    s_waitcnt lgkmcnt(0)
    s_barrier
    ds_read_b64_tr_b16 a[80:81], v23 offset:0
    ds_read_b64_tr_b16 a[82:83], v23 offset:160
    ds_read_b64_tr_b16 a[84:85], v23 offset:8
    ds_read_b64_tr_b16 a[86:87], v23 offset:168
    ds_read_b64_tr_b16 a[88:89], v23 offset:16
    ds_read_b64_tr_b16 a[90:91], v23 offset:176
    ds_read_b64_tr_b16 a[92:93], v23 offset:24
    ds_read_b64_tr_b16 a[94:95], v23 offset:184
    s_waitcnt lgkmcnt(6)
    v_mfma_f32_16x16x32_bf16 v[96:99], a[80:83], a[140:143], 0
    ds_read_b64_tr_b16 a[96:97], v23 offset:32
    v_mfma_f32_16x16x32_bf16 v[100:103], a[80:83], a[164:167], 0
    ds_read_b64_tr_b16 a[98:99], v23 offset:192
    v_mfma_f32_16x16x32_bf16 v[104:107], a[80:83], a[188:191], 0
    v_mfma_f32_16x16x32_bf16 v[108:111], a[80:83], a[212:215], 0
    s_waitcnt lgkmcnt(6)
    v_mfma_f32_16x16x32_bf16 v[112:115], a[84:87], a[140:143], 0
    ds_read_b64_tr_b16 a[100:101], v23 offset:320
    v_mfma_f32_16x16x32_bf16 v[116:119], a[84:87], a[164:167], 0
    ds_read_b64_tr_b16 a[102:103], v23 offset:480
    v_mfma_f32_16x16x32_bf16 v[120:123], a[84:87], a[188:191], 0
    v_mfma_f32_16x16x32_bf16 v[124:127], a[84:87], a[212:215], 0
    s_waitcnt lgkmcnt(6)
    v_mfma_f32_16x16x32_bf16 v[128:131], a[88:91], a[140:143], 0
    ds_read_b64_tr_b16 a[80:81], v23 offset:328
    v_mfma_f32_16x16x32_bf16 v[132:135], a[88:91], a[164:167], 0
    ds_read_b64_tr_b16 a[82:83], v23 offset:488
    v_mfma_f32_16x16x32_bf16 v[136:139], a[88:91], a[188:191], 0
    v_mfma_f32_16x16x32_bf16 v[140:143], a[88:91], a[212:215], 0
    s_waitcnt lgkmcnt(6)
    v_mfma_f32_16x16x32_bf16 v[144:147], a[92:95], a[140:143], 0
    ds_read_b64_tr_b16 a[84:85], v23 offset:336
    v_mfma_f32_16x16x32_bf16 v[148:151], a[92:95], a[164:167], 0
    ds_read_b64_tr_b16 a[86:87], v23 offset:496
    v_mfma_f32_16x16x32_bf16 v[152:155], a[92:95], a[188:191], 0
    v_mfma_f32_16x16x32_bf16 v[156:159], a[92:95], a[212:215], 0
    s_waitcnt lgkmcnt(6)
    v_mfma_f32_16x16x32_bf16 v[160:163], a[96:99], a[140:143], 0
    ds_read_b64_tr_b16 a[88:89], v23 offset:344
    v_mfma_f32_16x16x32_bf16 v[164:167], a[96:99], a[164:167], 0
    ds_read_b64_tr_b16 a[90:91], v23 offset:504
    v_mfma_f32_16x16x32_bf16 v[168:171], a[96:99], a[188:191], 0
    v_mfma_f32_16x16x32_bf16 v[172:175], a[96:99], a[212:215], 0
    s_waitcnt lgkmcnt(6)
    v_mfma_f32_16x16x32_bf16 v[96:99], a[100:103], a[144:147], v[96:99]
    ds_read_b64_tr_b16 a[92:93], v23 offset:352
    v_mfma_f32_16x16x32_bf16 v[100:103], a[100:103], a[168:171], v[100:103]
    ds_read_b64_tr_b16 a[94:95], v23 offset:512
    v_mfma_f32_16x16x32_bf16 v[104:107], a[100:103], a[192:195], v[104:107]
    v_mfma_f32_16x16x32_bf16 v[108:111], a[100:103], a[216:219], v[108:111]
    s_waitcnt lgkmcnt(6)
    v_mfma_f32_16x16x32_bf16 v[112:115], a[80:83], a[144:147], v[112:115]
    ds_read_b64_tr_b16 a[96:97], v23 offset:640
    v_mfma_f32_16x16x32_bf16 v[116:119], a[80:83], a[168:171], v[116:119]
    ds_read_b64_tr_b16 a[98:99], v23 offset:800
    v_mfma_f32_16x16x32_bf16 v[120:123], a[80:83], a[192:195], v[120:123]
    v_mfma_f32_16x16x32_bf16 v[124:127], a[80:83], a[216:219], v[124:127]
    s_waitcnt lgkmcnt(6)
    v_mfma_f32_16x16x32_bf16 v[128:131], a[84:87], a[144:147], v[128:131]
    ds_read_b64_tr_b16 a[100:101], v23 offset:648
    v_mfma_f32_16x16x32_bf16 v[132:135], a[84:87], a[168:171], v[132:135]
    ds_read_b64_tr_b16 a[102:103], v23 offset:808
    v_mfma_f32_16x16x32_bf16 v[136:139], a[84:87], a[192:195], v[136:139]
    v_mfma_f32_16x16x32_bf16 v[140:143], a[84:87], a[216:219], v[140:143]
    s_waitcnt lgkmcnt(6)
    v_mfma_f32_16x16x32_bf16 v[144:147], a[88:91], a[144:147], v[144:147]
    ds_read_b64_tr_b16 a[80:81], v23 offset:656
    v_mfma_f32_16x16x32_bf16 v[148:151], a[88:91], a[168:171], v[148:151]
    ds_read_b64_tr_b16 a[82:83], v23 offset:816
    v_mfma_f32_16x16x32_bf16 v[152:155], a[88:91], a[192:195], v[152:155]
    v_mfma_f32_16x16x32_bf16 v[156:159], a[88:91], a[216:219], v[156:159]
    s_waitcnt lgkmcnt(6)
    v_mfma_f32_16x16x32_bf16 v[160:163], a[92:95], a[144:147], v[160:163]
    ds_read_b64_tr_b16 a[84:85], v23 offset:664
    v_mfma_f32_16x16x32_bf16 v[164:167], a[92:95], a[168:171], v[164:167]
    ds_read_b64_tr_b16 a[86:87], v23 offset:824
    v_mfma_f32_16x16x32_bf16 v[168:171], a[92:95], a[192:195], v[168:171]
    v_mfma_f32_16x16x32_bf16 v[172:175], a[92:95], a[216:219], v[172:175]
    s_waitcnt lgkmcnt(6)
    v_mfma_f32_16x16x32_bf16 v[96:99], a[96:99], a[148:151], v[96:99]
    ds_read_b64_tr_b16 a[88:89], v23 offset:672
    v_mfma_f32_16x16x32_bf16 v[100:103], a[96:99], a[172:175], v[100:103]
    ds_read_b64_tr_b16 a[90:91], v23 offset:832
    v_mfma_f32_16x16x32_bf16 v[104:107], a[96:99], a[196:199], v[104:107]
    v_mfma_f32_16x16x32_bf16 v[108:111], a[96:99], a[220:223], v[108:111]
    s_waitcnt lgkmcnt(6)
    v_mfma_f32_16x16x32_bf16 v[112:115], a[100:103], a[148:151], v[112:115]
    ds_read_b64_tr_b16 a[92:93], v23 offset:960
    v_mfma_f32_16x16x32_bf16 v[116:119], a[100:103], a[172:175], v[116:119]
    ds_read_b64_tr_b16 a[94:95], v23 offset:1120
    v_mfma_f32_16x16x32_bf16 v[120:123], a[100:103], a[196:199], v[120:123]
    v_mfma_f32_16x16x32_bf16 v[124:127], a[100:103], a[220:223], v[124:127]
    s_waitcnt lgkmcnt(6)
    v_mfma_f32_16x16x32_bf16 v[128:131], a[80:83], a[148:151], v[128:131]
    ds_read_b64_tr_b16 a[96:97], v23 offset:968
    v_mfma_f32_16x16x32_bf16 v[132:135], a[80:83], a[172:175], v[132:135]
    ds_read_b64_tr_b16 a[98:99], v23 offset:1128
    v_mfma_f32_16x16x32_bf16 v[136:139], a[80:83], a[196:199], v[136:139]
    v_mfma_f32_16x16x32_bf16 v[140:143], a[80:83], a[220:223], v[140:143]
    s_waitcnt lgkmcnt(6)
    v_mfma_f32_16x16x32_bf16 v[144:147], a[84:87], a[148:151], v[144:147]
    ds_read_b64_tr_b16 a[100:101], v23 offset:976
    v_mfma_f32_16x16x32_bf16 v[148:151], a[84:87], a[172:175], v[148:151]
    ds_read_b64_tr_b16 a[102:103], v23 offset:1136
    v_mfma_f32_16x16x32_bf16 v[152:155], a[84:87], a[196:199], v[152:155]
    v_mfma_f32_16x16x32_bf16 v[156:159], a[84:87], a[220:223], v[156:159]
    s_waitcnt lgkmcnt(6)
    v_mfma_f32_16x16x32_bf16 v[160:163], a[88:91], a[148:151], v[160:163]
    ds_read_b64_tr_b16 a[80:81], v23 offset:984
    v_mfma_f32_16x16x32_bf16 v[164:167], a[88:91], a[172:175], v[164:167]
    ds_read_b64_tr_b16 a[82:83], v23 offset:1144
    v_mfma_f32_16x16x32_bf16 v[168:171], a[88:91], a[196:199], v[168:171]
    v_mfma_f32_16x16x32_bf16 v[172:175], a[88:91], a[220:223], v[172:175]
    s_waitcnt lgkmcnt(6)
    v_mfma_f32_16x16x32_bf16 v[176:179], a[92:95], a[152:155], 0
    ds_read_b64_tr_b16 a[84:85], v23 offset:992
    v_mfma_f32_16x16x32_bf16 v[180:183], a[92:95], a[176:179], 0
    ds_read_b64_tr_b16 a[86:87], v23 offset:1152
    v_mfma_f32_16x16x32_bf16 v[184:187], a[92:95], a[200:203], 0
    v_mfma_f32_16x16x32_bf16 v[188:191], a[92:95], a[224:227], 0
    s_waitcnt lgkmcnt(6)
    v_mfma_f32_16x16x32_bf16 v[192:195], a[96:99], a[152:155], 0
    ds_read_b64_tr_b16 a[88:89], v23 offset:1280
    v_mfma_f32_16x16x32_bf16 v[196:199], a[96:99], a[176:179], 0
    ds_read_b64_tr_b16 a[90:91], v23 offset:1440
    v_mfma_f32_16x16x32_bf16 v[200:203], a[96:99], a[200:203], 0
    v_mfma_f32_16x16x32_bf16 v[204:207], a[96:99], a[224:227], 0
    s_waitcnt lgkmcnt(6)
    v_mfma_f32_16x16x32_bf16 v[208:211], a[100:103], a[152:155], 0
    ds_read_b64_tr_b16 a[92:93], v23 offset:1288
    v_mfma_f32_16x16x32_bf16 v[212:215], a[100:103], a[176:179], 0
    ds_read_b64_tr_b16 a[94:95], v23 offset:1448
    v_mfma_f32_16x16x32_bf16 v[216:219], a[100:103], a[200:203], 0
    v_mfma_f32_16x16x32_bf16 v[220:223], a[100:103], a[224:227], 0
    s_waitcnt lgkmcnt(6)
    v_mfma_f32_16x16x32_bf16 v[224:227], a[80:83], a[152:155], 0
    ds_read_b64_tr_b16 a[96:97], v23 offset:1296
    v_mfma_f32_16x16x32_bf16 v[228:231], a[80:83], a[176:179], 0
    ds_read_b64_tr_b16 a[98:99], v23 offset:1456
    v_mfma_f32_16x16x32_bf16 v[232:235], a[80:83], a[200:203], 0
    v_mfma_f32_16x16x32_bf16 v[236:239], a[80:83], a[224:227], 0
    s_waitcnt lgkmcnt(6)
    v_mfma_f32_16x16x32_bf16 v[240:243], a[84:87], a[152:155], 0
    ds_read_b64_tr_b16 a[100:101], v23 offset:1304
    v_mfma_f32_16x16x32_bf16 v[244:247], a[84:87], a[176:179], 0
    ds_read_b64_tr_b16 a[102:103], v23 offset:1464
    v_mfma_f32_16x16x32_bf16 v[248:251], a[84:87], a[200:203], 0
    v_mfma_f32_16x16x32_bf16 v[252:255], a[84:87], a[224:227], 0
    s_waitcnt lgkmcnt(6)
    v_mfma_f32_16x16x32_bf16 v[176:179], a[88:91], a[156:159], v[176:179]
    ds_read_b64_tr_b16 a[80:81], v23 offset:1312
    v_mfma_f32_16x16x32_bf16 v[180:183], a[88:91], a[180:183], v[180:183]
    ds_read_b64_tr_b16 a[82:83], v23 offset:1472
    v_mfma_f32_16x16x32_bf16 v[184:187], a[88:91], a[204:207], v[184:187]
    v_mfma_f32_16x16x32_bf16 v[188:191], a[88:91], a[228:231], v[188:191]
    s_waitcnt lgkmcnt(6)
    v_mfma_f32_16x16x32_bf16 v[192:195], a[92:95], a[156:159], v[192:195]
    ds_read_b64_tr_b16 a[84:85], v23 offset:1600
    v_mfma_f32_16x16x32_bf16 v[196:199], a[92:95], a[180:183], v[196:199]
    ds_read_b64_tr_b16 a[86:87], v23 offset:1760
    v_mfma_f32_16x16x32_bf16 v[200:203], a[92:95], a[204:207], v[200:203]
    v_mfma_f32_16x16x32_bf16 v[204:207], a[92:95], a[228:231], v[204:207]
    s_waitcnt lgkmcnt(6)
    v_mfma_f32_16x16x32_bf16 v[208:211], a[96:99], a[156:159], v[208:211]
    ds_read_b64_tr_b16 a[88:89], v23 offset:1608
    v_mfma_f32_16x16x32_bf16 v[212:215], a[96:99], a[180:183], v[212:215]
    ds_read_b64_tr_b16 a[90:91], v23 offset:1768
    v_mfma_f32_16x16x32_bf16 v[216:219], a[96:99], a[204:207], v[216:219]
    v_mfma_f32_16x16x32_bf16 v[220:223], a[96:99], a[228:231], v[220:223]
    s_waitcnt lgkmcnt(6)
    v_mfma_f32_16x16x32_bf16 v[224:227], a[100:103], a[156:159], v[224:227]
    ds_read_b64_tr_b16 a[92:93], v23 offset:1616
    v_mfma_f32_16x16x32_bf16 v[228:231], a[100:103], a[180:183], v[228:231]
    ds_read_b64_tr_b16 a[94:95], v23 offset:1776
    v_mfma_f32_16x16x32_bf16 v[232:235], a[100:103], a[204:207], v[232:235]
    v_mfma_f32_16x16x32_bf16 v[236:239], a[100:103], a[228:231], v[236:239]
    s_waitcnt lgkmcnt(6)
    v_mfma_f32_16x16x32_bf16 v[240:243], a[80:83], a[156:159], v[240:243]
    ds_read_b64_tr_b16 a[96:97], v23 offset:1624
    v_mfma_f32_16x16x32_bf16 v[244:247], a[80:83], a[180:183], v[244:247]
    ds_read_b64_tr_b16 a[98:99], v23 offset:1784
    v_mfma_f32_16x16x32_bf16 v[248:251], a[80:83], a[204:207], v[248:251]
    v_mfma_f32_16x16x32_bf16 v[252:255], a[80:83], a[228:231], v[252:255]
    s_waitcnt lgkmcnt(6)
    v_mfma_f32_16x16x32_bf16 v[176:179], a[84:87], a[160:163], v[176:179]
    ds_read_b64_tr_b16 a[100:101], v23 offset:1632
    v_mfma_f32_16x16x32_bf16 v[180:183], a[84:87], a[184:187], v[180:183]
    ds_read_b64_tr_b16 a[102:103], v23 offset:1792
    v_mfma_f32_16x16x32_bf16 v[184:187], a[84:87], a[208:211], v[184:187]
    v_mfma_f32_16x16x32_bf16 v[188:191], a[84:87], a[232:235], v[188:191]
    s_waitcnt lgkmcnt(6)
    v_mfma_f32_16x16x32_bf16 v[192:195], a[88:91], a[160:163], v[192:195]
    v_mfma_f32_16x16x32_bf16 v[196:199], a[88:91], a[184:187], v[196:199]
    v_mfma_f32_16x16x32_bf16 v[200:203], a[88:91], a[208:211], v[200:203]
    v_mfma_f32_16x16x32_bf16 v[204:207], a[88:91], a[232:235], v[204:207]
    s_waitcnt lgkmcnt(4)
    v_mfma_f32_16x16x32_bf16 v[208:211], a[92:95], a[160:163], v[208:211]
    v_mfma_f32_16x16x32_bf16 v[212:215], a[92:95], a[184:187], v[212:215]
    v_mfma_f32_16x16x32_bf16 v[216:219], a[92:95], a[208:211], v[216:219]
    v_mfma_f32_16x16x32_bf16 v[220:223], a[92:95], a[232:235], v[220:223]
    s_waitcnt lgkmcnt(2)
    v_mfma_f32_16x16x32_bf16 v[224:227], a[96:99], a[160:163], v[224:227]
    v_mfma_f32_16x16x32_bf16 v[228:231], a[96:99], a[184:187], v[228:231]
    v_mfma_f32_16x16x32_bf16 v[232:235], a[96:99], a[208:211], v[232:235]
    v_mfma_f32_16x16x32_bf16 v[236:239], a[96:99], a[232:235], v[236:239]
    s_waitcnt lgkmcnt(0)
    v_mfma_f32_16x16x32_bf16 v[240:243], a[100:103], a[160:163], v[240:243]
    v_mfma_f32_16x16x32_bf16 v[244:247], a[100:103], a[184:187], v[244:247]
    v_mfma_f32_16x16x32_bf16 v[248:251], a[100:103], a[208:211], v[248:251]
    v_mfma_f32_16x16x32_bf16 v[252:255], a[100:103], a[232:235], v[252:255]
    s_lshl_b32 s38, s32, 3
    s_lshl_b32 s39, s24, 1
    s_add_u32 s38, s38, s39
    s_mul_i32 s38, s38, 162
    s_lshr_b32 s39, s33, 2
    s_add_u32 s40, s38, s39
    s_add_u32 s40, s40, 160
    s_lshl_b32 s40, s40, 11
    s_and_b32 s39, s33, 3
    s_lshl_b32 s39, s39, 2
    s_add_u32 s40, s40, s39
    s_lshl_b32 s39, s33, 1
    s_add_u32 s38, s38, s39
    s_add_u32 s38, s38, 144
    s_lshl_b32 s38, s38, 11
    v_and_b32 v72, 15, v20
    v_lshrrev_b32 v73, 4, v20
    v_and_b32 v74, 1, v73
    v_lshrrev_b32 v73, 1, v73
    v_lshlrev_b32 v72, 4, v72
    v_lshlrev_b32 v74, 9, v74
    v_lshlrev_b32 v73, 10, v73
    v_add3_u32 v72, v72, v74, v73
    s_nop 3
    v_rcp_f32 v24, v163
    v_rcp_f32 v26, v243
    s_nop 0
    v_mul_f32 v28, v162, v24
    v_fmac_f32 v28, v242, v26
    v_add_f32 v28, 0x358637bd, v28
    v_rcp_f32 v28, v28
    s_nop 0
    v_mul_f32 v24, v24, v28
    v_mul_f32 v26, v26, v28
    v_pk_mul_f32 v[30:31], v[96:97], v[24:25] op_sel_hi:[1,0]
    v_pk_fma_f32 v[30:31], v[176:177], v[26:27], v[30:31] op_sel_hi:[1,0,1]
    v_pk_mul_f32 v[32:33], v[98:99], v[24:25] op_sel_hi:[1,0]
    v_pk_fma_f32 v[32:33], v[178:179], v[26:27], v[32:33] op_sel_hi:[1,0,1]
    v_pk_mul_f32 v[34:35], v[112:113], v[24:25] op_sel_hi:[1,0]
    v_pk_fma_f32 v[34:35], v[192:193], v[26:27], v[34:35] op_sel_hi:[1,0,1]
    v_pk_mul_f32 v[36:37], v[114:115], v[24:25] op_sel_hi:[1,0]
    v_pk_fma_f32 v[36:37], v[194:195], v[26:27], v[36:37] op_sel_hi:[1,0,1]
    v_pk_mul_f32 v[38:39], v[128:129], v[24:25] op_sel_hi:[1,0]
    v_pk_fma_f32 v[38:39], v[208:209], v[26:27], v[38:39] op_sel_hi:[1,0,1]
    v_pk_mul_f32 v[40:41], v[130:131], v[24:25] op_sel_hi:[1,0]
    v_pk_fma_f32 v[40:41], v[210:211], v[26:27], v[40:41] op_sel_hi:[1,0,1]
    v_pk_mul_f32 v[42:43], v[144:145], v[24:25] op_sel_hi:[1,0]
    v_pk_fma_f32 v[42:43], v[224:225], v[26:27], v[42:43] op_sel_hi:[1,0,1]
    v_pk_mul_f32 v[44:45], v[146:147], v[24:25] op_sel_hi:[1,0]
    v_pk_fma_f32 v[44:45], v[226:227], v[26:27], v[44:45] op_sel_hi:[1,0,1]
    v_pk_mul_f32 v[46:47], v[160:161], v[24:25] op_sel_hi:[1,0]
    v_pk_fma_f32 v[46:47], v[240:241], v[26:27], v[46:47] op_sel_hi:[1,0,1]
    v_cvt_pk_bf16_f32 v48, v30, v31
    v_cvt_pk_bf16_f32 v49, v32, v33
    v_cvt_pk_bf16_f32 v50, v34, v35
    v_cvt_pk_bf16_f32 v51, v36, v37
    v_cvt_pk_bf16_f32 v52, v38, v39
    v_cvt_pk_bf16_f32 v53, v40, v41
    v_cvt_pk_bf16_f32 v54, v42, v43
    v_cvt_pk_bf16_f32 v55, v44, v45
    v_cvt_pk_bf16_f32 v56, v46, v47
    s_add_u32 s39, s38, 0
    buffer_store_dwordx4 v[48:51], v72, s[16:19], s39 offen sc1
    s_add_u32 s39, s38, 2048
    buffer_store_dwordx4 v[52:55], v72, s[16:19], s39 offen sc1
    s_add_u32 s39, s40, 0
    buffer_store_dword v56, v72, s[16:19], s39 offen sc1
    v_rcp_f32 v24, v167
    v_rcp_f32 v26, v247
    s_nop 0
    v_mul_f32 v28, v166, v24
    v_fmac_f32 v28, v246, v26
    v_add_f32 v28, 0x358637bd, v28
    v_rcp_f32 v28, v28
    s_nop 0
    v_mul_f32 v24, v24, v28
    v_mul_f32 v26, v26, v28
    v_pk_mul_f32 v[30:31], v[100:101], v[24:25] op_sel_hi:[1,0]
    v_pk_fma_f32 v[30:31], v[180:181], v[26:27], v[30:31] op_sel_hi:[1,0,1]
    v_pk_mul_f32 v[32:33], v[102:103], v[24:25] op_sel_hi:[1,0]
    v_pk_fma_f32 v[32:33], v[182:183], v[26:27], v[32:33] op_sel_hi:[1,0,1]
    v_pk_mul_f32 v[34:35], v[116:117], v[24:25] op_sel_hi:[1,0]
    v_pk_fma_f32 v[34:35], v[196:197], v[26:27], v[34:35] op_sel_hi:[1,0,1]
    v_pk_mul_f32 v[36:37], v[118:119], v[24:25] op_sel_hi:[1,0]
    v_pk_fma_f32 v[36:37], v[198:199], v[26:27], v[36:37] op_sel_hi:[1,0,1]
    v_pk_mul_f32 v[38:39], v[132:133], v[24:25] op_sel_hi:[1,0]
    v_pk_fma_f32 v[38:39], v[212:213], v[26:27], v[38:39] op_sel_hi:[1,0,1]
    v_pk_mul_f32 v[40:41], v[134:135], v[24:25] op_sel_hi:[1,0]
    v_pk_fma_f32 v[40:41], v[214:215], v[26:27], v[40:41] op_sel_hi:[1,0,1]
    v_pk_mul_f32 v[42:43], v[148:149], v[24:25] op_sel_hi:[1,0]
    v_pk_fma_f32 v[42:43], v[228:229], v[26:27], v[42:43] op_sel_hi:[1,0,1]
    v_pk_mul_f32 v[44:45], v[150:151], v[24:25] op_sel_hi:[1,0]
    v_pk_fma_f32 v[44:45], v[230:231], v[26:27], v[44:45] op_sel_hi:[1,0,1]
    v_pk_mul_f32 v[46:47], v[164:165], v[24:25] op_sel_hi:[1,0]
    v_pk_fma_f32 v[46:47], v[244:245], v[26:27], v[46:47] op_sel_hi:[1,0,1]
    v_cvt_pk_bf16_f32 v60, v30, v31
    v_cvt_pk_bf16_f32 v61, v32, v33
    v_cvt_pk_bf16_f32 v62, v34, v35
    v_cvt_pk_bf16_f32 v63, v36, v37
    v_cvt_pk_bf16_f32 v64, v38, v39
    v_cvt_pk_bf16_f32 v65, v40, v41
    v_cvt_pk_bf16_f32 v66, v42, v43
    v_cvt_pk_bf16_f32 v67, v44, v45
    v_cvt_pk_bf16_f32 v68, v46, v47
    s_add_u32 s39, s38, 256
    buffer_store_dwordx4 v[60:63], v72, s[16:19], s39 offen sc1
    s_add_u32 s39, s38, 2304
    buffer_store_dwordx4 v[64:67], v72, s[16:19], s39 offen sc1
    s_add_u32 s39, s40, 256
    buffer_store_dword v68, v72, s[16:19], s39 offen sc1
    s_add_u32 s38, s38, 331776
    s_add_u32 s40, s40, 331776
    v_rcp_f32 v24, v171
    v_rcp_f32 v26, v251
    s_nop 0
    v_mul_f32 v28, v170, v24
    v_fmac_f32 v28, v250, v26
    v_add_f32 v28, 0x358637bd, v28
    v_rcp_f32 v28, v28
    s_nop 0
    v_mul_f32 v24, v24, v28
    v_mul_f32 v26, v26, v28
    v_pk_mul_f32 v[30:31], v[104:105], v[24:25] op_sel_hi:[1,0]
    v_pk_fma_f32 v[30:31], v[184:185], v[26:27], v[30:31] op_sel_hi:[1,0,1]
    v_pk_mul_f32 v[32:33], v[106:107], v[24:25] op_sel_hi:[1,0]
    v_pk_fma_f32 v[32:33], v[186:187], v[26:27], v[32:33] op_sel_hi:[1,0,1]
    v_pk_mul_f32 v[34:35], v[120:121], v[24:25] op_sel_hi:[1,0]
    v_pk_fma_f32 v[34:35], v[200:201], v[26:27], v[34:35] op_sel_hi:[1,0,1]
    v_pk_mul_f32 v[36:37], v[122:123], v[24:25] op_sel_hi:[1,0]
    v_pk_fma_f32 v[36:37], v[202:203], v[26:27], v[36:37] op_sel_hi:[1,0,1]
    v_pk_mul_f32 v[38:39], v[136:137], v[24:25] op_sel_hi:[1,0]
    v_pk_fma_f32 v[38:39], v[216:217], v[26:27], v[38:39] op_sel_hi:[1,0,1]
    v_pk_mul_f32 v[40:41], v[138:139], v[24:25] op_sel_hi:[1,0]
    v_pk_fma_f32 v[40:41], v[218:219], v[26:27], v[40:41] op_sel_hi:[1,0,1]
    v_pk_mul_f32 v[42:43], v[152:153], v[24:25] op_sel_hi:[1,0]
    v_pk_fma_f32 v[42:43], v[232:233], v[26:27], v[42:43] op_sel_hi:[1,0,1]
    v_pk_mul_f32 v[44:45], v[154:155], v[24:25] op_sel_hi:[1,0]
    v_pk_fma_f32 v[44:45], v[234:235], v[26:27], v[44:45] op_sel_hi:[1,0,1]
    v_pk_mul_f32 v[46:47], v[168:169], v[24:25] op_sel_hi:[1,0]
    v_pk_fma_f32 v[46:47], v[248:249], v[26:27], v[46:47] op_sel_hi:[1,0,1]
    v_cvt_pk_bf16_f32 v48, v30, v31
    v_cvt_pk_bf16_f32 v49, v32, v33
    v_cvt_pk_bf16_f32 v50, v34, v35
    v_cvt_pk_bf16_f32 v51, v36, v37
    v_cvt_pk_bf16_f32 v52, v38, v39
    v_cvt_pk_bf16_f32 v53, v40, v41
    v_cvt_pk_bf16_f32 v54, v42, v43
    v_cvt_pk_bf16_f32 v55, v44, v45
    v_cvt_pk_bf16_f32 v56, v46, v47
    s_add_u32 s39, s38, 0
    buffer_store_dwordx4 v[48:51], v72, s[16:19], s39 offen sc1
    s_add_u32 s39, s38, 2048
    buffer_store_dwordx4 v[52:55], v72, s[16:19], s39 offen sc1
    s_add_u32 s39, s40, 0
    buffer_store_dword v56, v72, s[16:19], s39 offen sc1
    v_rcp_f32 v24, v175
    v_rcp_f32 v26, v255
    s_nop 0
    v_mul_f32 v28, v174, v24
    v_fmac_f32 v28, v254, v26
    v_add_f32 v28, 0x358637bd, v28
    v_rcp_f32 v28, v28
    s_nop 0
    v_mul_f32 v24, v24, v28
    v_mul_f32 v26, v26, v28
    v_pk_mul_f32 v[30:31], v[108:109], v[24:25] op_sel_hi:[1,0]
    v_pk_fma_f32 v[30:31], v[188:189], v[26:27], v[30:31] op_sel_hi:[1,0,1]
    v_pk_mul_f32 v[32:33], v[110:111], v[24:25] op_sel_hi:[1,0]
    v_pk_fma_f32 v[32:33], v[190:191], v[26:27], v[32:33] op_sel_hi:[1,0,1]
    v_pk_mul_f32 v[34:35], v[124:125], v[24:25] op_sel_hi:[1,0]
    v_pk_fma_f32 v[34:35], v[204:205], v[26:27], v[34:35] op_sel_hi:[1,0,1]
    v_pk_mul_f32 v[36:37], v[126:127], v[24:25] op_sel_hi:[1,0]
    v_pk_fma_f32 v[36:37], v[206:207], v[26:27], v[36:37] op_sel_hi:[1,0,1]
    v_pk_mul_f32 v[38:39], v[140:141], v[24:25] op_sel_hi:[1,0]
    v_pk_fma_f32 v[38:39], v[220:221], v[26:27], v[38:39] op_sel_hi:[1,0,1]
    v_pk_mul_f32 v[40:41], v[142:143], v[24:25] op_sel_hi:[1,0]
    v_pk_fma_f32 v[40:41], v[222:223], v[26:27], v[40:41] op_sel_hi:[1,0,1]
    v_pk_mul_f32 v[42:43], v[156:157], v[24:25] op_sel_hi:[1,0]
    v_pk_fma_f32 v[42:43], v[236:237], v[26:27], v[42:43] op_sel_hi:[1,0,1]
    v_pk_mul_f32 v[44:45], v[158:159], v[24:25] op_sel_hi:[1,0]
    v_pk_fma_f32 v[44:45], v[238:239], v[26:27], v[44:45] op_sel_hi:[1,0,1]
    v_pk_mul_f32 v[46:47], v[172:173], v[24:25] op_sel_hi:[1,0]
    v_pk_fma_f32 v[46:47], v[252:253], v[26:27], v[46:47] op_sel_hi:[1,0,1]
    v_cvt_pk_bf16_f32 v60, v30, v31
    v_cvt_pk_bf16_f32 v61, v32, v33
    v_cvt_pk_bf16_f32 v62, v34, v35
    v_cvt_pk_bf16_f32 v63, v36, v37
    v_cvt_pk_bf16_f32 v64, v38, v39
    v_cvt_pk_bf16_f32 v65, v40, v41
    v_cvt_pk_bf16_f32 v66, v42, v43
    v_cvt_pk_bf16_f32 v67, v44, v45
    v_cvt_pk_bf16_f32 v68, v46, v47
    s_add_u32 s39, s38, 256
    buffer_store_dwordx4 v[60:63], v72, s[16:19], s39 offen sc1
    s_add_u32 s39, s38, 2304
    buffer_store_dwordx4 v[64:67], v72, s[16:19], s39 offen sc1
    s_add_u32 s39, s40, 256
    buffer_store_dword v68, v72, s[16:19], s39 offen sc1
    s_mov_b32 s90, 1
    s_mov_b32 s91, 4
    s_lshl_b32 s92, s32, 3
    s_add_u32 s92, s92, s33
    s_mov_b32 s93, s24
    s_add_u32 s94, s32, 40
    s_mov_b32 s95, 0
    s_mul_i32 s38, s92, 171
    s_lshr_b32 s38, s38, 10
    s_add_u32 s96, s38, 40
    s_mov_b32 s97, 8
    s_branch L_p2
L_p2:
    s_add_u32 s64, s70, 22806528
    s_addc_u32 s65, s71, 0
    v_mov_b32 v28, 0
    global_load_dword v29, v28, s[68:69] sc1
    s_lshl_b32 s38, s96, 7
    v_mov_b32 v24, s38
    global_load_dword v25, v24, s[64:65] sc1
    s_load_dwordx2 s[40:41], s[0:1], 24
    s_load_dwordx2 s[42:43], s[0:1], 56
    s_load_dwordx2 s[44:45], s[0:1], 72
    s_mul_i32 s5, s92, 171
    s_lshr_b32 s5, s5, 9
    s_mul_i32 s6, s5, 3
    s_sub_u32 s6, s92, s6
    v_and_b32 v1, 63, v0
    v_lshlrev_b32 v20, 4, v1
    s_mul_i32 s48, s93, 192
    s_cmp_eq_u32 s90, 1
    s_cselect_b64 s[50:51], -1, 0
    v_add_u32 v4, s48, v1
    v_mul_u32_u24 v5, 0xaab, v4
    v_lshrrev_b32 v5, 16, v5
    v_mul_u32_u24 v6, 24, v5
    v_sub_u32 v6, v4, v6
    v_bfe_u32 v7, v5, 1, 1
    v_bfe_u32 v4, v5, 3, 1
    v_lshlrev_b32 v4, 1, v4
    v_or_b32 v7, v7, v4
    v_lshrrev_b32 v4, 1, v6
    v_xor_b32 v4, v4, v7
    v_lshlrev_b32 v4, 5, v4
    v_and_b32 v6, 1, v6
    v_lshlrev_b32 v6, 4, v6
    v_add3_u32 v4, v4, v6, 0
    v_add_u32 v31, 4096, v4
    v_and_b32 v6, 16, v5
    v_bfe_u32 v7, v5, 3, 1
    v_lshl_add_u32 v6, v7, 2, v6
    v_and_b32 v7, 3, v5
    v_add_u32 v6, v6, v7
    v_bfe_u32 v7, v5, 2, 1
    v_lshl_add_u32 v6, v7, 3, v6
    v_lshrrev_b32 v7, 3, v5
    v_mul_u32_u24 v7, 18, v7
    v_and_b32 v30, 7, v5
    v_add_u32 v7, v7, v30
    v_cndmask_b32 v6, v6, v7, s[50:51]
    v_mul_u32_u24 v6, 0x480, v6
    v_add_u32 v17, v6, v31
    v_bfe_u32 v6, v5, 1, 2
    v_mul_u32_u24 v6, 72, v6
    v_lshrrev_b32 v7, 3, v5
    v_mul_u32_u24 v7, 18, v7
    v_add_u32 v6, v6, v7
    v_and_b32 v7, 1, v5
    v_add3_u32 v6, v6, v7, 16
    v_mul_u32_u24 v6, 0x480, v6
    v_add_u32 v14, v6, v31
    v_add_u32 v4, s48, v1
    v_add_u32 v4, 64, v4
    v_mul_u32_u24 v5, 0xaab, v4
    v_lshrrev_b32 v5, 16, v5
    v_mul_u32_u24 v6, 24, v5
    v_sub_u32 v6, v4, v6
    v_bfe_u32 v7, v5, 1, 1
    v_bfe_u32 v4, v5, 3, 1
    v_lshlrev_b32 v4, 1, v4
    v_or_b32 v7, v7, v4
    v_lshrrev_b32 v4, 1, v6
    v_xor_b32 v4, v4, v7
    v_lshlrev_b32 v4, 5, v4
    v_and_b32 v6, 1, v6
    v_lshlrev_b32 v6, 4, v6
    v_add3_u32 v4, v4, v6, 0
    v_add_u32 v31, 3072, v4
    v_and_b32 v6, 16, v5
    v_bfe_u32 v7, v5, 3, 1
    v_lshl_add_u32 v6, v7, 2, v6
    v_and_b32 v7, 3, v5
    v_add_u32 v6, v6, v7
    v_bfe_u32 v7, v5, 2, 1
    v_lshl_add_u32 v6, v7, 3, v6
    v_lshrrev_b32 v7, 3, v5
    v_mul_u32_u24 v7, 18, v7
    v_and_b32 v30, 7, v5
    v_add_u32 v7, v7, v30
    v_cndmask_b32 v6, v6, v7, s[50:51]
    v_mul_u32_u24 v6, 0x480, v6
    v_add_u32 v18, v6, v31
    v_bfe_u32 v6, v5, 1, 2
    v_mul_u32_u24 v6, 72, v6
    v_lshrrev_b32 v7, 3, v5
    v_mul_u32_u24 v7, 18, v7
    v_add_u32 v6, v6, v7
    v_and_b32 v7, 1, v5
    v_add3_u32 v6, v6, v7, 16
    v_mul_u32_u24 v6, 0x480, v6
    v_add_u32 v15, v6, v31
    v_add_u32 v4, s48, v1
    v_add_u32 v4, 128, v4
    v_mul_u32_u24 v5, 0xaab, v4
    v_lshrrev_b32 v5, 16, v5
    v_mul_u32_u24 v6, 24, v5
    v_sub_u32 v6, v4, v6
    v_bfe_u32 v7, v5, 1, 1
    v_bfe_u32 v4, v5, 3, 1
    v_lshlrev_b32 v4, 1, v4
    v_or_b32 v7, v7, v4
    v_lshrrev_b32 v4, 1, v6
    v_xor_b32 v4, v4, v7
    v_lshlrev_b32 v4, 5, v4
    v_and_b32 v6, 1, v6
    v_lshlrev_b32 v6, 4, v6
    v_add3_u32 v4, v4, v6, 0
    v_add_u32 v31, 2048, v4
    v_and_b32 v6, 16, v5
    v_bfe_u32 v7, v5, 3, 1
    v_lshl_add_u32 v6, v7, 2, v6
    v_and_b32 v7, 3, v5
    v_add_u32 v6, v6, v7
    v_bfe_u32 v7, v5, 2, 1
    v_lshl_add_u32 v6, v7, 3, v6
    v_lshrrev_b32 v7, 3, v5
    v_mul_u32_u24 v7, 18, v7
    v_and_b32 v30, 7, v5
    v_add_u32 v7, v7, v30
    v_cndmask_b32 v6, v6, v7, s[50:51]
    v_mul_u32_u24 v6, 0x480, v6
    v_add_u32 v19, v6, v31
    v_bfe_u32 v6, v5, 1, 2
    v_mul_u32_u24 v6, 72, v6
    v_lshrrev_b32 v7, 3, v5
    v_mul_u32_u24 v7, 18, v7
    v_add_u32 v6, v6, v7
    v_and_b32 v7, 1, v5
    v_add3_u32 v6, v6, v7, 16
    v_mul_u32_u24 v6, 0x480, v6
    v_add_u32 v16, v6, v31
    v_lshrrev_b32 v2, 4, v1
    v_and_b32 v3, 15, v1
    v_lshrrev_b32 v4, 2, v3
    v_and_b32 v5, 3, v3
    v_lshlrev_b32 v6, 3, v2
    v_add_u32 v6, v6, v4
    v_mul_u32_u24 v6, 0x180, v6
    v_lshlrev_b32 v5, 3, v5
    v_add_u32 v6, v6, v5
    v_lshrrev_b32 v4, 1, v4
    v_and_b32 v5, 1, v2
    v_lshlrev_b32 v5, 1, v5
    v_or_b32 v4, v4, v5
    v_xor_b32 v5, 0, v4
    v_lshlrev_b32 v5, 5, v5
    v_add_u32 v8, v5, v6
    v_xor_b32 v5, 1, v4
    v_lshlrev_b32 v5, 5, v5
    v_add_u32 v9, v5, v6
    v_xor_b32 v5, 2, v4
    v_lshlrev_b32 v5, 5, v5
    v_add_u32 v10, v5, v6
    v_xor_b32 v5, 3, v4
    v_lshlrev_b32 v5, 5, v5
    v_add_u32 v11, v5, v6
    v_lshrrev_b32 v4, 1, v2
    v_lshlrev_b32 v4, 10, v4
    v_and_b32 v5, 1, v2
    v_lshlrev_b32 v5, 9, v5
    v_lshlrev_b32 v6, 4, v3
    v_add3_u32 v12, v4, v5, v6
    s_waitcnt lgkmcnt(0)
    s_cmp_eq_u32 s90, 1
    s_cselect_b32 s4, s40, s42
    s_cselect_b32 s7, s41, s43
    s_mov_b32 s62, 5312512
    s_cselect_b32 s62, 667648, s62
    s_mov_b32 s31, 36864
    s_cselect_b32 s31, 9216, s31
    s_mov_b32 s32, 36864
    s_cselect_b32 s32, 73728, s32
    s_mov_b32 s46, 110592
    s_cselect_b32 s46, 73728, s46
    s_mov_b32 s47, 110592
    s_cselect_b32 s47, 73728, s47
    s_mov_b32 s52, 2048
    s_cselect_b32 s52, 2048, s52
    s_mov_b32 s53, 2048
    s_cselect_b32 s53, 2048, s53
    s_mov_b32 s54, 6144
    s_cselect_b32 s54, 2048, s54
    s_mov_b32 s55, 6144
    s_cselect_b32 s55, 2048, s55
    s_mov_b32 s60, 4293787648
    s_cselect_b32 s60, 0, s60
    s_mov_b32 s61, 4294901760
    s_cselect_b32 s61, 0, s61
    s_mov_b32 s36, 3
    s_cselect_b32 s37, 1, 99
    s_cselect_b32 s67, 99, 1
    s_cselect_b32 s66, 1, 99
    s_mul_i32 s63, s91, 36
    s_cselect_b32 s63, 144, s63
    s_mul_i32 s56, s63, 36864
    s_cselect_b32 s30, 0, s56
    s_mul_i32 s57, s6, 384
    s_add_u32 s24, s4, s57
    s_addc_u32 s25, s7, 0
    s_sub_u32 s24, s24, 4096
    s_subb_u32 s25, s25, 0
    s_sub_u32 s26, s62, s57
    s_mov_b32 s27, 0x20000
    s_mov_b32 s16, s70
    s_mov_b32 s17, s71
    s_mov_b32 s18, 21233664
    s_mov_b32 s19, 0x20000
    s_lshl_b32 s57, s5, 2
    s_add_u32 s57, s57, s93
    s_mul_i32 s48, s57, 162
    s_add_u32 s48, s48, s63
    s_lshl_b32 s33, s48, 11
    s_mul_i32 s29, s93, 3072
    s_waitcnt vmcnt(0)
    s_barrier
    s_cmp_eq_u32 s93, 0
    s_cbranch_scc0 L_p2_zr_ok
    v_readfirstlane_b32 s38, v29
    s_nop 1
    s_cmp_ge_u32 s38, 273
    s_cbranch_scc1 L_p2_zr_ok
    v_mov_b32 v25, 0
    v_mov_b32 v2, 0
    s_mov_b32 s39, 0
L_p2_zr:
    global_load_dword v3, v2, s[68:69] sc1
    s_waitcnt vmcnt(0)
    v_readfirstlane_b32 s38, v3
    s_add_u32 s39, s39, 1
    s_cmp_ge_u32 s38, 273
    s_cbranch_scc1 L_p2_zr_ok
    s_cmp_gt_u32 s39, 200000
    s_cbranch_scc1 L_p2_zr_ok
    s_sleep 6
    s_branch L_p2_zr
L_p2_zr_ok:
    s_cmp_eq_u32 s93, 0
    s_cbranch_scc0 L_p2_sig1
    s_lshl_b32 s38, s94, 7
    v_mov_b32 v4, s38
    v_mov_b32 v5, 1
    v_cmp_eq_u32 vcc, 0, v0
    s_and_saveexec_b64 s[48:49], vcc
    global_atomic_add v4, v5, s[64:65] sc1
    s_mov_b64 exec, s[48:49]
L_p2_sig1:
    s_cmp_ge_u32 s92, 48
    s_cbranch_scc1 L_gate
    s_add_u32 m0, s29, 0
    s_nop 0
    buffer_load_dwordx4 v17, s[24:27], s30 offen offset:0 lds
    buffer_load_dwordx4 v18, s[24:27], s30 offen offset:1024 lds
    buffer_load_dwordx4 v19, s[24:27], s30 offen offset:2048 lds
    s_add_u32 s30, s30, s31
    s_add_u32 m0, s29, 12288
    s_nop 0
    buffer_load_dwordx4 v17, s[24:27], s30 offen offset:0 lds
    buffer_load_dwordx4 v18, s[24:27], s30 offen offset:1024 lds
    buffer_load_dwordx4 v19, s[24:27], s30 offen offset:2048 lds
    s_add_u32 s30, s30, s32
    s_add_u32 m0, s29, 24576
    s_nop 0
    buffer_load_dwordx4 v17, s[24:27], s30 offen offset:0 lds
    buffer_load_dwordx4 v18, s[24:27], s30 offen offset:1024 lds
    buffer_load_dwordx4 v19, s[24:27], s30 offen offset:2048 lds
    s_add_u32 s30, s30, s31
    s_add_u32 m0, s29, 36864
    s_nop 0
    buffer_load_dwordx4 v17, s[24:27], s30 offen offset:0 lds
    buffer_load_dwordx4 v18, s[24:27], s30 offen offset:1024 lds
    buffer_load_dwordx4 v19, s[24:27], s30 offen offset:2048 lds
    s_add_u32 s30, s30, s46
    s_cmp_eq_u32 s93, 0
    s_cbranch_scc0 L_p2_poll1_ok
    v_readfirstlane_b32 s38, v25
    s_nop 1
    s_cmp_ge_u32 s38, s97
    s_cbranch_scc1 L_p2_poll1_ok
    s_lshl_b32 s38, s96, 7
    v_mov_b32 v2, s38
    s_mov_b32 s39, 0
L_p2_poll1:
    global_load_dword v3, v2, s[64:65] sc1
    s_waitcnt vmcnt(0)
    v_readfirstlane_b32 s38, v3
    s_add_u32 s39, s39, 1
    s_cmp_ge_u32 s38, s97
    s_cbranch_scc1 L_p2_poll1_ok
    s_cmp_gt_u32 s39, 200000
    s_cbranch_scc1 L_p2_poll1_ok
    s_sleep 6
    s_branch L_p2_poll1
L_p2_poll1_ok:
    s_barrier
    s_lshl_b32 s38, s95, 7
    v_mov_b32 v7, s38
    buffer_load_dwordx4 a[0:3], v12, s[16:19], s33 offen sc1
    buffer_load_dwordx4 a[4:7], v12, s[16:19], s33 offen offset:256 sc1
    s_add_u32 s33, s33, s52
    buffer_load_dwordx4 a[8:11], v12, s[16:19], s33 offen sc1
    buffer_load_dwordx4 a[12:15], v12, s[16:19], s33 offen offset:256 sc1
    s_add_u32 s33, s33, s53
    buffer_load_dwordx4 a[16:19], v12, s[16:19], s33 offen sc1
    buffer_load_dwordx4 a[20:23], v12, s[16:19], s33 offen offset:256 sc1
    s_add_u32 s33, s33, s52
    buffer_load_dwordx4 a[24:27], v12, s[16:19], s33 offen sc1
    buffer_load_dwordx4 a[28:31], v12, s[16:19], s33 offen offset:256 sc1
    s_add_u32 s33, s33, s54
    v_mov_b32 v64, 0
    v_mov_b32 v65, 0
    v_mov_b32 v66, 0
    v_mov_b32 v67, 0
    v_mov_b32 v68, 0
    v_mov_b32 v69, 0
    v_mov_b32 v70, 0
    v_mov_b32 v71, 0
    v_mov_b32 v72, 0
    v_mov_b32 v73, 0
    v_mov_b32 v74, 0
    v_mov_b32 v75, 0
    v_mov_b32 v76, 0
    v_mov_b32 v77, 0
    v_mov_b32 v78, 0
    v_mov_b32 v79, 0
    v_mov_b32 v80, 0
    v_mov_b32 v81, 0
    v_mov_b32 v82, 0
    v_mov_b32 v83, 0
    v_mov_b32 v84, 0
    v_mov_b32 v85, 0
    v_mov_b32 v86, 0
    v_mov_b32 v87, 0
    v_mov_b32 v88, 0
    v_mov_b32 v89, 0
    v_mov_b32 v90, 0
    v_mov_b32 v91, 0
    v_mov_b32 v92, 0
    v_mov_b32 v93, 0
    v_mov_b32 v94, 0
    v_mov_b32 v95, 0
    v_mov_b32 v96, 0
    v_mov_b32 v97, 0
    v_mov_b32 v98, 0
    v_mov_b32 v99, 0
    v_mov_b32 v100, 0
    v_mov_b32 v101, 0
    v_mov_b32 v102, 0
    v_mov_b32 v103, 0
    v_mov_b32 v104, 0
    v_mov_b32 v105, 0
    v_mov_b32 v106, 0
    v_mov_b32 v107, 0
    v_mov_b32 v108, 0
    v_mov_b32 v109, 0
    v_mov_b32 v110, 0
    v_mov_b32 v111, 0
    v_mov_b32 v112, 0
    v_mov_b32 v113, 0
    v_mov_b32 v114, 0
    v_mov_b32 v115, 0
    v_mov_b32 v116, 0
    v_mov_b32 v117, 0
    v_mov_b32 v118, 0
    v_mov_b32 v119, 0
    v_mov_b32 v120, 0
    v_mov_b32 v121, 0
    v_mov_b32 v122, 0
    v_mov_b32 v123, 0
    v_mov_b32 v124, 0
    v_mov_b32 v125, 0
    v_mov_b32 v126, 0
    v_mov_b32 v127, 0
    v_mov_b32 v128, 0
    v_mov_b32 v129, 0
    v_mov_b32 v130, 0
    v_mov_b32 v131, 0
    v_mov_b32 v132, 0
    v_mov_b32 v133, 0
    v_mov_b32 v134, 0
    v_mov_b32 v135, 0
    v_mov_b32 v136, 0
    v_mov_b32 v137, 0
    v_mov_b32 v138, 0
    v_mov_b32 v139, 0
    v_mov_b32 v140, 0
    v_mov_b32 v141, 0
    v_mov_b32 v142, 0
    v_mov_b32 v143, 0
    v_mov_b32 v144, 0
    v_mov_b32 v145, 0
    v_mov_b32 v146, 0
    v_mov_b32 v147, 0
    v_mov_b32 v148, 0
    v_mov_b32 v149, 0
    v_mov_b32 v150, 0
    v_mov_b32 v151, 0
    v_mov_b32 v152, 0
    v_mov_b32 v153, 0
    v_mov_b32 v154, 0
    v_mov_b32 v155, 0
    v_mov_b32 v156, 0
    v_mov_b32 v157, 0
    v_mov_b32 v158, 0
    v_mov_b32 v159, 0
    s_waitcnt vmcnt(4)
    s_barrier
    s_branch L_p2c
L_p2b:
    s_waitcnt vmcnt(0)
    s_barrier
    s_cmp_eq_u32 s93, 0
    s_cbranch_scc0 L_p2_sig1b
    s_lshl_b32 s38, s94, 7
    v_mov_b32 v4, s38
    v_mov_b32 v5, 1
    v_cmp_eq_u32 vcc, 0, v0
    s_and_saveexec_b64 s[48:49], vcc
    global_atomic_add v4, v5, s[64:65] sc1
    s_mov_b64 exec, s[48:49]
L_p2_sig1b:
L_p2c:
    ds_read_b64_tr_b16 a[96:97], v8 offset:0
    ds_read_b64_tr_b16 a[98:99], v8 offset:1536
    ds_read_b64_tr_b16 a[100:101], v9 offset:0
    ds_read_b64_tr_b16 a[102:103], v9 offset:1536
    ds_read_b64_tr_b16 a[104:105], v10 offset:0
    ds_read_b64_tr_b16 a[106:107], v10 offset:1536
    ds_read_b64_tr_b16 a[108:109], v11 offset:0
    ds_read_b64_tr_b16 a[110:111], v11 offset:1536
    ds_read_b64_tr_b16 a[112:113], v8 offset:128
    ds_read_b64_tr_b16 a[114:115], v8 offset:1664
    ds_read_b64_tr_b16 a[116:117], v9 offset:128
    ds_read_b64_tr_b16 a[118:119], v9 offset:1664
    s_mov_b32 s35, 0
L_p2_loop:
    s_waitcnt vmcnt(10)
    s_barrier
    s_cmp_eq_u32 s35, s66
    s_cbranch_scc0 L_p2_nosw
    v_mov_b32 v17, v14
    v_mov_b32 v18, v15
    v_mov_b32 v19, v16
    s_mov_b32 s30, 0
    s_mov_b32 s31, 331776
    s_mov_b32 s46, 331776
    s_mov_b32 s47, 331776
    s_mov_b32 s32, 1073741824
    s_mov_b32 s53, 0x40000000
L_p2_nosw:
    s_nop 0
    s_waitcnt lgkmcnt(8)
    v_mfma_f32_16x16x32_bf16 v[64:67], a[96:99], a[0:3], v[64:67]
    ds_read_b64_tr_b16 a[120:121], v10 offset:128
    v_mfma_f32_16x16x32_bf16 v[68:71], a[96:99], a[4:7], v[68:71]
    ds_read_b64_tr_b16 a[122:123], v10 offset:1664
    v_mfma_f32_16x16x32_bf16 v[72:75], a[100:103], a[0:3], v[72:75]
    ds_read_b64_tr_b16 a[124:125], v11 offset:128
    v_mfma_f32_16x16x32_bf16 v[76:79], a[100:103], a[4:7], v[76:79]
    buffer_load_dwordx4 a[32:35], v12, s[16:19], s33 offen sc1
    ds_read_b64_tr_b16 a[126:127], v11 offset:1664
    s_waitcnt lgkmcnt(8)
    v_mfma_f32_16x16x32_bf16 v[80:83], a[104:107], a[0:3], v[80:83]
    ds_read_b64_tr_b16 a[128:129], v8 offset:256
    v_mfma_f32_16x16x32_bf16 v[84:87], a[104:107], a[4:7], v[84:87]
    buffer_load_dwordx4 a[36:39], v12, s[16:19], s33 offen offset:256 sc1
    ds_read_b64_tr_b16 a[130:131], v8 offset:1792
    v_mfma_f32_16x16x32_bf16 v[88:91], a[108:111], a[0:3], v[88:91]
    ds_read_b64_tr_b16 a[132:133], v9 offset:256
    v_mfma_f32_16x16x32_bf16 v[92:95], a[108:111], a[4:7], v[92:95]
    ds_read_b64_tr_b16 a[134:135], v9 offset:1792
    s_waitcnt lgkmcnt(8)
    v_mfma_f32_16x16x32_bf16 v[96:99], a[112:115], a[0:3], v[96:99]
    s_add_u32 s33, s33, s52
    s_add_u32 m0, s29, 49152
    ds_read_b64_tr_b16 a[136:137], v10 offset:256
    v_mfma_f32_16x16x32_bf16 v[100:103], a[112:115], a[4:7], v[100:103]
    ds_read_b64_tr_b16 a[138:139], v10 offset:1792
    v_mfma_f32_16x16x32_bf16 v[104:107], a[116:119], a[0:3], v[104:107]
    ds_read_b64_tr_b16 a[140:141], v11 offset:256
    v_mfma_f32_16x16x32_bf16 v[108:111], a[116:119], a[4:7], v[108:111]
    buffer_load_dwordx4 v17, s[24:27], s30 offen offset:0 lds
    ds_read_b64_tr_b16 a[142:143], v11 offset:1792
    s_waitcnt lgkmcnt(8)
    v_mfma_f32_16x16x32_bf16 v[112:115], a[120:123], a[0:3], v[112:115]
    ds_read_b64_tr_b16 a[96:97], v8 offset:12288
    v_mfma_f32_16x16x32_bf16 v[116:119], a[120:123], a[4:7], v[116:119]
    ds_read_b64_tr_b16 a[98:99], v8 offset:13824
    v_mfma_f32_16x16x32_bf16 v[120:123], a[124:127], a[0:3], v[120:123]
    buffer_load_dwordx4 v18, s[24:27], s30 offen offset:1024 lds
    ds_read_b64_tr_b16 a[100:101], v9 offset:12288
    v_mfma_f32_16x16x32_bf16 v[124:127], a[124:127], a[4:7], v[124:127]
    ds_read_b64_tr_b16 a[102:103], v9 offset:13824
    s_waitcnt lgkmcnt(8)
    v_mfma_f32_16x16x32_bf16 v[128:131], a[128:131], a[0:3], v[128:131]
    ds_read_b64_tr_b16 a[104:105], v10 offset:12288
    v_mfma_f32_16x16x32_bf16 v[132:135], a[128:131], a[4:7], v[132:135]
    buffer_load_dwordx4 v19, s[24:27], s30 offen offset:2048 lds
    ds_read_b64_tr_b16 a[106:107], v10 offset:13824
    v_mfma_f32_16x16x32_bf16 v[136:139], a[132:135], a[0:3], v[136:139]
    ds_read_b64_tr_b16 a[108:109], v11 offset:12288
    v_mfma_f32_16x16x32_bf16 v[140:143], a[132:135], a[4:7], v[140:143]
    ds_read_b64_tr_b16 a[110:111], v11 offset:13824
    s_waitcnt lgkmcnt(8)
    v_mfma_f32_16x16x32_bf16 v[144:147], a[136:139], a[0:3], v[144:147]
    s_add_u32 s30, s30, s31
    ds_read_b64_tr_b16 a[112:113], v8 offset:12416
    v_mfma_f32_16x16x32_bf16 v[148:151], a[136:139], a[4:7], v[148:151]
    ds_read_b64_tr_b16 a[114:115], v8 offset:13952
    v_mfma_f32_16x16x32_bf16 v[152:155], a[140:143], a[0:3], v[152:155]
    ds_read_b64_tr_b16 a[116:117], v9 offset:12416
    v_mfma_f32_16x16x32_bf16 v[156:159], a[140:143], a[4:7], v[156:159]
    ds_read_b64_tr_b16 a[118:119], v9 offset:13952
    s_waitcnt vmcnt(10)
    s_barrier
    s_waitcnt lgkmcnt(8)
    v_mfma_f32_16x16x32_bf16 v[64:67], a[96:99], a[8:11], v[64:67]
    ds_read_b64_tr_b16 a[120:121], v10 offset:12416
    v_mfma_f32_16x16x32_bf16 v[68:71], a[96:99], a[12:15], v[68:71]
    ds_read_b64_tr_b16 a[122:123], v10 offset:13952
    v_mfma_f32_16x16x32_bf16 v[72:75], a[100:103], a[8:11], v[72:75]
    ds_read_b64_tr_b16 a[124:125], v11 offset:12416
    v_mfma_f32_16x16x32_bf16 v[76:79], a[100:103], a[12:15], v[76:79]
    buffer_load_dwordx4 a[40:43], v12, s[16:19], s33 offen sc1
    ds_read_b64_tr_b16 a[126:127], v11 offset:13952
    s_waitcnt lgkmcnt(8)
    v_mfma_f32_16x16x32_bf16 v[80:83], a[104:107], a[8:11], v[80:83]
    ds_read_b64_tr_b16 a[128:129], v8 offset:12544
    v_mfma_f32_16x16x32_bf16 v[84:87], a[104:107], a[12:15], v[84:87]
    buffer_load_dwordx4 a[44:47], v12, s[16:19], s33 offen offset:256 sc1
    ds_read_b64_tr_b16 a[130:131], v8 offset:14080
    v_mfma_f32_16x16x32_bf16 v[88:91], a[108:111], a[8:11], v[88:91]
    ds_read_b64_tr_b16 a[132:133], v9 offset:12544
    v_mfma_f32_16x16x32_bf16 v[92:95], a[108:111], a[12:15], v[92:95]
    ds_read_b64_tr_b16 a[134:135], v9 offset:14080
    s_waitcnt lgkmcnt(8)
    v_mfma_f32_16x16x32_bf16 v[96:99], a[112:115], a[8:11], v[96:99]
    s_add_u32 s33, s33, s53
    s_add_u32 m0, s29, 61440
    ds_read_b64_tr_b16 a[136:137], v10 offset:12544
    v_mfma_f32_16x16x32_bf16 v[100:103], a[112:115], a[12:15], v[100:103]
    ds_read_b64_tr_b16 a[138:139], v10 offset:14080
    v_mfma_f32_16x16x32_bf16 v[104:107], a[116:119], a[8:11], v[104:107]
    ds_read_b64_tr_b16 a[140:141], v11 offset:12544
    v_mfma_f32_16x16x32_bf16 v[108:111], a[116:119], a[12:15], v[108:111]
    buffer_load_dwordx4 v17, s[24:27], s30 offen offset:0 lds
    ds_read_b64_tr_b16 a[142:143], v11 offset:14080
    s_waitcnt lgkmcnt(8)
    v_mfma_f32_16x16x32_bf16 v[112:115], a[120:123], a[8:11], v[112:115]
    ds_read_b64_tr_b16 a[96:97], v8 offset:24576
    v_mfma_f32_16x16x32_bf16 v[116:119], a[120:123], a[12:15], v[116:119]
    ds_read_b64_tr_b16 a[98:99], v8 offset:26112
    v_mfma_f32_16x16x32_bf16 v[120:123], a[124:127], a[8:11], v[120:123]
    buffer_load_dwordx4 v18, s[24:27], s30 offen offset:1024 lds
    ds_read_b64_tr_b16 a[100:101], v9 offset:24576
    v_mfma_f32_16x16x32_bf16 v[124:127], a[124:127], a[12:15], v[124:127]
    ds_read_b64_tr_b16 a[102:103], v9 offset:26112
    s_waitcnt lgkmcnt(8)
    v_mfma_f32_16x16x32_bf16 v[128:131], a[128:131], a[8:11], v[128:131]
    ds_read_b64_tr_b16 a[104:105], v10 offset:24576
    v_mfma_f32_16x16x32_bf16 v[132:135], a[128:131], a[12:15], v[132:135]
    buffer_load_dwordx4 v19, s[24:27], s30 offen offset:2048 lds
    ds_read_b64_tr_b16 a[106:107], v10 offset:26112
    v_mfma_f32_16x16x32_bf16 v[136:139], a[132:135], a[8:11], v[136:139]
    ds_read_b64_tr_b16 a[108:109], v11 offset:24576
    v_mfma_f32_16x16x32_bf16 v[140:143], a[132:135], a[12:15], v[140:143]
    ds_read_b64_tr_b16 a[110:111], v11 offset:26112
    s_waitcnt lgkmcnt(8)
    v_mfma_f32_16x16x32_bf16 v[144:147], a[136:139], a[8:11], v[144:147]
    s_add_u32 s30, s30, s32
    ds_read_b64_tr_b16 a[112:113], v8 offset:24704
    v_mfma_f32_16x16x32_bf16 v[148:151], a[136:139], a[12:15], v[148:151]
    ds_read_b64_tr_b16 a[114:115], v8 offset:26240
    v_mfma_f32_16x16x32_bf16 v[152:155], a[140:143], a[8:11], v[152:155]
    ds_read_b64_tr_b16 a[116:117], v9 offset:24704
    v_mfma_f32_16x16x32_bf16 v[156:159], a[140:143], a[12:15], v[156:159]
    ds_read_b64_tr_b16 a[118:119], v9 offset:26240
    s_waitcnt vmcnt(10)
    s_barrier
    s_waitcnt lgkmcnt(8)
    v_mfma_f32_16x16x32_bf16 v[64:67], a[96:99], a[16:19], v[64:67]
    ds_read_b64_tr_b16 a[120:121], v10 offset:24704
    v_mfma_f32_16x16x32_bf16 v[68:71], a[96:99], a[20:23], v[68:71]
    ds_read_b64_tr_b16 a[122:123], v10 offset:26240
    v_mfma_f32_16x16x32_bf16 v[72:75], a[100:103], a[16:19], v[72:75]
    ds_read_b64_tr_b16 a[124:125], v11 offset:24704
    v_mfma_f32_16x16x32_bf16 v[76:79], a[100:103], a[20:23], v[76:79]
    buffer_load_dwordx4 a[48:51], v12, s[16:19], s33 offen sc1
    ds_read_b64_tr_b16 a[126:127], v11 offset:26240
    s_waitcnt lgkmcnt(8)
    v_mfma_f32_16x16x32_bf16 v[80:83], a[104:107], a[16:19], v[80:83]
    ds_read_b64_tr_b16 a[128:129], v8 offset:24832
    v_mfma_f32_16x16x32_bf16 v[84:87], a[104:107], a[20:23], v[84:87]
    buffer_load_dwordx4 a[52:55], v12, s[16:19], s33 offen offset:256 sc1
    ds_read_b64_tr_b16 a[130:131], v8 offset:26368
    v_mfma_f32_16x16x32_bf16 v[88:91], a[108:111], a[16:19], v[88:91]
    ds_read_b64_tr_b16 a[132:133], v9 offset:24832
    v_mfma_f32_16x16x32_bf16 v[92:95], a[108:111], a[20:23], v[92:95]
    ds_read_b64_tr_b16 a[134:135], v9 offset:26368
    s_waitcnt lgkmcnt(8)
    v_mfma_f32_16x16x32_bf16 v[96:99], a[112:115], a[16:19], v[96:99]
    s_add_u32 s33, s33, s52
    s_add_u32 m0, s29, 0
    ds_read_b64_tr_b16 a[136:137], v10 offset:24832
    v_mfma_f32_16x16x32_bf16 v[100:103], a[112:115], a[20:23], v[100:103]
    ds_read_b64_tr_b16 a[138:139], v10 offset:26368
    v_mfma_f32_16x16x32_bf16 v[104:107], a[116:119], a[16:19], v[104:107]
    ds_read_b64_tr_b16 a[140:141], v11 offset:24832
    v_mfma_f32_16x16x32_bf16 v[108:111], a[116:119], a[20:23], v[108:111]
    buffer_load_dwordx4 v17, s[24:27], s30 offen offset:0 lds
    ds_read_b64_tr_b16 a[142:143], v11 offset:26368
    s_waitcnt lgkmcnt(8)
    v_mfma_f32_16x16x32_bf16 v[112:115], a[120:123], a[16:19], v[112:115]
    ds_read_b64_tr_b16 a[96:97], v8 offset:36864
    v_mfma_f32_16x16x32_bf16 v[116:119], a[120:123], a[20:23], v[116:119]
    ds_read_b64_tr_b16 a[98:99], v8 offset:38400
    v_mfma_f32_16x16x32_bf16 v[120:123], a[124:127], a[16:19], v[120:123]
    buffer_load_dwordx4 v18, s[24:27], s30 offen offset:1024 lds
    ds_read_b64_tr_b16 a[100:101], v9 offset:36864
    v_mfma_f32_16x16x32_bf16 v[124:127], a[124:127], a[20:23], v[124:127]
    ds_read_b64_tr_b16 a[102:103], v9 offset:38400
    s_waitcnt lgkmcnt(8)
    v_mfma_f32_16x16x32_bf16 v[128:131], a[128:131], a[16:19], v[128:131]
    ds_read_b64_tr_b16 a[104:105], v10 offset:36864
    v_mfma_f32_16x16x32_bf16 v[132:135], a[128:131], a[20:23], v[132:135]
    buffer_load_dwordx4 v19, s[24:27], s30 offen offset:2048 lds
    ds_read_b64_tr_b16 a[106:107], v10 offset:38400
    v_mfma_f32_16x16x32_bf16 v[136:139], a[132:135], a[16:19], v[136:139]
    ds_read_b64_tr_b16 a[108:109], v11 offset:36864
    v_mfma_f32_16x16x32_bf16 v[140:143], a[132:135], a[20:23], v[140:143]
    ds_read_b64_tr_b16 a[110:111], v11 offset:38400
    s_waitcnt lgkmcnt(8)
    v_mfma_f32_16x16x32_bf16 v[144:147], a[136:139], a[16:19], v[144:147]
    s_add_u32 s30, s30, s31
    ds_read_b64_tr_b16 a[112:113], v8 offset:36992
    v_mfma_f32_16x16x32_bf16 v[148:151], a[136:139], a[20:23], v[148:151]
    ds_read_b64_tr_b16 a[114:115], v8 offset:38528
    v_mfma_f32_16x16x32_bf16 v[152:155], a[140:143], a[16:19], v[152:155]
    ds_read_b64_tr_b16 a[116:117], v9 offset:36992
    v_mfma_f32_16x16x32_bf16 v[156:159], a[140:143], a[20:23], v[156:159]
    ds_read_b64_tr_b16 a[118:119], v9 offset:38528
    s_waitcnt vmcnt(10)
    s_barrier
    s_waitcnt lgkmcnt(8)
    v_mfma_f32_16x16x32_bf16 v[64:67], a[96:99], a[24:27], v[64:67]
    ds_read_b64_tr_b16 a[120:121], v10 offset:36992
    v_mfma_f32_16x16x32_bf16 v[68:71], a[96:99], a[28:31], v[68:71]
    ds_read_b64_tr_b16 a[122:123], v10 offset:38528
    v_mfma_f32_16x16x32_bf16 v[72:75], a[100:103], a[24:27], v[72:75]
    ds_read_b64_tr_b16 a[124:125], v11 offset:36992
    v_mfma_f32_16x16x32_bf16 v[76:79], a[100:103], a[28:31], v[76:79]
    buffer_load_dwordx4 a[56:59], v12, s[16:19], s33 offen sc1
    ds_read_b64_tr_b16 a[126:127], v11 offset:38528
    s_waitcnt lgkmcnt(8)
    v_mfma_f32_16x16x32_bf16 v[80:83], a[104:107], a[24:27], v[80:83]
    ds_read_b64_tr_b16 a[128:129], v8 offset:37120
    v_mfma_f32_16x16x32_bf16 v[84:87], a[104:107], a[28:31], v[84:87]
    buffer_load_dwordx4 a[60:63], v12, s[16:19], s33 offen offset:256 sc1
    ds_read_b64_tr_b16 a[130:131], v8 offset:38656
    v_mfma_f32_16x16x32_bf16 v[88:91], a[108:111], a[24:27], v[88:91]
    ds_read_b64_tr_b16 a[132:133], v9 offset:37120
    v_mfma_f32_16x16x32_bf16 v[92:95], a[108:111], a[28:31], v[92:95]
    ds_read_b64_tr_b16 a[134:135], v9 offset:38656
    s_waitcnt lgkmcnt(8)
    v_mfma_f32_16x16x32_bf16 v[96:99], a[112:115], a[24:27], v[96:99]
    s_add_u32 s33, s33, s54
    s_add_u32 m0, s29, 12288
    ds_read_b64_tr_b16 a[136:137], v10 offset:37120
    v_mfma_f32_16x16x32_bf16 v[100:103], a[112:115], a[28:31], v[100:103]
    ds_read_b64_tr_b16 a[138:139], v10 offset:38656
    v_mfma_f32_16x16x32_bf16 v[104:107], a[116:119], a[24:27], v[104:107]
    ds_read_b64_tr_b16 a[140:141], v11 offset:37120
    v_mfma_f32_16x16x32_bf16 v[108:111], a[116:119], a[28:31], v[108:111]
    buffer_load_dwordx4 v17, s[24:27], s30 offen offset:0 lds
    ds_read_b64_tr_b16 a[142:143], v11 offset:38656
    s_waitcnt lgkmcnt(8)
    v_mfma_f32_16x16x32_bf16 v[112:115], a[120:123], a[24:27], v[112:115]
    ds_read_b64_tr_b16 a[96:97], v8 offset:49152
    v_mfma_f32_16x16x32_bf16 v[116:119], a[120:123], a[28:31], v[116:119]
    ds_read_b64_tr_b16 a[98:99], v8 offset:50688
    v_mfma_f32_16x16x32_bf16 v[120:123], a[124:127], a[24:27], v[120:123]
    buffer_load_dwordx4 v18, s[24:27], s30 offen offset:1024 lds
    ds_read_b64_tr_b16 a[100:101], v9 offset:49152
    v_mfma_f32_16x16x32_bf16 v[124:127], a[124:127], a[28:31], v[124:127]
    ds_read_b64_tr_b16 a[102:103], v9 offset:50688
    s_waitcnt lgkmcnt(8)
    v_mfma_f32_16x16x32_bf16 v[128:131], a[128:131], a[24:27], v[128:131]
    ds_read_b64_tr_b16 a[104:105], v10 offset:49152
    v_mfma_f32_16x16x32_bf16 v[132:135], a[128:131], a[28:31], v[132:135]
    buffer_load_dwordx4 v19, s[24:27], s30 offen offset:2048 lds
    ds_read_b64_tr_b16 a[106:107], v10 offset:50688
    v_mfma_f32_16x16x32_bf16 v[136:139], a[132:135], a[24:27], v[136:139]
    ds_read_b64_tr_b16 a[108:109], v11 offset:49152
    v_mfma_f32_16x16x32_bf16 v[140:143], a[132:135], a[28:31], v[140:143]
    ds_read_b64_tr_b16 a[110:111], v11 offset:50688
    s_waitcnt lgkmcnt(8)
    v_mfma_f32_16x16x32_bf16 v[144:147], a[136:139], a[24:27], v[144:147]
    s_add_u32 s30, s30, s46
    ds_read_b64_tr_b16 a[112:113], v8 offset:49280
    v_mfma_f32_16x16x32_bf16 v[148:151], a[136:139], a[28:31], v[148:151]
    ds_read_b64_tr_b16 a[114:115], v8 offset:50816
    v_mfma_f32_16x16x32_bf16 v[152:155], a[140:143], a[24:27], v[152:155]
    ds_read_b64_tr_b16 a[116:117], v9 offset:49280
    v_mfma_f32_16x16x32_bf16 v[156:159], a[140:143], a[28:31], v[156:159]
    ds_read_b64_tr_b16 a[118:119], v9 offset:50816
    s_waitcnt vmcnt(10)
    s_barrier
    s_waitcnt lgkmcnt(8)
    v_mfma_f32_16x16x32_bf16 v[64:67], a[96:99], a[32:35], v[64:67]
    ds_read_b64_tr_b16 a[120:121], v10 offset:49280
    v_mfma_f32_16x16x32_bf16 v[68:71], a[96:99], a[36:39], v[68:71]
    ds_read_b64_tr_b16 a[122:123], v10 offset:50816
    v_mfma_f32_16x16x32_bf16 v[72:75], a[100:103], a[32:35], v[72:75]
    ds_read_b64_tr_b16 a[124:125], v11 offset:49280
    v_mfma_f32_16x16x32_bf16 v[76:79], a[100:103], a[36:39], v[76:79]
    global_load_dword v27, v7, s[64:65] sc1
    ds_read_b64_tr_b16 a[126:127], v11 offset:50816
    s_waitcnt lgkmcnt(8)
    v_mfma_f32_16x16x32_bf16 v[80:83], a[104:107], a[32:35], v[80:83]
    ds_read_b64_tr_b16 a[128:129], v8 offset:49408
    v_mfma_f32_16x16x32_bf16 v[84:87], a[104:107], a[36:39], v[84:87]
    buffer_load_dwordx4 a[64:67], v12, s[16:19], s33 offen sc1
    ds_read_b64_tr_b16 a[130:131], v8 offset:50944
    v_mfma_f32_16x16x32_bf16 v[88:91], a[108:111], a[32:35], v[88:91]
    ds_read_b64_tr_b16 a[132:133], v9 offset:49408
    v_mfma_f32_16x16x32_bf16 v[92:95], a[108:111], a[36:39], v[92:95]
    ds_read_b64_tr_b16 a[134:135], v9 offset:50944
    s_waitcnt lgkmcnt(8)
    v_mfma_f32_16x16x32_bf16 v[96:99], a[112:115], a[32:35], v[96:99]
    buffer_load_dwordx4 a[68:71], v12, s[16:19], s33 offen offset:256 sc1
    ds_read_b64_tr_b16 a[136:137], v10 offset:49408
    v_mfma_f32_16x16x32_bf16 v[100:103], a[112:115], a[36:39], v[100:103]
    ds_read_b64_tr_b16 a[138:139], v10 offset:50944
    v_mfma_f32_16x16x32_bf16 v[104:107], a[116:119], a[32:35], v[104:107]
    s_add_u32 s33, s33, s52
    s_add_u32 m0, s29, 24576
    ds_read_b64_tr_b16 a[140:141], v11 offset:49408
    v_mfma_f32_16x16x32_bf16 v[108:111], a[116:119], a[36:39], v[108:111]
    ds_read_b64_tr_b16 a[142:143], v11 offset:50944
    s_waitcnt lgkmcnt(8)
    v_mfma_f32_16x16x32_bf16 v[112:115], a[120:123], a[32:35], v[112:115]
    ds_read_b64_tr_b16 a[96:97], v8 offset:61440
    v_mfma_f32_16x16x32_bf16 v[116:119], a[120:123], a[36:39], v[116:119]
    buffer_load_dwordx4 v17, s[24:27], s30 offen offset:0 lds
    ds_read_b64_tr_b16 a[98:99], v8 offset:62976
    v_mfma_f32_16x16x32_bf16 v[120:123], a[124:127], a[32:35], v[120:123]
    ds_read_b64_tr_b16 a[100:101], v9 offset:61440
    v_mfma_f32_16x16x32_bf16 v[124:127], a[124:127], a[36:39], v[124:127]
    buffer_load_dwordx4 v18, s[24:27], s30 offen offset:1024 lds
    ds_read_b64_tr_b16 a[102:103], v9 offset:62976
    s_waitcnt lgkmcnt(8)
    v_mfma_f32_16x16x32_bf16 v[128:131], a[128:131], a[32:35], v[128:131]
    ds_read_b64_tr_b16 a[104:105], v10 offset:61440
    v_mfma_f32_16x16x32_bf16 v[132:135], a[128:131], a[36:39], v[132:135]
    ds_read_b64_tr_b16 a[106:107], v10 offset:62976
    v_mfma_f32_16x16x32_bf16 v[136:139], a[132:135], a[32:35], v[136:139]
    buffer_load_dwordx4 v19, s[24:27], s30 offen offset:2048 lds
    ds_read_b64_tr_b16 a[108:109], v11 offset:61440
    v_mfma_f32_16x16x32_bf16 v[140:143], a[132:135], a[36:39], v[140:143]
    ds_read_b64_tr_b16 a[110:111], v11 offset:62976
    s_waitcnt lgkmcnt(8)
    v_mfma_f32_16x16x32_bf16 v[144:147], a[136:139], a[32:35], v[144:147]
    s_add_u32 s30, s30, s31
    ds_read_b64_tr_b16 a[112:113], v8 offset:61568
    v_mfma_f32_16x16x32_bf16 v[148:151], a[136:139], a[36:39], v[148:151]
    ds_read_b64_tr_b16 a[114:115], v8 offset:63104
    v_mfma_f32_16x16x32_bf16 v[152:155], a[140:143], a[32:35], v[152:155]
    ds_read_b64_tr_b16 a[116:117], v9 offset:61568
    v_mfma_f32_16x16x32_bf16 v[156:159], a[140:143], a[36:39], v[156:159]
    ds_read_b64_tr_b16 a[118:119], v9 offset:63104
    s_waitcnt vmcnt(10)
    s_barrier
    s_waitcnt lgkmcnt(8)
    v_mfma_f32_16x16x32_bf16 v[64:67], a[96:99], a[40:43], v[64:67]
    ds_read_b64_tr_b16 a[120:121], v10 offset:61568
    v_mfma_f32_16x16x32_bf16 v[68:71], a[96:99], a[44:47], v[68:71]
    ds_read_b64_tr_b16 a[122:123], v10 offset:63104
    v_mfma_f32_16x16x32_bf16 v[72:75], a[100:103], a[40:43], v[72:75]
    ds_read_b64_tr_b16 a[124:125], v11 offset:61568
    v_mfma_f32_16x16x32_bf16 v[76:79], a[100:103], a[44:47], v[76:79]
    buffer_load_dwordx4 a[72:75], v12, s[16:19], s33 offen sc1
    ds_read_b64_tr_b16 a[126:127], v11 offset:63104
    s_waitcnt lgkmcnt(8)
    v_mfma_f32_16x16x32_bf16 v[80:83], a[104:107], a[40:43], v[80:83]
    ds_read_b64_tr_b16 a[128:129], v8 offset:61696
    v_mfma_f32_16x16x32_bf16 v[84:87], a[104:107], a[44:47], v[84:87]
    buffer_load_dwordx4 a[76:79], v12, s[16:19], s33 offen offset:256 sc1
    ds_read_b64_tr_b16 a[130:131], v8 offset:63232
    v_mfma_f32_16x16x32_bf16 v[88:91], a[108:111], a[40:43], v[88:91]
    ds_read_b64_tr_b16 a[132:133], v9 offset:61696
    v_mfma_f32_16x16x32_bf16 v[92:95], a[108:111], a[44:47], v[92:95]
    ds_read_b64_tr_b16 a[134:135], v9 offset:63232
    s_waitcnt lgkmcnt(8)
    v_mfma_f32_16x16x32_bf16 v[96:99], a[112:115], a[40:43], v[96:99]
    s_add_u32 s33, s33, s53
    s_add_u32 m0, s29, 36864
    ds_read_b64_tr_b16 a[136:137], v10 offset:61696
    v_mfma_f32_16x16x32_bf16 v[100:103], a[112:115], a[44:47], v[100:103]
    ds_read_b64_tr_b16 a[138:139], v10 offset:63232
    v_mfma_f32_16x16x32_bf16 v[104:107], a[116:119], a[40:43], v[104:107]
    ds_read_b64_tr_b16 a[140:141], v11 offset:61696
    v_mfma_f32_16x16x32_bf16 v[108:111], a[116:119], a[44:47], v[108:111]
    buffer_load_dwordx4 v17, s[24:27], s30 offen offset:0 lds
    ds_read_b64_tr_b16 a[142:143], v11 offset:63232
    s_waitcnt lgkmcnt(8)
    v_mfma_f32_16x16x32_bf16 v[112:115], a[120:123], a[40:43], v[112:115]
    ds_read_b64_tr_b16 a[96:97], v8 offset:0
    v_mfma_f32_16x16x32_bf16 v[116:119], a[120:123], a[44:47], v[116:119]
    ds_read_b64_tr_b16 a[98:99], v8 offset:1536
    v_mfma_f32_16x16x32_bf16 v[120:123], a[124:127], a[40:43], v[120:123]
    buffer_load_dwordx4 v18, s[24:27], s30 offen offset:1024 lds
    ds_read_b64_tr_b16 a[100:101], v9 offset:0
    v_mfma_f32_16x16x32_bf16 v[124:127], a[124:127], a[44:47], v[124:127]
    ds_read_b64_tr_b16 a[102:103], v9 offset:1536
    s_waitcnt lgkmcnt(8)
    v_mfma_f32_16x16x32_bf16 v[128:131], a[128:131], a[40:43], v[128:131]
    ds_read_b64_tr_b16 a[104:105], v10 offset:0
    v_mfma_f32_16x16x32_bf16 v[132:135], a[128:131], a[44:47], v[132:135]
    buffer_load_dwordx4 v19, s[24:27], s30 offen offset:2048 lds
    ds_read_b64_tr_b16 a[106:107], v10 offset:1536
    v_mfma_f32_16x16x32_bf16 v[136:139], a[132:135], a[40:43], v[136:139]
    ds_read_b64_tr_b16 a[108:109], v11 offset:0
    v_mfma_f32_16x16x32_bf16 v[140:143], a[132:135], a[44:47], v[140:143]
    ds_read_b64_tr_b16 a[110:111], v11 offset:1536
    s_waitcnt lgkmcnt(8)
    v_mfma_f32_16x16x32_bf16 v[144:147], a[136:139], a[40:43], v[144:147]
    s_add_u32 s30, s30, s32
    ds_read_b64_tr_b16 a[112:113], v8 offset:128
    v_mfma_f32_16x16x32_bf16 v[148:151], a[136:139], a[44:47], v[148:151]
    ds_read_b64_tr_b16 a[114:115], v8 offset:1664
    v_mfma_f32_16x16x32_bf16 v[152:155], a[140:143], a[40:43], v[152:155]
    ds_read_b64_tr_b16 a[116:117], v9 offset:128
    v_mfma_f32_16x16x32_bf16 v[156:159], a[140:143], a[44:47], v[156:159]
    ds_read_b64_tr_b16 a[118:119], v9 offset:1664
    s_cmp_eq_u32 s35, s37
    s_cbranch_scc1 L_p2_lend
    s_waitcnt vmcnt(10)
    s_barrier
    s_waitcnt lgkmcnt(8)
    v_mfma_f32_16x16x32_bf16 v[64:67], a[96:99], a[48:51], v[64:67]
    ds_read_b64_tr_b16 a[120:121], v10 offset:128
    v_mfma_f32_16x16x32_bf16 v[68:71], a[96:99], a[52:55], v[68:71]
    ds_read_b64_tr_b16 a[122:123], v10 offset:1664
    v_mfma_f32_16x16x32_bf16 v[72:75], a[100:103], a[48:51], v[72:75]
    ds_read_b64_tr_b16 a[124:125], v11 offset:128
    v_mfma_f32_16x16x32_bf16 v[76:79], a[100:103], a[52:55], v[76:79]
    buffer_load_dwordx4 a[80:83], v12, s[16:19], s33 offen sc1
    ds_read_b64_tr_b16 a[126:127], v11 offset:1664
    s_waitcnt lgkmcnt(8)
    v_mfma_f32_16x16x32_bf16 v[80:83], a[104:107], a[48:51], v[80:83]
    ds_read_b64_tr_b16 a[128:129], v8 offset:256
    v_mfma_f32_16x16x32_bf16 v[84:87], a[104:107], a[52:55], v[84:87]
    buffer_load_dwordx4 a[84:87], v12, s[16:19], s33 offen offset:256 sc1
    ds_read_b64_tr_b16 a[130:131], v8 offset:1792
    v_mfma_f32_16x16x32_bf16 v[88:91], a[108:111], a[48:51], v[88:91]
    ds_read_b64_tr_b16 a[132:133], v9 offset:256
    v_mfma_f32_16x16x32_bf16 v[92:95], a[108:111], a[52:55], v[92:95]
    ds_read_b64_tr_b16 a[134:135], v9 offset:1792
    s_waitcnt lgkmcnt(8)
    v_mfma_f32_16x16x32_bf16 v[96:99], a[112:115], a[48:51], v[96:99]
    s_add_u32 s33, s33, s52
    s_add_u32 m0, s29, 49152
    ds_read_b64_tr_b16 a[136:137], v10 offset:256
    v_mfma_f32_16x16x32_bf16 v[100:103], a[112:115], a[52:55], v[100:103]
    ds_read_b64_tr_b16 a[138:139], v10 offset:1792
    v_mfma_f32_16x16x32_bf16 v[104:107], a[116:119], a[48:51], v[104:107]
    ds_read_b64_tr_b16 a[140:141], v11 offset:256
    v_mfma_f32_16x16x32_bf16 v[108:111], a[116:119], a[52:55], v[108:111]
    buffer_load_dwordx4 v17, s[24:27], s30 offen offset:0 lds
    ds_read_b64_tr_b16 a[142:143], v11 offset:1792
    s_waitcnt lgkmcnt(8)
    v_mfma_f32_16x16x32_bf16 v[112:115], a[120:123], a[48:51], v[112:115]
    ds_read_b64_tr_b16 a[96:97], v8 offset:12288
    v_mfma_f32_16x16x32_bf16 v[116:119], a[120:123], a[52:55], v[116:119]
    ds_read_b64_tr_b16 a[98:99], v8 offset:13824
    v_mfma_f32_16x16x32_bf16 v[120:123], a[124:127], a[48:51], v[120:123]
    buffer_load_dwordx4 v18, s[24:27], s30 offen offset:1024 lds
    ds_read_b64_tr_b16 a[100:101], v9 offset:12288
    v_mfma_f32_16x16x32_bf16 v[124:127], a[124:127], a[52:55], v[124:127]
    ds_read_b64_tr_b16 a[102:103], v9 offset:13824
    s_waitcnt lgkmcnt(8)
    v_mfma_f32_16x16x32_bf16 v[128:131], a[128:131], a[48:51], v[128:131]
    ds_read_b64_tr_b16 a[104:105], v10 offset:12288
    v_mfma_f32_16x16x32_bf16 v[132:135], a[128:131], a[52:55], v[132:135]
    buffer_load_dwordx4 v19, s[24:27], s30 offen offset:2048 lds
    ds_read_b64_tr_b16 a[106:107], v10 offset:13824
    v_mfma_f32_16x16x32_bf16 v[136:139], a[132:135], a[48:51], v[136:139]
    ds_read_b64_tr_b16 a[108:109], v11 offset:12288
    v_mfma_f32_16x16x32_bf16 v[140:143], a[132:135], a[52:55], v[140:143]
    ds_read_b64_tr_b16 a[110:111], v11 offset:13824
    s_waitcnt lgkmcnt(8)
    v_mfma_f32_16x16x32_bf16 v[144:147], a[136:139], a[48:51], v[144:147]
    s_add_u32 s30, s30, s31
    ds_read_b64_tr_b16 a[112:113], v8 offset:12416
    v_mfma_f32_16x16x32_bf16 v[148:151], a[136:139], a[52:55], v[148:151]
    ds_read_b64_tr_b16 a[114:115], v8 offset:13952
    v_mfma_f32_16x16x32_bf16 v[152:155], a[140:143], a[48:51], v[152:155]
    ds_read_b64_tr_b16 a[116:117], v9 offset:12416
    v_mfma_f32_16x16x32_bf16 v[156:159], a[140:143], a[52:55], v[156:159]
    ds_read_b64_tr_b16 a[118:119], v9 offset:13952
    s_waitcnt vmcnt(10)
    s_barrier
    s_waitcnt lgkmcnt(8)
    v_mfma_f32_16x16x32_bf16 v[64:67], a[96:99], a[56:59], v[64:67]
    ds_read_b64_tr_b16 a[120:121], v10 offset:12416
    v_mfma_f32_16x16x32_bf16 v[68:71], a[96:99], a[60:63], v[68:71]
    ds_read_b64_tr_b16 a[122:123], v10 offset:13952
    v_mfma_f32_16x16x32_bf16 v[72:75], a[100:103], a[56:59], v[72:75]
    ds_read_b64_tr_b16 a[124:125], v11 offset:12416
    v_mfma_f32_16x16x32_bf16 v[76:79], a[100:103], a[60:63], v[76:79]
    buffer_load_dwordx4 a[88:91], v12, s[16:19], s33 offen sc1
    ds_read_b64_tr_b16 a[126:127], v11 offset:13952
    s_waitcnt lgkmcnt(8)
    v_mfma_f32_16x16x32_bf16 v[80:83], a[104:107], a[56:59], v[80:83]
    ds_read_b64_tr_b16 a[128:129], v8 offset:12544
    v_mfma_f32_16x16x32_bf16 v[84:87], a[104:107], a[60:63], v[84:87]
    buffer_load_dwordx4 a[92:95], v12, s[16:19], s33 offen offset:256 sc1
    ds_read_b64_tr_b16 a[130:131], v8 offset:14080
    v_mfma_f32_16x16x32_bf16 v[88:91], a[108:111], a[56:59], v[88:91]
    ds_read_b64_tr_b16 a[132:133], v9 offset:12544
    v_mfma_f32_16x16x32_bf16 v[92:95], a[108:111], a[60:63], v[92:95]
    ds_read_b64_tr_b16 a[134:135], v9 offset:14080
    s_waitcnt lgkmcnt(8)
    v_mfma_f32_16x16x32_bf16 v[96:99], a[112:115], a[56:59], v[96:99]
    s_add_u32 s33, s33, s55
    s_add_u32 m0, s29, 61440
    ds_read_b64_tr_b16 a[136:137], v10 offset:12544
    v_mfma_f32_16x16x32_bf16 v[100:103], a[112:115], a[60:63], v[100:103]
    ds_read_b64_tr_b16 a[138:139], v10 offset:14080
    v_mfma_f32_16x16x32_bf16 v[104:107], a[116:119], a[56:59], v[104:107]
    ds_read_b64_tr_b16 a[140:141], v11 offset:12544
    v_mfma_f32_16x16x32_bf16 v[108:111], a[116:119], a[60:63], v[108:111]
    buffer_load_dwordx4 v17, s[24:27], s30 offen offset:0 lds
    ds_read_b64_tr_b16 a[142:143], v11 offset:14080
    s_waitcnt lgkmcnt(8)
    v_mfma_f32_16x16x32_bf16 v[112:115], a[120:123], a[56:59], v[112:115]
    ds_read_b64_tr_b16 a[96:97], v8 offset:24576
    v_mfma_f32_16x16x32_bf16 v[116:119], a[120:123], a[60:63], v[116:119]
    ds_read_b64_tr_b16 a[98:99], v8 offset:26112
    v_mfma_f32_16x16x32_bf16 v[120:123], a[124:127], a[56:59], v[120:123]
    buffer_load_dwordx4 v18, s[24:27], s30 offen offset:1024 lds
    ds_read_b64_tr_b16 a[100:101], v9 offset:24576
    v_mfma_f32_16x16x32_bf16 v[124:127], a[124:127], a[60:63], v[124:127]
    ds_read_b64_tr_b16 a[102:103], v9 offset:26112
    s_waitcnt lgkmcnt(8)
    v_mfma_f32_16x16x32_bf16 v[128:131], a[128:131], a[56:59], v[128:131]
    ds_read_b64_tr_b16 a[104:105], v10 offset:24576
    v_mfma_f32_16x16x32_bf16 v[132:135], a[128:131], a[60:63], v[132:135]
    buffer_load_dwordx4 v19, s[24:27], s30 offen offset:2048 lds
    ds_read_b64_tr_b16 a[106:107], v10 offset:26112
    v_mfma_f32_16x16x32_bf16 v[136:139], a[132:135], a[56:59], v[136:139]
    ds_read_b64_tr_b16 a[108:109], v11 offset:24576
    v_mfma_f32_16x16x32_bf16 v[140:143], a[132:135], a[60:63], v[140:143]
    ds_read_b64_tr_b16 a[110:111], v11 offset:26112
    s_waitcnt lgkmcnt(8)
    v_mfma_f32_16x16x32_bf16 v[144:147], a[136:139], a[56:59], v[144:147]
    s_add_u32 s30, s30, s47
    ds_read_b64_tr_b16 a[112:113], v8 offset:24704
    v_mfma_f32_16x16x32_bf16 v[148:151], a[136:139], a[60:63], v[148:151]
    ds_read_b64_tr_b16 a[114:115], v8 offset:26240
    v_mfma_f32_16x16x32_bf16 v[152:155], a[140:143], a[56:59], v[152:155]
    ds_read_b64_tr_b16 a[116:117], v9 offset:24704
    v_mfma_f32_16x16x32_bf16 v[156:159], a[140:143], a[60:63], v[156:159]
    ds_read_b64_tr_b16 a[118:119], v9 offset:26240
    s_waitcnt vmcnt(10)
    s_barrier
    s_cmp_eq_u32 s35, s67
    s_cbranch_scc0 L_p2_nolate
    s_mov_b32 s32, 184320
    s_mov_b32 s46, 184320
    s_mov_b32 s53, 10240
    s_mov_b32 s54, 10240
    s_mov_b32 s47, 0x40000000
    s_mov_b32 s55, 0x40000000
    v_readfirstlane_b32 s38, v27
    s_mov_b32 s39, 0
L_p2_late:
    s_cmp_ge_u32 s38, 6
    s_cbranch_scc1 L_p2_nolate
    s_add_u32 s39, s39, 1
    s_cmp_gt_u32 s39, 200000
    s_cbranch_scc1 L_p2_nolate
    s_sleep 6
    global_load_dword v27, v7, s[64:65] sc1
    s_waitcnt vmcnt(0)
    v_readfirstlane_b32 s38, v27
    s_branch L_p2_late
L_p2_nolate:
    s_nop 0
    s_waitcnt lgkmcnt(8)
    v_mfma_f32_16x16x32_bf16 v[64:67], a[96:99], a[64:67], v[64:67]
    ds_read_b64_tr_b16 a[120:121], v10 offset:24704
    v_mfma_f32_16x16x32_bf16 v[68:71], a[96:99], a[68:71], v[68:71]
    ds_read_b64_tr_b16 a[122:123], v10 offset:26240
    v_mfma_f32_16x16x32_bf16 v[72:75], a[100:103], a[64:67], v[72:75]
    ds_read_b64_tr_b16 a[124:125], v11 offset:24704
    v_mfma_f32_16x16x32_bf16 v[76:79], a[100:103], a[68:71], v[76:79]
    buffer_load_dwordx4 a[0:3], v12, s[16:19], s33 offen sc1
    ds_read_b64_tr_b16 a[126:127], v11 offset:26240
    s_waitcnt lgkmcnt(8)
    v_mfma_f32_16x16x32_bf16 v[80:83], a[104:107], a[64:67], v[80:83]
    ds_read_b64_tr_b16 a[128:129], v8 offset:24832
    v_mfma_f32_16x16x32_bf16 v[84:87], a[104:107], a[68:71], v[84:87]
    buffer_load_dwordx4 a[4:7], v12, s[16:19], s33 offen offset:256 sc1
    ds_read_b64_tr_b16 a[130:131], v8 offset:26368
    v_mfma_f32_16x16x32_bf16 v[88:91], a[108:111], a[64:67], v[88:91]
    ds_read_b64_tr_b16 a[132:133], v9 offset:24832
    v_mfma_f32_16x16x32_bf16 v[92:95], a[108:111], a[68:71], v[92:95]
    ds_read_b64_tr_b16 a[134:135], v9 offset:26368
    s_waitcnt lgkmcnt(8)
    v_mfma_f32_16x16x32_bf16 v[96:99], a[112:115], a[64:67], v[96:99]
    s_add_u32 s33, s33, s52
    s_add_u32 m0, s29, 0
    ds_read_b64_tr_b16 a[136:137], v10 offset:24832
    v_mfma_f32_16x16x32_bf16 v[100:103], a[112:115], a[68:71], v[100:103]
    ds_read_b64_tr_b16 a[138:139], v10 offset:26368
    v_mfma_f32_16x16x32_bf16 v[104:107], a[116:119], a[64:67], v[104:107]
    ds_read_b64_tr_b16 a[140:141], v11 offset:24832
    v_mfma_f32_16x16x32_bf16 v[108:111], a[116:119], a[68:71], v[108:111]
    buffer_load_dwordx4 v17, s[24:27], s30 offen offset:0 lds
    ds_read_b64_tr_b16 a[142:143], v11 offset:26368
    s_waitcnt lgkmcnt(8)
    v_mfma_f32_16x16x32_bf16 v[112:115], a[120:123], a[64:67], v[112:115]
    ds_read_b64_tr_b16 a[96:97], v8 offset:36864
    v_mfma_f32_16x16x32_bf16 v[116:119], a[120:123], a[68:71], v[116:119]
    ds_read_b64_tr_b16 a[98:99], v8 offset:38400
    v_mfma_f32_16x16x32_bf16 v[120:123], a[124:127], a[64:67], v[120:123]
    buffer_load_dwordx4 v18, s[24:27], s30 offen offset:1024 lds
    ds_read_b64_tr_b16 a[100:101], v9 offset:36864
    v_mfma_f32_16x16x32_bf16 v[124:127], a[124:127], a[68:71], v[124:127]
    ds_read_b64_tr_b16 a[102:103], v9 offset:38400
    s_waitcnt lgkmcnt(8)
    v_mfma_f32_16x16x32_bf16 v[128:131], a[128:131], a[64:67], v[128:131]
    ds_read_b64_tr_b16 a[104:105], v10 offset:36864
    v_mfma_f32_16x16x32_bf16 v[132:135], a[128:131], a[68:71], v[132:135]
    buffer_load_dwordx4 v19, s[24:27], s30 offen offset:2048 lds
    ds_read_b64_tr_b16 a[106:107], v10 offset:38400
    v_mfma_f32_16x16x32_bf16 v[136:139], a[132:135], a[64:67], v[136:139]
    ds_read_b64_tr_b16 a[108:109], v11 offset:36864
    v_mfma_f32_16x16x32_bf16 v[140:143], a[132:135], a[68:71], v[140:143]
    ds_read_b64_tr_b16 a[110:111], v11 offset:38400
    s_waitcnt lgkmcnt(8)
    v_mfma_f32_16x16x32_bf16 v[144:147], a[136:139], a[64:67], v[144:147]
    s_add_u32 s30, s30, s31
    ds_read_b64_tr_b16 a[112:113], v8 offset:36992
    v_mfma_f32_16x16x32_bf16 v[148:151], a[136:139], a[68:71], v[148:151]
    ds_read_b64_tr_b16 a[114:115], v8 offset:38528
    v_mfma_f32_16x16x32_bf16 v[152:155], a[140:143], a[64:67], v[152:155]
    ds_read_b64_tr_b16 a[116:117], v9 offset:36992
    v_mfma_f32_16x16x32_bf16 v[156:159], a[140:143], a[68:71], v[156:159]
    ds_read_b64_tr_b16 a[118:119], v9 offset:38528
    s_waitcnt vmcnt(10)
    s_barrier
    s_waitcnt lgkmcnt(8)
    v_mfma_f32_16x16x32_bf16 v[64:67], a[96:99], a[72:75], v[64:67]
    ds_read_b64_tr_b16 a[120:121], v10 offset:36992
    v_mfma_f32_16x16x32_bf16 v[68:71], a[96:99], a[76:79], v[68:71]
    ds_read_b64_tr_b16 a[122:123], v10 offset:38528
    v_mfma_f32_16x16x32_bf16 v[72:75], a[100:103], a[72:75], v[72:75]
    ds_read_b64_tr_b16 a[124:125], v11 offset:36992
    v_mfma_f32_16x16x32_bf16 v[76:79], a[100:103], a[76:79], v[76:79]
    buffer_load_dwordx4 a[8:11], v12, s[16:19], s33 offen sc1
    ds_read_b64_tr_b16 a[126:127], v11 offset:38528
    s_waitcnt lgkmcnt(8)
    v_mfma_f32_16x16x32_bf16 v[80:83], a[104:107], a[72:75], v[80:83]
    ds_read_b64_tr_b16 a[128:129], v8 offset:37120
    v_mfma_f32_16x16x32_bf16 v[84:87], a[104:107], a[76:79], v[84:87]
    buffer_load_dwordx4 a[12:15], v12, s[16:19], s33 offen offset:256 sc1
    ds_read_b64_tr_b16 a[130:131], v8 offset:38656
    v_mfma_f32_16x16x32_bf16 v[88:91], a[108:111], a[72:75], v[88:91]
    ds_read_b64_tr_b16 a[132:133], v9 offset:37120
    v_mfma_f32_16x16x32_bf16 v[92:95], a[108:111], a[76:79], v[92:95]
    ds_read_b64_tr_b16 a[134:135], v9 offset:38656
    s_waitcnt lgkmcnt(8)
    v_mfma_f32_16x16x32_bf16 v[96:99], a[112:115], a[72:75], v[96:99]
    s_add_u32 s33, s33, s53
    s_add_u32 m0, s29, 12288
    ds_read_b64_tr_b16 a[136:137], v10 offset:37120
    v_mfma_f32_16x16x32_bf16 v[100:103], a[112:115], a[76:79], v[100:103]
    ds_read_b64_tr_b16 a[138:139], v10 offset:38656
    v_mfma_f32_16x16x32_bf16 v[104:107], a[116:119], a[72:75], v[104:107]
    ds_read_b64_tr_b16 a[140:141], v11 offset:37120
    v_mfma_f32_16x16x32_bf16 v[108:111], a[116:119], a[76:79], v[108:111]
    buffer_load_dwordx4 v17, s[24:27], s30 offen offset:0 lds
    ds_read_b64_tr_b16 a[142:143], v11 offset:38656
    s_waitcnt lgkmcnt(8)
    v_mfma_f32_16x16x32_bf16 v[112:115], a[120:123], a[72:75], v[112:115]
    ds_read_b64_tr_b16 a[96:97], v8 offset:49152
    v_mfma_f32_16x16x32_bf16 v[116:119], a[120:123], a[76:79], v[116:119]
    ds_read_b64_tr_b16 a[98:99], v8 offset:50688
    v_mfma_f32_16x16x32_bf16 v[120:123], a[124:127], a[72:75], v[120:123]
    buffer_load_dwordx4 v18, s[24:27], s30 offen offset:1024 lds
    ds_read_b64_tr_b16 a[100:101], v9 offset:49152
    v_mfma_f32_16x16x32_bf16 v[124:127], a[124:127], a[76:79], v[124:127]
    ds_read_b64_tr_b16 a[102:103], v9 offset:50688
    s_waitcnt lgkmcnt(8)
    v_mfma_f32_16x16x32_bf16 v[128:131], a[128:131], a[72:75], v[128:131]
    ds_read_b64_tr_b16 a[104:105], v10 offset:49152
    v_mfma_f32_16x16x32_bf16 v[132:135], a[128:131], a[76:79], v[132:135]
    buffer_load_dwordx4 v19, s[24:27], s30 offen offset:2048 lds
    ds_read_b64_tr_b16 a[106:107], v10 offset:50688
    v_mfma_f32_16x16x32_bf16 v[136:139], a[132:135], a[72:75], v[136:139]
    ds_read_b64_tr_b16 a[108:109], v11 offset:49152
    v_mfma_f32_16x16x32_bf16 v[140:143], a[132:135], a[76:79], v[140:143]
    ds_read_b64_tr_b16 a[110:111], v11 offset:50688
    s_waitcnt lgkmcnt(8)
    v_mfma_f32_16x16x32_bf16 v[144:147], a[136:139], a[72:75], v[144:147]
    s_add_u32 s30, s30, s32
    ds_read_b64_tr_b16 a[112:113], v8 offset:49280
    v_mfma_f32_16x16x32_bf16 v[148:151], a[136:139], a[76:79], v[148:151]
    ds_read_b64_tr_b16 a[114:115], v8 offset:50816
    v_mfma_f32_16x16x32_bf16 v[152:155], a[140:143], a[72:75], v[152:155]
    ds_read_b64_tr_b16 a[116:117], v9 offset:49280
    v_mfma_f32_16x16x32_bf16 v[156:159], a[140:143], a[76:79], v[156:159]
    ds_read_b64_tr_b16 a[118:119], v9 offset:50816
    s_waitcnt vmcnt(10)
    s_barrier
    s_waitcnt lgkmcnt(8)
    v_mfma_f32_16x16x32_bf16 v[64:67], a[96:99], a[80:83], v[64:67]
    ds_read_b64_tr_b16 a[120:121], v10 offset:49280
    v_mfma_f32_16x16x32_bf16 v[68:71], a[96:99], a[84:87], v[68:71]
    ds_read_b64_tr_b16 a[122:123], v10 offset:50816
    v_mfma_f32_16x16x32_bf16 v[72:75], a[100:103], a[80:83], v[72:75]
    ds_read_b64_tr_b16 a[124:125], v11 offset:49280
    v_mfma_f32_16x16x32_bf16 v[76:79], a[100:103], a[84:87], v[76:79]
    buffer_load_dwordx4 a[16:19], v12, s[16:19], s33 offen sc1
    ds_read_b64_tr_b16 a[126:127], v11 offset:50816
    s_waitcnt lgkmcnt(8)
    v_mfma_f32_16x16x32_bf16 v[80:83], a[104:107], a[80:83], v[80:83]
    ds_read_b64_tr_b16 a[128:129], v8 offset:49408
    v_mfma_f32_16x16x32_bf16 v[84:87], a[104:107], a[84:87], v[84:87]
    buffer_load_dwordx4 a[20:23], v12, s[16:19], s33 offen offset:256 sc1
    ds_read_b64_tr_b16 a[130:131], v8 offset:50944
    v_mfma_f32_16x16x32_bf16 v[88:91], a[108:111], a[80:83], v[88:91]
    ds_read_b64_tr_b16 a[132:133], v9 offset:49408
    v_mfma_f32_16x16x32_bf16 v[92:95], a[108:111], a[84:87], v[92:95]
    ds_read_b64_tr_b16 a[134:135], v9 offset:50944
    s_waitcnt lgkmcnt(8)
    v_mfma_f32_16x16x32_bf16 v[96:99], a[112:115], a[80:83], v[96:99]
    s_add_u32 s33, s33, s52
    s_add_u32 m0, s29, 24576
    ds_read_b64_tr_b16 a[136:137], v10 offset:49408
    v_mfma_f32_16x16x32_bf16 v[100:103], a[112:115], a[84:87], v[100:103]
    ds_read_b64_tr_b16 a[138:139], v10 offset:50944
    v_mfma_f32_16x16x32_bf16 v[104:107], a[116:119], a[80:83], v[104:107]
    ds_read_b64_tr_b16 a[140:141], v11 offset:49408
    v_mfma_f32_16x16x32_bf16 v[108:111], a[116:119], a[84:87], v[108:111]
    buffer_load_dwordx4 v17, s[24:27], s30 offen offset:0 lds
    ds_read_b64_tr_b16 a[142:143], v11 offset:50944
    s_waitcnt lgkmcnt(8)
    v_mfma_f32_16x16x32_bf16 v[112:115], a[120:123], a[80:83], v[112:115]
    ds_read_b64_tr_b16 a[96:97], v8 offset:61440
    v_mfma_f32_16x16x32_bf16 v[116:119], a[120:123], a[84:87], v[116:119]
    ds_read_b64_tr_b16 a[98:99], v8 offset:62976
    v_mfma_f32_16x16x32_bf16 v[120:123], a[124:127], a[80:83], v[120:123]
    buffer_load_dwordx4 v18, s[24:27], s30 offen offset:1024 lds
    ds_read_b64_tr_b16 a[100:101], v9 offset:61440
    v_mfma_f32_16x16x32_bf16 v[124:127], a[124:127], a[84:87], v[124:127]
    ds_read_b64_tr_b16 a[102:103], v9 offset:62976
    s_waitcnt lgkmcnt(8)
    v_mfma_f32_16x16x32_bf16 v[128:131], a[128:131], a[80:83], v[128:131]
    ds_read_b64_tr_b16 a[104:105], v10 offset:61440
    v_mfma_f32_16x16x32_bf16 v[132:135], a[128:131], a[84:87], v[132:135]
    buffer_load_dwordx4 v19, s[24:27], s30 offen offset:2048 lds
    ds_read_b64_tr_b16 a[106:107], v10 offset:62976
    v_mfma_f32_16x16x32_bf16 v[136:139], a[132:135], a[80:83], v[136:139]
    ds_read_b64_tr_b16 a[108:109], v11 offset:61440
    v_mfma_f32_16x16x32_bf16 v[140:143], a[132:135], a[84:87], v[140:143]
    ds_read_b64_tr_b16 a[110:111], v11 offset:62976
    s_waitcnt lgkmcnt(8)
    v_mfma_f32_16x16x32_bf16 v[144:147], a[136:139], a[80:83], v[144:147]
    s_add_u32 s30, s30, s31
    ds_read_b64_tr_b16 a[112:113], v8 offset:61568
    v_mfma_f32_16x16x32_bf16 v[148:151], a[136:139], a[84:87], v[148:151]
    ds_read_b64_tr_b16 a[114:115], v8 offset:63104
    v_mfma_f32_16x16x32_bf16 v[152:155], a[140:143], a[80:83], v[152:155]
    ds_read_b64_tr_b16 a[116:117], v9 offset:61568
    v_mfma_f32_16x16x32_bf16 v[156:159], a[140:143], a[84:87], v[156:159]
    ds_read_b64_tr_b16 a[118:119], v9 offset:63104
    s_waitcnt vmcnt(10)
    s_barrier
    s_waitcnt lgkmcnt(8)
    v_mfma_f32_16x16x32_bf16 v[64:67], a[96:99], a[88:91], v[64:67]
    ds_read_b64_tr_b16 a[120:121], v10 offset:61568
    v_mfma_f32_16x16x32_bf16 v[68:71], a[96:99], a[92:95], v[68:71]
    ds_read_b64_tr_b16 a[122:123], v10 offset:63104
    v_mfma_f32_16x16x32_bf16 v[72:75], a[100:103], a[88:91], v[72:75]
    ds_read_b64_tr_b16 a[124:125], v11 offset:61568
    v_mfma_f32_16x16x32_bf16 v[76:79], a[100:103], a[92:95], v[76:79]
    buffer_load_dwordx4 a[24:27], v12, s[16:19], s33 offen sc1
    ds_read_b64_tr_b16 a[126:127], v11 offset:63104
    s_waitcnt lgkmcnt(8)
    v_mfma_f32_16x16x32_bf16 v[80:83], a[104:107], a[88:91], v[80:83]
    ds_read_b64_tr_b16 a[128:129], v8 offset:61696
    v_mfma_f32_16x16x32_bf16 v[84:87], a[104:107], a[92:95], v[84:87]
    buffer_load_dwordx4 a[28:31], v12, s[16:19], s33 offen offset:256 sc1
    ds_read_b64_tr_b16 a[130:131], v8 offset:63232
    v_mfma_f32_16x16x32_bf16 v[88:91], a[108:111], a[88:91], v[88:91]
    ds_read_b64_tr_b16 a[132:133], v9 offset:61696
    v_mfma_f32_16x16x32_bf16 v[92:95], a[108:111], a[92:95], v[92:95]
    ds_read_b64_tr_b16 a[134:135], v9 offset:63232
    s_waitcnt lgkmcnt(8)
    v_mfma_f32_16x16x32_bf16 v[96:99], a[112:115], a[88:91], v[96:99]
    s_add_u32 s33, s33, s54
    s_add_u32 m0, s29, 36864
    ds_read_b64_tr_b16 a[136:137], v10 offset:61696
    v_mfma_f32_16x16x32_bf16 v[100:103], a[112:115], a[92:95], v[100:103]
    ds_read_b64_tr_b16 a[138:139], v10 offset:63232
    v_mfma_f32_16x16x32_bf16 v[104:107], a[116:119], a[88:91], v[104:107]
    ds_read_b64_tr_b16 a[140:141], v11 offset:61696
    v_mfma_f32_16x16x32_bf16 v[108:111], a[116:119], a[92:95], v[108:111]
    buffer_load_dwordx4 v17, s[24:27], s30 offen offset:0 lds
    ds_read_b64_tr_b16 a[142:143], v11 offset:63232
    s_waitcnt lgkmcnt(8)
    v_mfma_f32_16x16x32_bf16 v[112:115], a[120:123], a[88:91], v[112:115]
    ds_read_b64_tr_b16 a[96:97], v8 offset:0
    v_mfma_f32_16x16x32_bf16 v[116:119], a[120:123], a[92:95], v[116:119]
    ds_read_b64_tr_b16 a[98:99], v8 offset:1536
    v_mfma_f32_16x16x32_bf16 v[120:123], a[124:127], a[88:91], v[120:123]
    buffer_load_dwordx4 v18, s[24:27], s30 offen offset:1024 lds
    ds_read_b64_tr_b16 a[100:101], v9 offset:0
    v_mfma_f32_16x16x32_bf16 v[124:127], a[124:127], a[92:95], v[124:127]
    ds_read_b64_tr_b16 a[102:103], v9 offset:1536
    s_waitcnt lgkmcnt(8)
    v_mfma_f32_16x16x32_bf16 v[128:131], a[128:131], a[88:91], v[128:131]
    ds_read_b64_tr_b16 a[104:105], v10 offset:0
    v_mfma_f32_16x16x32_bf16 v[132:135], a[128:131], a[92:95], v[132:135]
    buffer_load_dwordx4 v19, s[24:27], s30 offen offset:2048 lds
    ds_read_b64_tr_b16 a[106:107], v10 offset:1536
    v_mfma_f32_16x16x32_bf16 v[136:139], a[132:135], a[88:91], v[136:139]
    ds_read_b64_tr_b16 a[108:109], v11 offset:0
    v_mfma_f32_16x16x32_bf16 v[140:143], a[132:135], a[92:95], v[140:143]
    ds_read_b64_tr_b16 a[110:111], v11 offset:1536
    s_waitcnt lgkmcnt(8)
    v_mfma_f32_16x16x32_bf16 v[144:147], a[136:139], a[88:91], v[144:147]
    s_add_u32 s30, s30, s46
    ds_read_b64_tr_b16 a[112:113], v8 offset:128
    v_mfma_f32_16x16x32_bf16 v[148:151], a[136:139], a[92:95], v[148:151]
    ds_read_b64_tr_b16 a[114:115], v8 offset:1664
    v_mfma_f32_16x16x32_bf16 v[152:155], a[140:143], a[88:91], v[152:155]
    ds_read_b64_tr_b16 a[116:117], v9 offset:128
    v_mfma_f32_16x16x32_bf16 v[156:159], a[140:143], a[92:95], v[156:159]
    ds_read_b64_tr_b16 a[118:119], v9 offset:1664
    s_add_u32 s47, s47, s60
    s_add_u32 s55, s55, s61
    s_add_u32 s35, s35, 1
    s_cmp_lt_u32 s35, s36
    s_cbranch_scc1 L_p2_loop
L_p2_lend:
    s_waitcnt lgkmcnt(0)
    s_mul_i32 s47, s92, 5
    s_add_u32 s47, s47, s91
    s_lshl_b32 s47, s47, 2
    s_add_u32 s47, s47, s93
    s_mul_i32 s47, s47, 12288
    s_add_u32 s20, s70, 23068672
    s_addc_u32 s21, s71, 0
    s_mov_b32 s22, 11796480
    s_mov_b32 s23, 0x20000
    s_nop 7
    v_mov_b32 v21, 34816
    global_load_dword v22, v21, s[64:65] sc1
    s_cmp_eq_u32 s91, 0
    s_cbranch_scc1 L_p3_own0
    v_cvt_pk_bf16_f32 v32, v64, v65
    v_cvt_pk_bf16_f32 v33, v66, v67
    v_cvt_pk_bf16_f32 v34, v72, v73
    v_cvt_pk_bf16_f32 v35, v74, v75
    s_add_u32 s56, s47, 0
    buffer_store_dwordx4 v[32:35], v20, s[20:23], s56 offen offset:0 sc1
    s_branch L_p3_nx0
L_p3_own0:
    v_mov_b32 v200, v64
    v_mov_b32 v201, v65
    v_mov_b32 v202, v66
    v_mov_b32 v203, v67
    v_mov_b32 v204, v72
    v_mov_b32 v205, v73
    v_mov_b32 v206, v74
    v_mov_b32 v207, v75
L_p3_nx0:
    s_cmp_eq_u32 s91, 1
    s_cbranch_scc1 L_p3_own1
    v_cvt_pk_bf16_f32 v36, v80, v81
    v_cvt_pk_bf16_f32 v37, v82, v83
    v_cvt_pk_bf16_f32 v38, v88, v89
    v_cvt_pk_bf16_f32 v39, v90, v91
    s_add_u32 s56, s47, 0
    buffer_store_dwordx4 v[36:39], v20, s[20:23], s56 offen offset:1024 sc1
    s_branch L_p3_nx1
L_p3_own1:
    v_mov_b32 v200, v80
    v_mov_b32 v201, v81
    v_mov_b32 v202, v82
    v_mov_b32 v203, v83
    v_mov_b32 v204, v88
    v_mov_b32 v205, v89
    v_mov_b32 v206, v90
    v_mov_b32 v207, v91
L_p3_nx1:
    s_cmp_eq_u32 s91, 2
    s_cbranch_scc1 L_p3_own2
    v_cvt_pk_bf16_f32 v40, v96, v97
    v_cvt_pk_bf16_f32 v41, v98, v99
    v_cvt_pk_bf16_f32 v42, v104, v105
    v_cvt_pk_bf16_f32 v43, v106, v107
    s_add_u32 s56, s47, 0
    buffer_store_dwordx4 v[40:43], v20, s[20:23], s56 offen offset:2048 sc1
    s_branch L_p3_nx2
L_p3_own2:
    v_mov_b32 v200, v96
    v_mov_b32 v201, v97
    v_mov_b32 v202, v98
    v_mov_b32 v203, v99
    v_mov_b32 v204, v104
    v_mov_b32 v205, v105
    v_mov_b32 v206, v106
    v_mov_b32 v207, v107
L_p3_nx2:
    s_cmp_eq_u32 s91, 3
    s_cbranch_scc1 L_p3_own3
    v_cvt_pk_bf16_f32 v44, v112, v113
    v_cvt_pk_bf16_f32 v45, v114, v115
    v_cvt_pk_bf16_f32 v46, v120, v121
    v_cvt_pk_bf16_f32 v47, v122, v123
    s_add_u32 s56, s47, 0
    buffer_store_dwordx4 v[44:47], v20, s[20:23], s56 offen offset:3072 sc1
    s_branch L_p3_nx3
L_p3_own3:
    v_mov_b32 v200, v112
    v_mov_b32 v201, v113
    v_mov_b32 v202, v114
    v_mov_b32 v203, v115
    v_mov_b32 v204, v120
    v_mov_b32 v205, v121
    v_mov_b32 v206, v122
    v_mov_b32 v207, v123
L_p3_nx3:
    s_cmp_eq_u32 s91, 4
    s_cbranch_scc1 L_p3_own4
    v_cvt_pk_bf16_f32 v32, v128, v129
    v_cvt_pk_bf16_f32 v33, v130, v131
    v_cvt_pk_bf16_f32 v34, v136, v137
    v_cvt_pk_bf16_f32 v35, v138, v139
    s_add_u32 s56, s47, 4096
    buffer_store_dwordx4 v[32:35], v20, s[20:23], s56 offen offset:0 sc1
    s_branch L_p3_nx4
L_p3_own4:
    v_mov_b32 v200, v128
    v_mov_b32 v201, v129
    v_mov_b32 v202, v130
    v_mov_b32 v203, v131
    v_mov_b32 v204, v136
    v_mov_b32 v205, v137
    v_mov_b32 v206, v138
    v_mov_b32 v207, v139
L_p3_nx4:
    s_cmp_eq_u32 s91, 0
    s_cbranch_scc1 L_p3_own5
    v_cvt_pk_bf16_f32 v36, v144, v145
    v_cvt_pk_bf16_f32 v37, v146, v147
    v_cvt_pk_bf16_f32 v38, v152, v153
    v_cvt_pk_bf16_f32 v39, v154, v155
    s_add_u32 s56, s47, 4096
    buffer_store_dwordx4 v[36:39], v20, s[20:23], s56 offen offset:1024 sc1
    s_branch L_p3_nx5
L_p3_own5:
    v_mov_b32 v208, v144
    v_mov_b32 v209, v145
    v_mov_b32 v210, v146
    v_mov_b32 v211, v147
    v_mov_b32 v212, v152
    v_mov_b32 v213, v153
    v_mov_b32 v214, v154
    v_mov_b32 v215, v155
L_p3_nx5:
    s_cmp_eq_u32 s91, 1
    s_cbranch_scc1 L_p3_own6
    v_cvt_pk_bf16_f32 v40, v68, v69
    v_cvt_pk_bf16_f32 v41, v70, v71
    v_cvt_pk_bf16_f32 v42, v76, v77
    v_cvt_pk_bf16_f32 v43, v78, v79
    s_add_u32 s56, s47, 4096
    buffer_store_dwordx4 v[40:43], v20, s[20:23], s56 offen offset:2048 sc1
    s_branch L_p3_nx6
L_p3_own6:
    v_mov_b32 v208, v68
    v_mov_b32 v209, v69
    v_mov_b32 v210, v70
    v_mov_b32 v211, v71
    v_mov_b32 v212, v76
    v_mov_b32 v213, v77
    v_mov_b32 v214, v78
    v_mov_b32 v215, v79
L_p3_nx6:
    s_cmp_eq_u32 s91, 2
    s_cbranch_scc1 L_p3_own7
    v_cvt_pk_bf16_f32 v44, v84, v85
    v_cvt_pk_bf16_f32 v45, v86, v87
    v_cvt_pk_bf16_f32 v46, v92, v93
    v_cvt_pk_bf16_f32 v47, v94, v95
    s_add_u32 s56, s47, 4096
    buffer_store_dwordx4 v[44:47], v20, s[20:23], s56 offen offset:3072 sc1
    s_branch L_p3_nx7
L_p3_own7:
    v_mov_b32 v208, v84
    v_mov_b32 v209, v85
    v_mov_b32 v210, v86
    v_mov_b32 v211, v87
    v_mov_b32 v212, v92
    v_mov_b32 v213, v93
    v_mov_b32 v214, v94
    v_mov_b32 v215, v95
L_p3_nx7:
    s_cmp_eq_u32 s91, 3
    s_cbranch_scc1 L_p3_own8
    v_cvt_pk_bf16_f32 v32, v100, v101
    v_cvt_pk_bf16_f32 v33, v102, v103
    v_cvt_pk_bf16_f32 v34, v108, v109
    v_cvt_pk_bf16_f32 v35, v110, v111
    s_add_u32 s56, s47, 8192
    buffer_store_dwordx4 v[32:35], v20, s[20:23], s56 offen offset:0 sc1
    s_branch L_p3_nx8
L_p3_own8:
    v_mov_b32 v208, v100
    v_mov_b32 v209, v101
    v_mov_b32 v210, v102
    v_mov_b32 v211, v103
    v_mov_b32 v212, v108
    v_mov_b32 v213, v109
    v_mov_b32 v214, v110
    v_mov_b32 v215, v111
L_p3_nx8:
    s_cmp_eq_u32 s91, 4
    s_cbranch_scc1 L_p3_own9
    v_cvt_pk_bf16_f32 v36, v116, v117
    v_cvt_pk_bf16_f32 v37, v118, v119
    v_cvt_pk_bf16_f32 v38, v124, v125
    v_cvt_pk_bf16_f32 v39, v126, v127
    s_add_u32 s56, s47, 8192
    buffer_store_dwordx4 v[36:39], v20, s[20:23], s56 offen offset:1024 sc1
    s_branch L_p3_nx9
L_p3_own9:
    v_mov_b32 v208, v116
    v_mov_b32 v209, v117
    v_mov_b32 v210, v118
    v_mov_b32 v211, v119
    v_mov_b32 v212, v124
    v_mov_b32 v213, v125
    v_mov_b32 v214, v126
    v_mov_b32 v215, v127
L_p3_nx9:
    s_cmp_eq_u32 s91, 0
    s_cbranch_scc1 L_p3_own10
    v_cvt_pk_bf16_f32 v40, v132, v133
    v_cvt_pk_bf16_f32 v41, v134, v135
    v_cvt_pk_bf16_f32 v42, v140, v141
    v_cvt_pk_bf16_f32 v43, v142, v143
    s_add_u32 s56, s47, 8192
    buffer_store_dwordx4 v[40:43], v20, s[20:23], s56 offen offset:2048 sc1
    s_branch L_p3_nx10
L_p3_own10:
    v_mov_b32 v216, v132
    v_mov_b32 v217, v133
    v_mov_b32 v218, v134
    v_mov_b32 v219, v135
    v_mov_b32 v220, v140
    v_mov_b32 v221, v141
    v_mov_b32 v222, v142
    v_mov_b32 v223, v143
L_p3_nx10:
    s_cmp_eq_u32 s91, 1
    s_cbranch_scc1 L_p3_own11
    v_cvt_pk_bf16_f32 v44, v148, v149
    v_cvt_pk_bf16_f32 v45, v150, v151
    v_cvt_pk_bf16_f32 v46, v156, v157
    v_cvt_pk_bf16_f32 v47, v158, v159
    s_add_u32 s56, s47, 8192
    buffer_store_dwordx4 v[44:47], v20, s[20:23], s56 offen offset:3072 sc1
    s_branch L_p3_nx11
L_p3_own11:
    v_mov_b32 v216, v148
    v_mov_b32 v217, v149
    v_mov_b32 v218, v150
    v_mov_b32 v219, v151
    v_mov_b32 v220, v156
    v_mov_b32 v221, v157
    v_mov_b32 v222, v158
    v_mov_b32 v223, v159
L_p3_nx11:
    s_lshl_b32 s57, s92, 2
    s_add_u32 s57, s57, s93
    s_add_u32 s57, s57, 80
    v_and_b32 v4, 15, v1
    v_lshrrev_b32 v5, 4, v1
    s_lshl_b32 s60, s5, 7
    s_lshl_b32 s61, s93, 5
    s_add_u32 s60, s60, s61
    v_add_u32 v6, s60, v4
    v_lshlrev_b32 v7, 2, v6
    v_mul_u32_u24 v6, 0x480, v6
    v_lshlrev_b32 v5, 3, v5
    v_add_u32 v6, v6, v5
    s_mov_b32 s8, s44
    s_mov_b32 s9, s45
    s_mov_b32 s10, 2359296
    s_mov_b32 s11, 0x20000
    s_add_u32 s12, s70, 22020096
    s_addc_u32 s13, s71, 0
    s_mov_b32 s14, 8192
    s_mov_b32 s15, 0x20000
    s_mul_i32 s62, s92, 245760
    s_mul_i32 s63, s93, 12288
    s_add_u32 s62, s62, s63
    s_lshl_b32 s38, s57, 7
    v_mov_b32 v2, s38
    s_lshl_b32 s38, 1, s91
    v_mov_b32 v8, s38
    s_waitcnt vmcnt(0)
    s_mov_b32 s39, 0
L_p3_gc:
    v_readfirstlane_b32 s38, v22
    s_add_u32 s39, s39, 1
    s_cmp_ge_u32 s38, 16
    s_cbranch_scc1 L_p3_gcok
    s_cmp_gt_u32 s39, 200000
    s_cbranch_scc1 L_p3_gcok
    s_sleep 6
    global_load_dword v22, v21, s[64:65] sc1
    s_waitcnt vmcnt(0)
    s_branch L_p3_gc
L_p3_gcok:
    buffer_load_dword v11, v7, s[12:15], 0 offen sc1
    buffer_load_dword v13, v7, s[12:15], 0 offen offset:64 sc1
    v_cmp_eq_u32 vcc, 0, v1
    s_and_saveexec_b64 s[48:49], vcc
    global_atomic_add v2, v8, s[64:65] sc1
    s_mov_b64 exec, s[48:49]
    s_add_u32 s38, s91, 1
    s_and_b32 s38, s38, 3
    s_cmp_eq_u32 s91, 4
    s_cselect_b32 s38, 0, s38
    s_mul_i32 s52, s38, 49152
    s_lshl_b32 s16, 1, s38
    s_add_u32 s38, s91, 2
    s_and_b32 s38, s38, 3
    s_cmp_eq_u32 s91, 4
    s_cselect_b32 s38, 1, s38
    s_mul_i32 s53, s38, 49152
    s_lshl_b32 s17, 1, s38
    s_add_u32 s38, s91, 3
    s_and_b32 s38, s38, 3
    s_cmp_eq_u32 s91, 4
    s_cselect_b32 s38, 2, s38
    s_mul_i32 s54, s38, 49152
    s_lshl_b32 s18, 1, s38
    s_add_u32 s38, s91, 4
    s_and_b32 s38, s38, 3
    s_mov_b32 s38, 4
    s_cmp_eq_u32 s91, 4
    s_cselect_b32 s38, 3, s38
    s_mul_i32 s55, s38, 49152
    s_lshl_b32 s19, 1, s38
    s_lshl_b32 s63, s91, 10
    s_add_u32 s63, s63, s62
    s_mov_b32 s39, 0
    s_mov_b32 s46, 0
L_p2_poll2:
    global_load_dword v3, v2, s[64:65] sc1
    s_waitcnt vmcnt(0)
    v_readfirstlane_b32 s38, v3
    s_add_u32 s39, s39, 1
    s_cmp_gt_u32 s39, 200000
    s_cselect_b32 s38, 31, s38
    s_andn2_b32 s38, s38, s46
    s_and_b32 s47, s38, s16
    s_cbranch_scc0 L_p3_s0
    s_or_b32 s46, s46, s16
    s_add_u32 s47, s63, s52
    buffer_load_dwordx4 v[64:67], v20, s[20:23], s47 offen sc1
    s_add_u32 s47, s47, 5120
    buffer_load_dwordx4 v[80:83], v20, s[20:23], s47 offen sc1
    s_add_u32 s47, s47, 5120
    s_cmp_gt_u32 s91, 1
    s_cbranch_scc1 L_p3_s0
    buffer_load_dwordx4 v[96:99], v20, s[20:23], s47 offen sc1
L_p3_s0:
    s_and_b32 s47, s38, s17
    s_cbranch_scc0 L_p3_s1
    s_or_b32 s46, s46, s17
    s_add_u32 s47, s63, s53
    buffer_load_dwordx4 v[68:71], v20, s[20:23], s47 offen sc1
    s_add_u32 s47, s47, 5120
    buffer_load_dwordx4 v[84:87], v20, s[20:23], s47 offen sc1
    s_add_u32 s47, s47, 5120
    s_cmp_gt_u32 s91, 1
    s_cbranch_scc1 L_p3_s1
    buffer_load_dwordx4 v[100:103], v20, s[20:23], s47 offen sc1
L_p3_s1:
    s_and_b32 s47, s38, s18
    s_cbranch_scc0 L_p3_s2
    s_or_b32 s46, s46, s18
    s_add_u32 s47, s63, s54
    buffer_load_dwordx4 v[72:75], v20, s[20:23], s47 offen sc1
    s_add_u32 s47, s47, 5120
    buffer_load_dwordx4 v[88:91], v20, s[20:23], s47 offen sc1
    s_add_u32 s47, s47, 5120
    s_cmp_gt_u32 s91, 1
    s_cbranch_scc1 L_p3_s2
    buffer_load_dwordx4 v[104:107], v20, s[20:23], s47 offen sc1
L_p3_s2:
    s_and_b32 s47, s38, s19
    s_cbranch_scc0 L_p3_s3
    s_or_b32 s46, s46, s19
    s_add_u32 s47, s63, s55
    buffer_load_dwordx4 v[76:79], v20, s[20:23], s47 offen sc1
    s_add_u32 s47, s47, 5120
    buffer_load_dwordx4 v[92:95], v20, s[20:23], s47 offen sc1
    s_add_u32 s47, s47, 5120
    s_cmp_gt_u32 s91, 1
    s_cbranch_scc1 L_p3_s3
    buffer_load_dwordx4 v[108:111], v20, s[20:23], s47 offen sc1
L_p3_s3:
    s_lshl_b32 s47, 1, s91
    s_or_b32 s47, s47, s46
    s_cmp_eq_u32 s47, 31
    s_cbranch_scc1 L_p2_poll2_ok
    s_sleep 2
    s_branch L_p2_poll2
L_p2_poll2_ok:
L_p3_ld2:
    s_waitcnt vmcnt(0)
    v_mov_b32 v14, v11
    s_cmp_eq_u32 s91, 4
    s_cbranch_scc1 L_p3_att
    s_add_u32 s63, s91, 0
    s_cmp_ge_u32 s63, 6
    s_cselect_b32 s56, 6, 0
    s_cselect_b64 s[50:51], -1, 0
    s_cselect_b32 s57, 18432, 0
    s_sub_u32 s63, s63, s56
    s_lshl_b32 s63, s63, 6
    s_mul_i32 s56, s6, 384
    s_add_u32 s63, s63, s56
    s_add_u32 s63, s63, s57
    v_cndmask_b32 v11, v14, v13, s[50:51]
    v_sub_f32 v12, 1.0, v11
    v_lshlrev_b32 v48, 16, v64
    v_and_b32 v49, 0xffff0000, v64
    v_pk_add_f32 v[40:41], v[200:201], v[48:49]
    v_lshlrev_b32 v48, 16, v68
    v_and_b32 v49, 0xffff0000, v68
    v_pk_add_f32 v[40:41], v[40:41], v[48:49]
    v_lshlrev_b32 v48, 16, v72
    v_and_b32 v49, 0xffff0000, v72
    v_pk_add_f32 v[40:41], v[40:41], v[48:49]
    v_lshlrev_b32 v48, 16, v76
    v_and_b32 v49, 0xffff0000, v76
    v_pk_mul_f32 v[40:41], v[40:41], v[12:13] op_sel_hi:[1,0]
    v_pk_fma_f32 v[40:41], v[48:49], v[10:11], v[40:41] op_sel:[0,1,0] op_sel_hi:[1,1,1]
    v_lshlrev_b32 v48, 16, v65
    v_and_b32 v49, 0xffff0000, v65
    v_pk_add_f32 v[42:43], v[202:203], v[48:49]
    v_lshlrev_b32 v48, 16, v69
    v_and_b32 v49, 0xffff0000, v69
    v_pk_add_f32 v[42:43], v[42:43], v[48:49]
    v_lshlrev_b32 v48, 16, v73
    v_and_b32 v49, 0xffff0000, v73
    v_pk_add_f32 v[42:43], v[42:43], v[48:49]
    v_lshlrev_b32 v48, 16, v77
    v_and_b32 v49, 0xffff0000, v77
    v_pk_mul_f32 v[42:43], v[42:43], v[12:13] op_sel_hi:[1,0]
    v_pk_fma_f32 v[42:43], v[48:49], v[10:11], v[42:43] op_sel:[0,1,0] op_sel_hi:[1,1,1]
    v_lshlrev_b32 v48, 16, v66
    v_and_b32 v49, 0xffff0000, v66
    v_pk_add_f32 v[44:45], v[204:205], v[48:49]
    v_lshlrev_b32 v48, 16, v70
    v_and_b32 v49, 0xffff0000, v70
    v_pk_add_f32 v[44:45], v[44:45], v[48:49]
    v_lshlrev_b32 v48, 16, v74
    v_and_b32 v49, 0xffff0000, v74
    v_pk_add_f32 v[44:45], v[44:45], v[48:49]
    v_lshlrev_b32 v48, 16, v78
    v_and_b32 v49, 0xffff0000, v78
    v_pk_mul_f32 v[44:45], v[44:45], v[12:13] op_sel_hi:[1,0]
    v_pk_fma_f32 v[44:45], v[48:49], v[10:11], v[44:45] op_sel:[0,1,0] op_sel_hi:[1,1,1]
    v_lshlrev_b32 v48, 16, v67
    v_and_b32 v49, 0xffff0000, v67
    v_pk_add_f32 v[46:47], v[206:207], v[48:49]
    v_lshlrev_b32 v48, 16, v71
    v_and_b32 v49, 0xffff0000, v71
    v_pk_add_f32 v[46:47], v[46:47], v[48:49]
    v_lshlrev_b32 v48, 16, v75
    v_and_b32 v49, 0xffff0000, v75
    v_pk_add_f32 v[46:47], v[46:47], v[48:49]
    v_lshlrev_b32 v48, 16, v79
    v_and_b32 v49, 0xffff0000, v79
    v_pk_mul_f32 v[46:47], v[46:47], v[12:13] op_sel_hi:[1,0]
    v_pk_fma_f32 v[46:47], v[48:49], v[10:11], v[46:47] op_sel:[0,1,0] op_sel_hi:[1,1,1]
    v_cvt_pk_bf16_f32 v52, v40, v41
    v_cvt_pk_bf16_f32 v53, v42, v43
    v_cvt_pk_bf16_f32 v54, v44, v45
    v_cvt_pk_bf16_f32 v55, v46, v47
    buffer_store_dwordx2 v[52:53], v6, s[8:11], s63 offen
    buffer_store_dwordx2 v[54:55], v6, s[8:11], s63 offen offset:32
    s_add_u32 s63, s91, 5
    s_cmp_ge_u32 s63, 6
    s_cselect_b32 s56, 6, 0
    s_cselect_b64 s[50:51], -1, 0
    s_cselect_b32 s57, 18432, 0
    s_sub_u32 s63, s63, s56
    s_lshl_b32 s63, s63, 6
    s_mul_i32 s56, s6, 384
    s_add_u32 s63, s63, s56
    s_add_u32 s63, s63, s57
    v_cndmask_b32 v11, v14, v13, s[50:51]
    v_sub_f32 v12, 1.0, v11
    v_lshlrev_b32 v48, 16, v80
    v_and_b32 v49, 0xffff0000, v80
    v_pk_add_f32 v[40:41], v[208:209], v[48:49]
    v_lshlrev_b32 v48, 16, v84
    v_and_b32 v49, 0xffff0000, v84
    v_pk_add_f32 v[40:41], v[40:41], v[48:49]
    v_lshlrev_b32 v48, 16, v88
    v_and_b32 v49, 0xffff0000, v88
    v_pk_add_f32 v[40:41], v[40:41], v[48:49]
    v_lshlrev_b32 v48, 16, v92
    v_and_b32 v49, 0xffff0000, v92
    v_pk_mul_f32 v[40:41], v[40:41], v[12:13] op_sel_hi:[1,0]
    v_pk_fma_f32 v[40:41], v[48:49], v[10:11], v[40:41] op_sel:[0,1,0] op_sel_hi:[1,1,1]
    v_lshlrev_b32 v48, 16, v81
    v_and_b32 v49, 0xffff0000, v81
    v_pk_add_f32 v[42:43], v[210:211], v[48:49]
    v_lshlrev_b32 v48, 16, v85
    v_and_b32 v49, 0xffff0000, v85
    v_pk_add_f32 v[42:43], v[42:43], v[48:49]
    v_lshlrev_b32 v48, 16, v89
    v_and_b32 v49, 0xffff0000, v89
    v_pk_add_f32 v[42:43], v[42:43], v[48:49]
    v_lshlrev_b32 v48, 16, v93
    v_and_b32 v49, 0xffff0000, v93
    v_pk_mul_f32 v[42:43], v[42:43], v[12:13] op_sel_hi:[1,0]
    v_pk_fma_f32 v[42:43], v[48:49], v[10:11], v[42:43] op_sel:[0,1,0] op_sel_hi:[1,1,1]
    v_lshlrev_b32 v48, 16, v82
    v_and_b32 v49, 0xffff0000, v82
    v_pk_add_f32 v[44:45], v[212:213], v[48:49]
    v_lshlrev_b32 v48, 16, v86
    v_and_b32 v49, 0xffff0000, v86
    v_pk_add_f32 v[44:45], v[44:45], v[48:49]
    v_lshlrev_b32 v48, 16, v90
    v_and_b32 v49, 0xffff0000, v90
    v_pk_add_f32 v[44:45], v[44:45], v[48:49]
    v_lshlrev_b32 v48, 16, v94
    v_and_b32 v49, 0xffff0000, v94
    v_pk_mul_f32 v[44:45], v[44:45], v[12:13] op_sel_hi:[1,0]
    v_pk_fma_f32 v[44:45], v[48:49], v[10:11], v[44:45] op_sel:[0,1,0] op_sel_hi:[1,1,1]
    v_lshlrev_b32 v48, 16, v83
    v_and_b32 v49, 0xffff0000, v83
    v_pk_add_f32 v[46:47], v[214:215], v[48:49]
    v_lshlrev_b32 v48, 16, v87
    v_and_b32 v49, 0xffff0000, v87
    v_pk_add_f32 v[46:47], v[46:47], v[48:49]
    v_lshlrev_b32 v48, 16, v91
    v_and_b32 v49, 0xffff0000, v91
    v_pk_add_f32 v[46:47], v[46:47], v[48:49]
    v_lshlrev_b32 v48, 16, v95
    v_and_b32 v49, 0xffff0000, v95
    v_pk_mul_f32 v[46:47], v[46:47], v[12:13] op_sel_hi:[1,0]
    v_pk_fma_f32 v[46:47], v[48:49], v[10:11], v[46:47] op_sel:[0,1,0] op_sel_hi:[1,1,1]
    v_cvt_pk_bf16_f32 v56, v40, v41
    v_cvt_pk_bf16_f32 v57, v42, v43
    v_cvt_pk_bf16_f32 v58, v44, v45
    v_cvt_pk_bf16_f32 v59, v46, v47
    buffer_store_dwordx2 v[56:57], v6, s[8:11], s63 offen
    buffer_store_dwordx2 v[58:59], v6, s[8:11], s63 offen offset:32
    s_cmp_gt_u32 s91, 1
    s_cbranch_scc1 L_p2_end
    s_add_u32 s63, s91, 10
    s_cmp_ge_u32 s63, 6
    s_cselect_b32 s56, 6, 0
    s_cselect_b64 s[50:51], -1, 0
    s_cselect_b32 s57, 18432, 0
    s_sub_u32 s63, s63, s56
    s_lshl_b32 s63, s63, 6
    s_mul_i32 s56, s6, 384
    s_add_u32 s63, s63, s56
    s_add_u32 s63, s63, s57
    v_cndmask_b32 v11, v14, v13, s[50:51]
    v_sub_f32 v12, 1.0, v11
    v_lshlrev_b32 v48, 16, v96
    v_and_b32 v49, 0xffff0000, v96
    v_pk_add_f32 v[40:41], v[216:217], v[48:49]
    v_lshlrev_b32 v48, 16, v100
    v_and_b32 v49, 0xffff0000, v100
    v_pk_add_f32 v[40:41], v[40:41], v[48:49]
    v_lshlrev_b32 v48, 16, v104
    v_and_b32 v49, 0xffff0000, v104
    v_pk_add_f32 v[40:41], v[40:41], v[48:49]
    v_lshlrev_b32 v48, 16, v108
    v_and_b32 v49, 0xffff0000, v108
    v_pk_mul_f32 v[40:41], v[40:41], v[12:13] op_sel_hi:[1,0]
    v_pk_fma_f32 v[40:41], v[48:49], v[10:11], v[40:41] op_sel:[0,1,0] op_sel_hi:[1,1,1]
    v_lshlrev_b32 v48, 16, v97
    v_and_b32 v49, 0xffff0000, v97
    v_pk_add_f32 v[42:43], v[218:219], v[48:49]
    v_lshlrev_b32 v48, 16, v101
    v_and_b32 v49, 0xffff0000, v101
    v_pk_add_f32 v[42:43], v[42:43], v[48:49]
    v_lshlrev_b32 v48, 16, v105
    v_and_b32 v49, 0xffff0000, v105
    v_pk_add_f32 v[42:43], v[42:43], v[48:49]
    v_lshlrev_b32 v48, 16, v109
    v_and_b32 v49, 0xffff0000, v109
    v_pk_mul_f32 v[42:43], v[42:43], v[12:13] op_sel_hi:[1,0]
    v_pk_fma_f32 v[42:43], v[48:49], v[10:11], v[42:43] op_sel:[0,1,0] op_sel_hi:[1,1,1]
    v_lshlrev_b32 v48, 16, v98
    v_and_b32 v49, 0xffff0000, v98
    v_pk_add_f32 v[44:45], v[220:221], v[48:49]
    v_lshlrev_b32 v48, 16, v102
    v_and_b32 v49, 0xffff0000, v102
    v_pk_add_f32 v[44:45], v[44:45], v[48:49]
    v_lshlrev_b32 v48, 16, v106
    v_and_b32 v49, 0xffff0000, v106
    v_pk_add_f32 v[44:45], v[44:45], v[48:49]
    v_lshlrev_b32 v48, 16, v110
    v_and_b32 v49, 0xffff0000, v110
    v_pk_mul_f32 v[44:45], v[44:45], v[12:13] op_sel_hi:[1,0]
    v_pk_fma_f32 v[44:45], v[48:49], v[10:11], v[44:45] op_sel:[0,1,0] op_sel_hi:[1,1,1]
    v_lshlrev_b32 v48, 16, v99
    v_and_b32 v49, 0xffff0000, v99
    v_pk_add_f32 v[46:47], v[222:223], v[48:49]
    v_lshlrev_b32 v48, 16, v103
    v_and_b32 v49, 0xffff0000, v103
    v_pk_add_f32 v[46:47], v[46:47], v[48:49]
    v_lshlrev_b32 v48, 16, v107
    v_and_b32 v49, 0xffff0000, v107
    v_pk_add_f32 v[46:47], v[46:47], v[48:49]
    v_lshlrev_b32 v48, 16, v111
    v_and_b32 v49, 0xffff0000, v111
    v_pk_mul_f32 v[46:47], v[46:47], v[12:13] op_sel_hi:[1,0]
    v_pk_fma_f32 v[46:47], v[48:49], v[10:11], v[46:47] op_sel:[0,1,0] op_sel_hi:[1,1,1]
    v_cvt_pk_bf16_f32 v52, v40, v41
    v_cvt_pk_bf16_f32 v53, v42, v43
    v_cvt_pk_bf16_f32 v54, v44, v45
    v_cvt_pk_bf16_f32 v55, v46, v47
    buffer_store_dwordx2 v[52:53], v6, s[8:11], s63 offen
    buffer_store_dwordx2 v[54:55], v6, s[8:11], s63 offen offset:32
    s_branch L_p2_end
L_p3_att:
    s_add_u32 s63, s91, 0
    s_cmp_ge_u32 s63, 6
    s_cselect_b32 s56, 6, 0
    s_cselect_b64 s[50:51], -1, 0
    s_cselect_b32 s57, 18432, 0
    s_sub_u32 s63, s63, s56
    s_lshl_b32 s63, s63, 6
    s_mul_i32 s56, s6, 384
    s_add_u32 s63, s63, s56
    s_add_u32 s63, s63, s57
    v_cndmask_b32 v11, v14, v13, s[50:51]
    v_sub_f32 v12, 1.0, v11
    v_lshlrev_b32 v40, 16, v64
    v_and_b32 v41, 0xffff0000, v64
    v_lshlrev_b32 v48, 16, v68
    v_and_b32 v49, 0xffff0000, v68
    v_pk_add_f32 v[40:41], v[40:41], v[48:49]
    v_lshlrev_b32 v48, 16, v72
    v_and_b32 v49, 0xffff0000, v72
    v_pk_add_f32 v[40:41], v[40:41], v[48:49]
    v_lshlrev_b32 v48, 16, v76
    v_and_b32 v49, 0xffff0000, v76
    v_pk_add_f32 v[40:41], v[40:41], v[48:49]
    v_pk_mul_f32 v[40:41], v[40:41], v[12:13] op_sel_hi:[1,0]
    v_pk_fma_f32 v[40:41], v[200:201], v[10:11], v[40:41] op_sel:[0,1,0] op_sel_hi:[1,1,1]
    v_lshlrev_b32 v42, 16, v65
    v_and_b32 v43, 0xffff0000, v65
    v_lshlrev_b32 v48, 16, v69
    v_and_b32 v49, 0xffff0000, v69
    v_pk_add_f32 v[42:43], v[42:43], v[48:49]
    v_lshlrev_b32 v48, 16, v73
    v_and_b32 v49, 0xffff0000, v73
    v_pk_add_f32 v[42:43], v[42:43], v[48:49]
    v_lshlrev_b32 v48, 16, v77
    v_and_b32 v49, 0xffff0000, v77
    v_pk_add_f32 v[42:43], v[42:43], v[48:49]
    v_pk_mul_f32 v[42:43], v[42:43], v[12:13] op_sel_hi:[1,0]
    v_pk_fma_f32 v[42:43], v[202:203], v[10:11], v[42:43] op_sel:[0,1,0] op_sel_hi:[1,1,1]
    v_lshlrev_b32 v44, 16, v66
    v_and_b32 v45, 0xffff0000, v66
    v_lshlrev_b32 v48, 16, v70
    v_and_b32 v49, 0xffff0000, v70
    v_pk_add_f32 v[44:45], v[44:45], v[48:49]
    v_lshlrev_b32 v48, 16, v74
    v_and_b32 v49, 0xffff0000, v74
    v_pk_add_f32 v[44:45], v[44:45], v[48:49]
    v_lshlrev_b32 v48, 16, v78
    v_and_b32 v49, 0xffff0000, v78
    v_pk_add_f32 v[44:45], v[44:45], v[48:49]
    v_pk_mul_f32 v[44:45], v[44:45], v[12:13] op_sel_hi:[1,0]
    v_pk_fma_f32 v[44:45], v[204:205], v[10:11], v[44:45] op_sel:[0,1,0] op_sel_hi:[1,1,1]
    v_lshlrev_b32 v46, 16, v67
    v_and_b32 v47, 0xffff0000, v67
    v_lshlrev_b32 v48, 16, v71
    v_and_b32 v49, 0xffff0000, v71
    v_pk_add_f32 v[46:47], v[46:47], v[48:49]
    v_lshlrev_b32 v48, 16, v75
    v_and_b32 v49, 0xffff0000, v75
    v_pk_add_f32 v[46:47], v[46:47], v[48:49]
    v_lshlrev_b32 v48, 16, v79
    v_and_b32 v49, 0xffff0000, v79
    v_pk_add_f32 v[46:47], v[46:47], v[48:49]
    v_pk_mul_f32 v[46:47], v[46:47], v[12:13] op_sel_hi:[1,0]
    v_pk_fma_f32 v[46:47], v[206:207], v[10:11], v[46:47] op_sel:[0,1,0] op_sel_hi:[1,1,1]
    v_cvt_pk_bf16_f32 v52, v40, v41
    v_cvt_pk_bf16_f32 v53, v42, v43
    v_cvt_pk_bf16_f32 v54, v44, v45
    v_cvt_pk_bf16_f32 v55, v46, v47
    buffer_store_dwordx2 v[52:53], v6, s[8:11], s63 offen
    buffer_store_dwordx2 v[54:55], v6, s[8:11], s63 offen offset:32
    s_add_u32 s63, s91, 5
    s_cmp_ge_u32 s63, 6
    s_cselect_b32 s56, 6, 0
    s_cselect_b64 s[50:51], -1, 0
    s_cselect_b32 s57, 18432, 0
    s_sub_u32 s63, s63, s56
    s_lshl_b32 s63, s63, 6
    s_mul_i32 s56, s6, 384
    s_add_u32 s63, s63, s56
    s_add_u32 s63, s63, s57
    v_cndmask_b32 v11, v14, v13, s[50:51]
    v_sub_f32 v12, 1.0, v11
    v_lshlrev_b32 v40, 16, v80
    v_and_b32 v41, 0xffff0000, v80
    v_lshlrev_b32 v48, 16, v84
    v_and_b32 v49, 0xffff0000, v84
    v_pk_add_f32 v[40:41], v[40:41], v[48:49]
    v_lshlrev_b32 v48, 16, v88
    v_and_b32 v49, 0xffff0000, v88
    v_pk_add_f32 v[40:41], v[40:41], v[48:49]
    v_lshlrev_b32 v48, 16, v92
    v_and_b32 v49, 0xffff0000, v92
    v_pk_add_f32 v[40:41], v[40:41], v[48:49]
    v_pk_mul_f32 v[40:41], v[40:41], v[12:13] op_sel_hi:[1,0]
    v_pk_fma_f32 v[40:41], v[208:209], v[10:11], v[40:41] op_sel:[0,1,0] op_sel_hi:[1,1,1]
    v_lshlrev_b32 v42, 16, v81
    v_and_b32 v43, 0xffff0000, v81
    v_lshlrev_b32 v48, 16, v85
    v_and_b32 v49, 0xffff0000, v85
    v_pk_add_f32 v[42:43], v[42:43], v[48:49]
    v_lshlrev_b32 v48, 16, v89
    v_and_b32 v49, 0xffff0000, v89
    v_pk_add_f32 v[42:43], v[42:43], v[48:49]
    v_lshlrev_b32 v48, 16, v93
    v_and_b32 v49, 0xffff0000, v93
    v_pk_add_f32 v[42:43], v[42:43], v[48:49]
    v_pk_mul_f32 v[42:43], v[42:43], v[12:13] op_sel_hi:[1,0]
    v_pk_fma_f32 v[42:43], v[210:211], v[10:11], v[42:43] op_sel:[0,1,0] op_sel_hi:[1,1,1]
    v_lshlrev_b32 v44, 16, v82
    v_and_b32 v45, 0xffff0000, v82
    v_lshlrev_b32 v48, 16, v86
    v_and_b32 v49, 0xffff0000, v86
    v_pk_add_f32 v[44:45], v[44:45], v[48:49]
    v_lshlrev_b32 v48, 16, v90
    v_and_b32 v49, 0xffff0000, v90
    v_pk_add_f32 v[44:45], v[44:45], v[48:49]
    v_lshlrev_b32 v48, 16, v94
    v_and_b32 v49, 0xffff0000, v94
    v_pk_add_f32 v[44:45], v[44:45], v[48:49]
    v_pk_mul_f32 v[44:45], v[44:45], v[12:13] op_sel_hi:[1,0]
    v_pk_fma_f32 v[44:45], v[212:213], v[10:11], v[44:45] op_sel:[0,1,0] op_sel_hi:[1,1,1]
    v_lshlrev_b32 v46, 16, v83
    v_and_b32 v47, 0xffff0000, v83
    v_lshlrev_b32 v48, 16, v87
    v_and_b32 v49, 0xffff0000, v87
    v_pk_add_f32 v[46:47], v[46:47], v[48:49]
    v_lshlrev_b32 v48, 16, v91
    v_and_b32 v49, 0xffff0000, v91
    v_pk_add_f32 v[46:47], v[46:47], v[48:49]
    v_lshlrev_b32 v48, 16, v95
    v_and_b32 v49, 0xffff0000, v95
    v_pk_add_f32 v[46:47], v[46:47], v[48:49]
    v_pk_mul_f32 v[46:47], v[46:47], v[12:13] op_sel_hi:[1,0]
    v_pk_fma_f32 v[46:47], v[214:215], v[10:11], v[46:47] op_sel:[0,1,0] op_sel_hi:[1,1,1]
    v_cvt_pk_bf16_f32 v56, v40, v41
    v_cvt_pk_bf16_f32 v57, v42, v43
    v_cvt_pk_bf16_f32 v58, v44, v45
    v_cvt_pk_bf16_f32 v59, v46, v47
    buffer_store_dwordx2 v[56:57], v6, s[8:11], s63 offen
    buffer_store_dwordx2 v[58:59], v6, s[8:11], s63 offen offset:32
    s_cmp_gt_u32 s91, 1
    s_cbranch_scc1 L_p2_end
    s_branch L_p2_end
L_gate:
    s_load_dwordx2 s[8:9], s[0:1], 0
    s_load_dwordx2 s[12:13], s[0:1], 64
    v_and_b32 v1, 63, v0
    v_lshrrev_b32 v2, 3, v1
    v_and_b32 v3, 7, v1
    v_lshlrev_b32 v4, 4, v3
    v_mul_u32_u24 v5, 0x480, v2
    v_add_u32 v5, v5, v4
    v_lshlrev_b32 v6, 2, v2
    s_sub_u32 s47, s92, 48
    s_lshl_b32 s47, s47, 4
    s_lshl_b32 s46, s93, 2
    s_add_u32 s47, s47, s46
    s_add_u32 s16, s70, 22020096
    s_addc_u32 s17, s71, 0
    s_mov_b32 s18, 8192
    s_mov_b32 s19, 0x20000
    s_waitcnt lgkmcnt(0)
    s_mov_b32 s10, 2359296
    s_mov_b32 s11, 0x20000
    s_mov_b32 s14, 1152
    s_mov_b32 s15, 0x20000
    buffer_load_dwordx4 v[16:19], v4, s[12:15], 0 offen offset:0
    buffer_load_dwordx4 v[20:23], v4, s[12:15], 0 offen offset:128
    buffer_load_dwordx4 v[24:27], v4, s[12:15], 0 offen offset:256
    buffer_load_dwordx4 v[28:31], v4, s[12:15], 0 offen offset:384
    buffer_load_dwordx4 v[32:35], v4, s[12:15], 0 offen offset:512
    buffer_load_dwordx4 v[36:39], v4, s[12:15], 0 offen offset:640
    buffer_load_dwordx4 v[40:43], v4, s[12:15], 0 offen offset:768
    buffer_load_dwordx4 v[44:47], v4, s[12:15], 0 offen offset:896
    buffer_load_dwordx4 v[48:51], v4, s[12:15], 0 offen offset:1024
    s_add_u32 s46, s47, 0
    s_mul_i32 s46, s46, 9216
    buffer_load_dwordx4 v[64:67], v5, s[8:11], s46 offen offset:0
    buffer_load_dwordx4 v[68:71], v5, s[8:11], s46 offen offset:128
    buffer_load_dwordx4 v[72:75], v5, s[8:11], s46 offen offset:256
    buffer_load_dwordx4 v[76:79], v5, s[8:11], s46 offen offset:384
    buffer_load_dwordx4 v[80:83], v5, s[8:11], s46 offen offset:512
    buffer_load_dwordx4 v[84:87], v5, s[8:11], s46 offen offset:640
    buffer_load_dwordx4 v[88:91], v5, s[8:11], s46 offen offset:768
    buffer_load_dwordx4 v[92:95], v5, s[8:11], s46 offen offset:896
    buffer_load_dwordx4 v[96:99], v5, s[8:11], s46 offen offset:1024
    s_add_u32 s46, s47, 1
    s_mul_i32 s46, s46, 9216
    buffer_load_dwordx4 v[100:103], v5, s[8:11], s46 offen offset:0
    buffer_load_dwordx4 v[104:107], v5, s[8:11], s46 offen offset:128
    buffer_load_dwordx4 v[108:111], v5, s[8:11], s46 offen offset:256
    buffer_load_dwordx4 v[112:115], v5, s[8:11], s46 offen offset:384
    buffer_load_dwordx4 v[116:119], v5, s[8:11], s46 offen offset:512
    buffer_load_dwordx4 v[120:123], v5, s[8:11], s46 offen offset:640
    buffer_load_dwordx4 v[124:127], v5, s[8:11], s46 offen offset:768
    buffer_load_dwordx4 v[128:131], v5, s[8:11], s46 offen offset:896
    buffer_load_dwordx4 v[132:135], v5, s[8:11], s46 offen offset:1024
    s_add_u32 s46, s47, 2
    s_mul_i32 s46, s46, 9216
    buffer_load_dwordx4 v[136:139], v5, s[8:11], s46 offen offset:0
    buffer_load_dwordx4 v[140:143], v5, s[8:11], s46 offen offset:128
    buffer_load_dwordx4 v[144:147], v5, s[8:11], s46 offen offset:256
    buffer_load_dwordx4 v[148:151], v5, s[8:11], s46 offen offset:384
    buffer_load_dwordx4 v[152:155], v5, s[8:11], s46 offen offset:512
    buffer_load_dwordx4 v[156:159], v5, s[8:11], s46 offen offset:640
    buffer_load_dwordx4 v[160:163], v5, s[8:11], s46 offen offset:768
    buffer_load_dwordx4 v[164:167], v5, s[8:11], s46 offen offset:896
    buffer_load_dwordx4 v[168:171], v5, s[8:11], s46 offen offset:1024
    s_add_u32 s46, s47, 3
    s_mul_i32 s46, s46, 9216
    buffer_load_dwordx4 v[172:175], v5, s[8:11], s46 offen offset:0
    buffer_load_dwordx4 v[176:179], v5, s[8:11], s46 offen offset:128
    buffer_load_dwordx4 v[180:183], v5, s[8:11], s46 offen offset:256
    buffer_load_dwordx4 v[184:187], v5, s[8:11], s46 offen offset:384
    buffer_load_dwordx4 v[188:191], v5, s[8:11], s46 offen offset:512
    buffer_load_dwordx4 v[192:195], v5, s[8:11], s46 offen offset:640
    buffer_load_dwordx4 v[196:199], v5, s[8:11], s46 offen offset:768
    buffer_load_dwordx4 v[200:203], v5, s[8:11], s46 offen offset:896
    buffer_load_dwordx4 v[204:207], v5, s[8:11], s46 offen offset:1024
    s_waitcnt vmcnt(0)
    v_mov_b32 v8, 0
    v_mov_b32 v9, 0
    v_dot2_f32_bf16 v8, v64, v16, v8
    v_dot2_f32_bf16 v9, v65, v17, v9
    v_dot2_f32_bf16 v8, v66, v18, v8
    v_dot2_f32_bf16 v9, v67, v19, v9
    v_dot2_f32_bf16 v8, v68, v20, v8
    v_dot2_f32_bf16 v9, v69, v21, v9
    v_dot2_f32_bf16 v8, v70, v22, v8
    v_dot2_f32_bf16 v9, v71, v23, v9
    v_dot2_f32_bf16 v8, v72, v24, v8
    v_dot2_f32_bf16 v9, v73, v25, v9
    v_dot2_f32_bf16 v8, v74, v26, v8
    v_dot2_f32_bf16 v9, v75, v27, v9
    v_dot2_f32_bf16 v8, v76, v28, v8
    v_dot2_f32_bf16 v9, v77, v29, v9
    v_dot2_f32_bf16 v8, v78, v30, v8
    v_dot2_f32_bf16 v9, v79, v31, v9
    v_dot2_f32_bf16 v8, v80, v32, v8
    v_dot2_f32_bf16 v9, v81, v33, v9
    v_dot2_f32_bf16 v8, v82, v34, v8
    v_dot2_f32_bf16 v9, v83, v35, v9
    v_dot2_f32_bf16 v8, v84, v36, v8
    v_dot2_f32_bf16 v9, v85, v37, v9
    v_dot2_f32_bf16 v8, v86, v38, v8
    v_dot2_f32_bf16 v9, v87, v39, v9
    v_dot2_f32_bf16 v8, v88, v40, v8
    v_dot2_f32_bf16 v9, v89, v41, v9
    v_dot2_f32_bf16 v8, v90, v42, v8
    v_dot2_f32_bf16 v9, v91, v43, v9
    v_dot2_f32_bf16 v8, v92, v44, v8
    v_dot2_f32_bf16 v9, v93, v45, v9
    v_dot2_f32_bf16 v8, v94, v46, v8
    v_dot2_f32_bf16 v9, v95, v47, v9
    v_dot2_f32_bf16 v8, v96, v48, v8
    v_dot2_f32_bf16 v9, v97, v49, v9
    v_dot2_f32_bf16 v8, v98, v50, v8
    v_dot2_f32_bf16 v9, v99, v51, v9
    s_nop 3
    v_add_f32 v8, v8, v9
    s_nop 0
    ds_swizzle_b32 v9, v8 offset:0x041F
    s_waitcnt lgkmcnt(0)
    v_add_f32 v8, v8, v9
    s_nop 0
    ds_swizzle_b32 v9, v8 offset:0x081F
    s_waitcnt lgkmcnt(0)
    v_add_f32 v8, v8, v9
    s_nop 0
    ds_swizzle_b32 v9, v8 offset:0x101F
    s_waitcnt lgkmcnt(0)
    v_add_f32 v8, v8, v9
    v_mul_f32 v8, 0xbfb8aa3b, v8
    v_exp_f32 v8, v8
    s_nop 0
    v_add_f32 v8, 1.0, v8
    v_rcp_f32 v8, v8
    s_add_u32 s46, s47, 0
    s_lshl_b32 s46, s46, 5
    v_cmp_eq_u32 vcc, 0, v3
    s_and_saveexec_b64 s[22:23], vcc
    buffer_store_dword v8, v6, s[16:19], s46 offen sc1
    s_mov_b64 exec, s[22:23]
    v_mov_b32 v8, 0
    v_mov_b32 v9, 0
    v_dot2_f32_bf16 v8, v100, v16, v8
    v_dot2_f32_bf16 v9, v101, v17, v9
    v_dot2_f32_bf16 v8, v102, v18, v8
    v_dot2_f32_bf16 v9, v103, v19, v9
    v_dot2_f32_bf16 v8, v104, v20, v8
    v_dot2_f32_bf16 v9, v105, v21, v9
    v_dot2_f32_bf16 v8, v106, v22, v8
    v_dot2_f32_bf16 v9, v107, v23, v9
    v_dot2_f32_bf16 v8, v108, v24, v8
    v_dot2_f32_bf16 v9, v109, v25, v9
    v_dot2_f32_bf16 v8, v110, v26, v8
    v_dot2_f32_bf16 v9, v111, v27, v9
    v_dot2_f32_bf16 v8, v112, v28, v8
    v_dot2_f32_bf16 v9, v113, v29, v9
    v_dot2_f32_bf16 v8, v114, v30, v8
    v_dot2_f32_bf16 v9, v115, v31, v9
    v_dot2_f32_bf16 v8, v116, v32, v8
    v_dot2_f32_bf16 v9, v117, v33, v9
    v_dot2_f32_bf16 v8, v118, v34, v8
    v_dot2_f32_bf16 v9, v119, v35, v9
    v_dot2_f32_bf16 v8, v120, v36, v8
    v_dot2_f32_bf16 v9, v121, v37, v9
    v_dot2_f32_bf16 v8, v122, v38, v8
    v_dot2_f32_bf16 v9, v123, v39, v9
    v_dot2_f32_bf16 v8, v124, v40, v8
    v_dot2_f32_bf16 v9, v125, v41, v9
    v_dot2_f32_bf16 v8, v126, v42, v8
    v_dot2_f32_bf16 v9, v127, v43, v9
    v_dot2_f32_bf16 v8, v128, v44, v8
    v_dot2_f32_bf16 v9, v129, v45, v9
    v_dot2_f32_bf16 v8, v130, v46, v8
    v_dot2_f32_bf16 v9, v131, v47, v9
    v_dot2_f32_bf16 v8, v132, v48, v8
    v_dot2_f32_bf16 v9, v133, v49, v9
    v_dot2_f32_bf16 v8, v134, v50, v8
    v_dot2_f32_bf16 v9, v135, v51, v9
    s_nop 3
    v_add_f32 v8, v8, v9
    s_nop 0
    ds_swizzle_b32 v9, v8 offset:0x041F
    s_waitcnt lgkmcnt(0)
    v_add_f32 v8, v8, v9
    s_nop 0
    ds_swizzle_b32 v9, v8 offset:0x081F
    s_waitcnt lgkmcnt(0)
    v_add_f32 v8, v8, v9
    s_nop 0
    ds_swizzle_b32 v9, v8 offset:0x101F
    s_waitcnt lgkmcnt(0)
    v_add_f32 v8, v8, v9
    v_mul_f32 v8, 0xbfb8aa3b, v8
    v_exp_f32 v8, v8
    s_nop 0
    v_add_f32 v8, 1.0, v8
    v_rcp_f32 v8, v8
    s_add_u32 s46, s47, 1
    s_lshl_b32 s46, s46, 5
    v_cmp_eq_u32 vcc, 0, v3
    s_and_saveexec_b64 s[22:23], vcc
    buffer_store_dword v8, v6, s[16:19], s46 offen sc1
    s_mov_b64 exec, s[22:23]
    v_mov_b32 v8, 0
    v_mov_b32 v9, 0
    v_dot2_f32_bf16 v8, v136, v16, v8
    v_dot2_f32_bf16 v9, v137, v17, v9
    v_dot2_f32_bf16 v8, v138, v18, v8
    v_dot2_f32_bf16 v9, v139, v19, v9
    v_dot2_f32_bf16 v8, v140, v20, v8
    v_dot2_f32_bf16 v9, v141, v21, v9
    v_dot2_f32_bf16 v8, v142, v22, v8
    v_dot2_f32_bf16 v9, v143, v23, v9
    v_dot2_f32_bf16 v8, v144, v24, v8
    v_dot2_f32_bf16 v9, v145, v25, v9
    v_dot2_f32_bf16 v8, v146, v26, v8
    v_dot2_f32_bf16 v9, v147, v27, v9
    v_dot2_f32_bf16 v8, v148, v28, v8
    v_dot2_f32_bf16 v9, v149, v29, v9
    v_dot2_f32_bf16 v8, v150, v30, v8
    v_dot2_f32_bf16 v9, v151, v31, v9
    v_dot2_f32_bf16 v8, v152, v32, v8
    v_dot2_f32_bf16 v9, v153, v33, v9
    v_dot2_f32_bf16 v8, v154, v34, v8
    v_dot2_f32_bf16 v9, v155, v35, v9
    v_dot2_f32_bf16 v8, v156, v36, v8
    v_dot2_f32_bf16 v9, v157, v37, v9
    v_dot2_f32_bf16 v8, v158, v38, v8
    v_dot2_f32_bf16 v9, v159, v39, v9
    v_dot2_f32_bf16 v8, v160, v40, v8
    v_dot2_f32_bf16 v9, v161, v41, v9
    v_dot2_f32_bf16 v8, v162, v42, v8
    v_dot2_f32_bf16 v9, v163, v43, v9
    v_dot2_f32_bf16 v8, v164, v44, v8
    v_dot2_f32_bf16 v9, v165, v45, v9
    v_dot2_f32_bf16 v8, v166, v46, v8
    v_dot2_f32_bf16 v9, v167, v47, v9
    v_dot2_f32_bf16 v8, v168, v48, v8
    v_dot2_f32_bf16 v9, v169, v49, v9
    v_dot2_f32_bf16 v8, v170, v50, v8
    v_dot2_f32_bf16 v9, v171, v51, v9
    s_nop 3
    v_add_f32 v8, v8, v9
    s_nop 0
    ds_swizzle_b32 v9, v8 offset:0x041F
    s_waitcnt lgkmcnt(0)
    v_add_f32 v8, v8, v9
    s_nop 0
    ds_swizzle_b32 v9, v8 offset:0x081F
    s_waitcnt lgkmcnt(0)
    v_add_f32 v8, v8, v9
    s_nop 0
    ds_swizzle_b32 v9, v8 offset:0x101F
    s_waitcnt lgkmcnt(0)
    v_add_f32 v8, v8, v9
    v_mul_f32 v8, 0xbfb8aa3b, v8
    v_exp_f32 v8, v8
    s_nop 0
    v_add_f32 v8, 1.0, v8
    v_rcp_f32 v8, v8
    s_add_u32 s46, s47, 2
    s_lshl_b32 s46, s46, 5
    v_cmp_eq_u32 vcc, 0, v3
    s_and_saveexec_b64 s[22:23], vcc
    buffer_store_dword v8, v6, s[16:19], s46 offen sc1
    s_mov_b64 exec, s[22:23]
    v_mov_b32 v8, 0
    v_mov_b32 v9, 0
    v_dot2_f32_bf16 v8, v172, v16, v8
    v_dot2_f32_bf16 v9, v173, v17, v9
    v_dot2_f32_bf16 v8, v174, v18, v8
    v_dot2_f32_bf16 v9, v175, v19, v9
    v_dot2_f32_bf16 v8, v176, v20, v8
    v_dot2_f32_bf16 v9, v177, v21, v9
    v_dot2_f32_bf16 v8, v178, v22, v8
    v_dot2_f32_bf16 v9, v179, v23, v9
    v_dot2_f32_bf16 v8, v180, v24, v8
    v_dot2_f32_bf16 v9, v181, v25, v9
    v_dot2_f32_bf16 v8, v182, v26, v8
    v_dot2_f32_bf16 v9, v183, v27, v9
    v_dot2_f32_bf16 v8, v184, v28, v8
    v_dot2_f32_bf16 v9, v185, v29, v9
    v_dot2_f32_bf16 v8, v186, v30, v8
    v_dot2_f32_bf16 v9, v187, v31, v9
    v_dot2_f32_bf16 v8, v188, v32, v8
    v_dot2_f32_bf16 v9, v189, v33, v9
    v_dot2_f32_bf16 v8, v190, v34, v8
    v_dot2_f32_bf16 v9, v191, v35, v9
    v_dot2_f32_bf16 v8, v192, v36, v8
    v_dot2_f32_bf16 v9, v193, v37, v9
    v_dot2_f32_bf16 v8, v194, v38, v8
    v_dot2_f32_bf16 v9, v195, v39, v9
    v_dot2_f32_bf16 v8, v196, v40, v8
    v_dot2_f32_bf16 v9, v197, v41, v9
    v_dot2_f32_bf16 v8, v198, v42, v8
    v_dot2_f32_bf16 v9, v199, v43, v9
    v_dot2_f32_bf16 v8, v200, v44, v8
    v_dot2_f32_bf16 v9, v201, v45, v9
    v_dot2_f32_bf16 v8, v202, v46, v8
    v_dot2_f32_bf16 v9, v203, v47, v9
    v_dot2_f32_bf16 v8, v204, v48, v8
    v_dot2_f32_bf16 v9, v205, v49, v9
    v_dot2_f32_bf16 v8, v206, v50, v8
    v_dot2_f32_bf16 v9, v207, v51, v9
    s_nop 3
    v_add_f32 v8, v8, v9
    s_nop 0
    ds_swizzle_b32 v9, v8 offset:0x041F
    s_waitcnt lgkmcnt(0)
    v_add_f32 v8, v8, v9
    s_nop 0
    ds_swizzle_b32 v9, v8 offset:0x081F
    s_waitcnt lgkmcnt(0)
    v_add_f32 v8, v8, v9
    s_nop 0
    ds_swizzle_b32 v9, v8 offset:0x101F
    s_waitcnt lgkmcnt(0)
    v_add_f32 v8, v8, v9
    v_mul_f32 v8, 0xbfb8aa3b, v8
    v_exp_f32 v8, v8
    s_nop 0
    v_add_f32 v8, 1.0, v8
    v_rcp_f32 v8, v8
    s_add_u32 s46, s47, 3
    s_lshl_b32 s46, s46, 5
    v_cmp_eq_u32 vcc, 0, v3
    s_and_saveexec_b64 s[22:23], vcc
    buffer_store_dword v8, v6, s[16:19], s46 offen sc1
    s_mov_b64 exec, s[22:23]
    s_waitcnt vmcnt(0)
    s_barrier
    s_mov_b32 s46, 272
    s_cmp_eq_u32 s93, 0
    s_cbranch_scc0 L_gate_sig
    s_lshl_b32 s38, s46, 7
    v_mov_b32 v10, s38
    v_mov_b32 v11, 1
    v_cmp_eq_u32 vcc, 0, v0
    s_and_saveexec_b64 s[48:49], vcc
    global_atomic_add v10, v11, s[64:65] sc1
    s_mov_b64 exec, s[48:49]
L_gate_sig:
L_p2_end:
    s_endpgm
L_k1_end:
    s_endpgm
L_code_end:
.section .rodata,"a"
.p2align 6
.amdhsa_kernel gated_mix__linear_kernel_hedgehog__geglu_ffn__prompt_kernel
  .amdhsa_next_free_vgpr 512
  .amdhsa_next_free_sgpr 102
  .amdhsa_accum_offset 256
  .amdhsa_group_segment_fixed_size 0
  .amdhsa_kernarg_size 96
  .amdhsa_user_sgpr_count 2
  .amdhsa_user_sgpr_kernarg_segment_ptr 1
  .amdhsa_system_sgpr_workgroup_id_x 1
  .amdhsa_float_denorm_mode_32 3
  .amdhsa_float_denorm_mode_16_64 3
.end_amdhsa_kernel
```
